```python
import torch

def _softmax(x, axis=-1):
    return torch.softmax(x, dim=axis)

def _gelu(x):
    return torch.nn.functional.gelu(x, approximate='tanh')

def _silu(x):
    return torch.nn.functional.silu(x)

def _sigmoid(x):
    return torch.sigmoid(x)

def _layernorm(x, axis=-1, eps=1e-05):
    m = x.mean(dim=axis, keepdim=True)
    v = x.var(dim=axis, keepdim=True, unbiased=False)
    return (x - m) / torch.sqrt(v + eps)

def _scatter_add(tgt, idx, src, axis=0):
    return tgt.clone().index_add_(axis, idx, src)

def _segment_sum(src, seg, n):
    out = torch.zeros((n,) + src.shape[1:], dtype=src.dtype)
    return out.index_add_(0, seg, src)

def _pad(x, pw):
    flat = tuple((v for pair in reversed(pw) for v in pair))
    return torch.nn.functional.pad(x, flat)
kernel_name = 'standalone__factorization_afm__recsys'

def setup_inputs():

    _w = lambda a: (lambda t: t.to(torch.bfloat16) if t.is_floating_point() else t)(torch.as_tensor(a))
    B, F, D, V = (4096, 26, 128, min(1000000, 100000))
    A = D
    ii, jj = tuple(torch.triu_indices(F, F, 1).unbind(0))
    return {'idx': _w((lambda lo, hi, *s: torch.randint(lo, hi, s))(0, V, B, F).to(torch.int64)), 'table': _w((lambda *s: torch.randn(*s, dtype=torch.bfloat16) * 0.2)(V, D)), 'ii': _w(ii.to(torch.int64)), 'jj': _w(jj.to(torch.int64)), 'W': _w((lambda *s: torch.randn(*s, dtype=torch.bfloat16) * 1.6)(D, A) * (1.0 / D ** 0.5)), 'b': _w((lambda *s: torch.randn(*s, dtype=torch.bfloat16) * 1.6)(A)), 'h': _w((lambda *s: torch.randn(*s, dtype=torch.bfloat16) * 1.6)(A)), 'p': _w((lambda *s: torch.randn(*s, dtype=torch.bfloat16) * 0.2)(D))}

def reference(idx, table, ii, jj, W, b, h, p):
    emb = table[idx]
    ei = emb[:, ii, :].clone()
    ej = emb[:, jj, :].clone()
    pair = ei * ej
    hid = pair @ W + b
    hid = 0.5 * (hid + torch.abs(hid))
    e = hid @ h
    alpha = _softmax(e, axis=-1)
    pooled = torch.einsum('bp,bpd->bd', alpha, pair)
    return pooled @ p
```

```asm
; @launch grid=(256,1,1) block=(256,1,1) lds=44160
.amdgcn_target "amdgcn-amd-amdhsa--gfx950"
.text
.globl standalone__factorization_afm__recsys_kernel
.p2align 12
.p2align 8
.type standalone__factorization_afm__recsys_kernel,@function
standalone__factorization_afm__recsys_kernel:
    s_cmp_ge_u32 s2, 256
    s_cbranch_scc1 L_done
    s_load_dwordx4 s[4:7], s[0:1], 0
    s_load_dwordx4 s[8:11], s[0:1], 32
    s_load_dwordx4 s[12:15], s[0:1], 48
    s_load_dwordx2 s[16:17], s[0:1], 64
    v_lshrrev_b32 v75, 6, v0
    v_and_b32 v64, 15, v0
    v_readfirstlane_b32 s18, v75
    s_getpc_b64 s[32:33]
L_pfbase:
    s_getreg_b32 s3, hwreg(HW_REG_HW_ID, 13, 2)
    s_getreg_b32 s19, hwreg(HW_REG_HW_ID, 8, 2)
    s_lshl2_add_u32 s3, s3, s19
    s_getreg_b32 s19, hwreg(HW_REG_HW_ID, 4, 2)
    s_lshl2_add_u32 s3, s3, s19
    s_mul_i32 s3, s3, 768
    v_min_u32 v70, 5, v64
    v_lshl_add_u32 v70, v70, 7, s3
    v_min_u32 v70, L_end-L_pfbase-4, v70
    global_load_dword v255, v70, s[32:33]
    s_lshl_b32 s3, s2, 2
    s_add_u32 s3, s3, s18
    s_mul_i32 s19, s3, 416
    v_lshl_add_u32 v248, v64, 2, s19
    v_bfe_u32 v65, v0, 4, 2
    s_lshl_b32 s26, s18, 13
    v_lshrrev_b32 v74, 1, v64
    v_xor_b32 v72, v74, v65
    v_lshlrev_b32 v72, 5, v72
    v_and_b32 v73, 1, v0
    v_lshl_add_u32 v72, v73, 4, v72
    v_lshl_add_u32 v72, v65, 8, v72
    v_add_u32 v67, s26, v72
    v_xor_b32 v68, 0x80, v67
    s_add_u32 s27, s26, 0x1000
    s_mov_b32 m0, s26
    s_waitcnt lgkmcnt(0)
    global_load_dword v245, v248, s[4:5] nt
    global_load_lds_dwordx4 v67, s[8:9] offset:0
    global_load_lds_dwordx4 v67, s[8:9] offset:1024
    global_load_lds_dwordx4 v68, s[8:9] offset:2048
    global_load_lds_dwordx4 v68, s[8:9] offset:3072
    v_add_u32 v67, 0x1000, v67
    s_mov_b32 m0, s27
    v_add_u32 v68, 0x1000, v68
    global_load_lds_dwordx4 v67, s[8:9] offset:0
    global_load_lds_dwordx4 v67, s[8:9] offset:1024
    global_load_lds_dwordx4 v68, s[8:9] offset:2048
    global_load_lds_dwordx4 v68, s[8:9] offset:3072
    v_and_b32 v66, 63, v0
    v_lshlrev_b32 v71, 2, v66
    v_cmp_eq_u32 vcc, 0, v75
    v_lshlrev_b32 v72, 2, v73
    v_lshl_add_u32 v72, v74, 5, v72
    v_lshl_add_u32 v72, v65, 3, v72
    v_cndmask_b32 v71, v71, v72, vcc
    v_cmp_eq_u32 vcc, 2, v75
    v_bfe_u32 v68, v0, 5, 1
    v_lshlrev_b32 v68, 2, v68
    v_and_b32 v72, 31, v0
    v_lshl_add_u32 v72, v72, 3, v68
    v_cndmask_b32 v71, v71, v72, vcc
    v_cmp_eq_u32 vcc, 3, v75
    v_lshl_add_u32 v68, v73, 5, v68
    v_and_b32 v72, 3, v74
    v_lshl_add_u32 v68, v72, 3, v68
    v_bfe_u32 v72, v0, 3, 2
    v_lshl_add_u32 v68, v72, 6, v68
    v_cndmask_b32 v71, v71, v68, vcc
    s_mov_b32 s28, 32768
    s_cmp_eq_u32 s18, 1
    s_cselect_b32 s28, 33664, s28
    s_cmp_eq_u32 s18, 3
    s_cselect_b32 s28, 33024, s28
    s_cselect_b64 s[34:35], s[12:13], s[14:15]
    s_cmp_eq_u32 s18, 0
    s_cselect_b32 s28, 33408, s28
    s_mov_b32 m0, s28
    s_cselect_b64 s[34:35], s[10:11], s[34:35]
    global_load_lds_dword v71, s[34:35]
    v_lshlrev_b32 v251, 4, v65
    s_mov_b32 s20, 0x37512340
    s_mov_b32 s21, 0x98730962
    s_mov_b32 s28, 0x90417682
    s_mov_b32 s29, 0x61854951
    v_lshlrev_b32 v250, 2, v64
    v_lshrrev_b64 v[72:73], v250, s[20:21]
    v_and_b32 v249, 15, v72
    v_lshrrev_b64 v[72:73], v250, s[28:29]
    v_and_b32 v250, 15, v72
    v_lshl_add_u32 v249, v249, 2, s19
    v_lshl_add_u32 v250, v250, 2, s19
    v_mov_b32 v213, 0
    v_mov_b32 v214, 0
    v_mov_b32 v215, 0
    v_lshlrev_b32 v66, 1, v66
    ds_write_b16 v66, v213 offset:33280
    v_and_b32 v73, 1, v65
    v_lshrrev_b32 v72, 2, v64
    v_lshl_or_b32 v73, v73, 2, v72
    v_lshl_add_u32 v72, v65, 3, v72
    v_lshlrev_b32 v72, 8, v72
    v_lshl_add_u32 v72, v73, 5, v72
    v_and_b32 v73, 3, v64
    v_lshl_add_u32 v76, v73, 3, v72
    v_xor_b32 v77, 32, v76
    v_xor_b32 v78, 64, v76
    v_xor_b32 v79, 96, v76
    v_xor_b32 v80, 128, v76
    v_xor_b32 v81, 160, v76
    v_xor_b32 v82, 192, v76
    v_xor_b32 v83, 224, v76
    v_lshlrev_b32 v92, 6, v65
    s_mov_b32 s36, s4
    s_mov_b32 s37, s5
    s_mov_b32 s38, 425984
    s_mov_b32 s39, 0x00020000
    s_lshl_b32 s3, s3, 3
    v_lshl_add_u32 v252, v65, 1, s3
    v_and_b32 v73, 1, v64
    v_lshlrev_b32 v72, 4, v73
    v_mov_b32 v95, 0xffff
    v_lshlrev_b32 v95, v72, v95
    s_mov_b32 s20, 0x33333333
    s_mov_b32 s21, 0x33333333
    v_cndmask_b32 v94, 0, v95, s[20:21]
    v_sub_u32 v95, v95, v94
    v_and_b32 v72, 0x2f802f80, v94
    v_accvgpr_write_b32 a200, v72
    v_and_b32 v184, 0x1f801f80, v94
    v_and_b32 v72, 0x2f802f80, v95
    v_accvgpr_write_b32 a201, v72
    v_and_b32 v185, 0x1f801f80, v95
    v_accvgpr_write_b32 a204, 0
    v_accvgpr_write_b32 a205, 0
    v_mul_u32_u24 v233, 0xaaaa, v73
    v_add_u32 v233, 0x4444, v233
    v_xor_b32 v69, 32, v251
    v_add_u32 v69, 33280, v69
    v_lshl_add_u32 v67, v73, 7, v251
    v_add_u32 v68, 32768, v67
    v_add_u32 v67, 33024, v67
    v_cndmask_b32 v67, v69, v67, s[20:21]
    v_cndmask_b32 v68, v68, v69, s[20:21]
    s_mov_b32 s20, 0x000f000f
    s_mov_b32 s21, 0x000f000f
    v_cndmask_b32 v88, v69, v67, s[20:21]
    v_cndmask_b32 v84, v69, v68, s[20:21]
    s_mov_b32 s20, 0x00f000f0
    s_mov_b32 s21, 0x00f000f0
    v_cndmask_b32 v89, v69, v67, s[20:21]
    v_cndmask_b32 v85, v69, v68, s[20:21]
    s_mov_b32 s20, 0x0f000f00
    s_mov_b32 s21, 0x0f000f00
    v_cndmask_b32 v90, v69, v67, s[20:21]
    v_cndmask_b32 v86, v69, v68, s[20:21]
    s_mov_b32 s20, 0xf000f000
    s_mov_b32 s21, 0xf000f000
    v_cndmask_b32 v91, v69, v67, s[20:21]
    v_mov_b32 v234, 0xff800000
    v_mov_b32 v253, 0x5fb8aa3b
    v_mov_b32 v241, 0x5f800000
    s_mov_b32 s20, 0x00000410
    s_mov_b32 s21, 0x00000100
    v_cndmask_b32 v212, v213, v234, s[20:21]
    s_mul_i32 s27, s18, 2560
    s_add_u32 s27, s27, 33920
    v_mul_u32_u24 v72, 80, v64
    v_add_u32 v72, s27, v72
    v_add_u32 v242, v72, v251
    v_sub_u32 v73, v64, v65
    v_add_u32 v74, -1, v73
    v_and_b32 v74, 15, v74
    v_lshl_add_u32 v243, v74, 2, v72
    v_add_u32 v74, -5, v73
    v_and_b32 v74, 15, v74
    v_lshl_add_u32 v244, v74, 2, v72
    s_mov_b32 s20, 0x00000000
    s_mov_b32 s21, 0x00ff0000
    s_mov_b32 s28, 0x00000000
    s_mov_b32 s29, 0xff000000
    s_mov_b32 s30, 0x00010001
    s_mov_b32 s31, 0x00010001
    s_movk_i32 s22, 104
    s_mov_b32 s23, 0xb4000000
    s_waitcnt vmcnt(9)
    v_lshl_add_u32 v245, v245, 8, v251
    global_load_dwordx4 v[112:115], v245, s[6:7] offset:0 nt
    global_load_dwordx4 v[116:119], v245, s[6:7] offset:64 nt
    global_load_dwordx4 v[120:123], v245, s[6:7] offset:128 nt
    global_load_dwordx4 v[124:127], v245, s[6:7] offset:192 nt
    global_load_dword v246, v249, s[4:5] offset:64 nt
    global_load_dword v247, v250, s[4:5] offset:64 nt
    s_mov_b64 vcc, -1
    s_cmp_eq_u32 s18, 0
    s_cbranch_scc1 L_pad0
    s_cmp_eq_u32 s18, 1
    s_cbranch_scc1 L_pad1
    s_cmp_eq_u32 s18, 2
    s_cbranch_scc1 L_pad2
    s_branch L_pad3
L_resume:
    s_mov_b64 vcc, 0
    s_waitcnt vmcnt(6)
    s_waitcnt lgkmcnt(0)
    s_barrier
    ds_read_b128 v[16:19], v92 offset:33408
    ds_read_b128 v[20:23], v92 offset:33424
    ds_read_b128 v[24:27], v92 offset:33440
    ds_read_b128 v[28:31], v92 offset:33456
    ds_read_b128 v[128:131], v251 offset:33664
    ds_read_b128 v[132:135], v251 offset:33728
    ds_read_b128 v[136:139], v251 offset:33792
    ds_read_b128 v[140:143], v251 offset:33856
    ds_read_b64_tr_b16 a[0:1], v76 offset:0
    ds_read_b64_tr_b16 a[2:3], v76 offset:1024
    ds_read_b64_tr_b16 a[4:5], v76 offset:8192
    ds_read_b64_tr_b16 a[6:7], v76 offset:9216
    ds_read_b64_tr_b16 a[8:9], v76 offset:16384
    ds_read_b64_tr_b16 a[10:11], v76 offset:17408
    ds_read_b64_tr_b16 a[12:13], v76 offset:24576
    ds_read_b64_tr_b16 a[14:15], v76 offset:25600
    ds_read_b64_tr_b16 a[16:17], v77 offset:0
    ds_read_b64_tr_b16 a[18:19], v77 offset:1024
    ds_read_b64_tr_b16 a[20:21], v77 offset:8192
    ds_read_b64_tr_b16 a[22:23], v77 offset:9216
    ds_read_b64_tr_b16 a[24:25], v77 offset:16384
    ds_read_b64_tr_b16 a[26:27], v77 offset:17408
    ds_read_b64_tr_b16 a[28:29], v77 offset:24576
    s_waitcnt lgkmcnt(15)
    ds_read_b64_tr_b16 a[30:31], v77 offset:25600
    v_mfma_f32_4x4x4_16b_bf16 v[0:3], v[184:185], v[16:17], 0
    v_and_b32 v128, v94, v128
    ds_read_b64_tr_b16 a[32:33], v78 offset:0
    v_accvgpr_write_b32 a184, v128
    v_and_b32 v129, v95, v129
    ds_read_b64_tr_b16 a[34:35], v78 offset:1024
    v_accvgpr_write_b32 a185, v129
    v_mfma_f32_4x4x4_16b_bf16 v[4:7], v[184:185], v[18:19], 0
    ds_read_b64_tr_b16 a[36:37], v78 offset:8192
    v_and_b32 v130, v94, v130
    v_accvgpr_write_b32 a186, v130
    ds_read_b64_tr_b16 a[38:39], v78 offset:9216
    v_and_b32 v131, v95, v131
    v_accvgpr_write_b32 a187, v131
    ds_read_b64_tr_b16 a[40:41], v78 offset:16384
    v_mfma_f32_4x4x4_16b_bf16 v[8:11], v[184:185], v[20:21], 0
    v_and_b32 v132, v94, v132
    ds_read_b64_tr_b16 a[42:43], v78 offset:17408
    v_accvgpr_write_b32 a188, v132
    v_and_b32 v133, v95, v133
    ds_read_b64_tr_b16 a[44:45], v78 offset:24576
    v_accvgpr_write_b32 a189, v133
    v_mfma_f32_4x4x4_16b_bf16 v[12:15], v[184:185], v[22:23], 0
    ds_read_b64_tr_b16 a[46:47], v78 offset:25600
    v_and_b32 v134, v94, v134
    v_accvgpr_write_b32 a190, v134
    ds_read_b64_tr_b16 a[48:49], v79 offset:0
    v_and_b32 v135, v95, v135
    v_accvgpr_write_b32 a191, v135
    ds_read_b64_tr_b16 a[50:51], v79 offset:1024
    v_mfma_f32_4x4x4_16b_bf16 v[16:19], v[184:185], v[24:25], 0
    v_and_b32 v136, v94, v136
    ds_read_b64_tr_b16 a[52:53], v79 offset:8192
    v_accvgpr_write_b32 a192, v136
    v_and_b32 v137, v95, v137
    ds_read_b64_tr_b16 a[54:55], v79 offset:9216
    v_accvgpr_write_b32 a193, v137
    v_mfma_f32_4x4x4_16b_bf16 v[20:23], v[184:185], v[26:27], 0
    ds_read_b64_tr_b16 a[56:57], v79 offset:16384
    v_and_b32 v138, v94, v138
    v_accvgpr_write_b32 a194, v138
    ds_read_b64_tr_b16 a[58:59], v79 offset:17408
    v_and_b32 v139, v95, v139
    v_accvgpr_write_b32 a195, v139
    ds_read_b64_tr_b16 a[60:61], v79 offset:24576
    v_mfma_f32_4x4x4_16b_bf16 v[24:27], v[184:185], v[28:29], 0
    v_and_b32 v140, v94, v140
    ds_read_b64_tr_b16 a[62:63], v79 offset:25600
    v_accvgpr_write_b32 a196, v140
    v_and_b32 v141, v95, v141
    ds_read_b64_tr_b16 a[64:65], v80 offset:0
    v_accvgpr_write_b32 a197, v141
    v_mfma_f32_4x4x4_16b_bf16 v[28:31], v[184:185], v[30:31], 0
    ds_read_b64_tr_b16 a[66:67], v80 offset:1024
    v_and_b32 v142, v94, v142
    v_accvgpr_write_b32 a198, v142
    ds_read_b64_tr_b16 a[68:69], v80 offset:8192
    v_and_b32 v143, v95, v143
    v_accvgpr_write_b32 a199, v143
    ds_read_b64_tr_b16 a[70:71], v80 offset:9216
    ds_read_b64_tr_b16 a[72:73], v80 offset:16384
    ds_read_b64_tr_b16 a[74:75], v80 offset:17408
    ds_read_b64_tr_b16 a[76:77], v80 offset:24576
    ds_read_b64_tr_b16 a[78:79], v80 offset:25600
    ds_read_b64_tr_b16 a[80:81], v81 offset:0
    ds_read_b64_tr_b16 a[82:83], v81 offset:1024
    ds_read_b64_tr_b16 a[84:85], v81 offset:8192
    ds_read_b64_tr_b16 a[86:87], v81 offset:9216
    ds_read_b64_tr_b16 a[88:89], v81 offset:16384
    ds_read_b64_tr_b16 a[90:91], v81 offset:17408
    ds_read_b64_tr_b16 a[92:93], v81 offset:24576
    ds_read_b64_tr_b16 a[94:95], v81 offset:25600
    ds_read_b64_tr_b16 a[96:97], v82 offset:0
    ds_read_b64_tr_b16 a[98:99], v82 offset:1024
    ds_read_b64_tr_b16 a[100:101], v82 offset:8192
    ds_read_b64_tr_b16 a[102:103], v82 offset:9216
    ds_read_b64_tr_b16 a[104:105], v82 offset:16384
    ds_read_b64_tr_b16 a[106:107], v82 offset:17408
    ds_read_b64_tr_b16 a[108:109], v82 offset:24576
    ds_read_b64_tr_b16 a[110:111], v82 offset:25600
    ds_read_b64_tr_b16 a[112:113], v83 offset:0
    ds_read_b64_tr_b16 a[114:115], v83 offset:1024
    ds_read_b64_tr_b16 a[116:117], v83 offset:8192
    ds_read_b64_tr_b16 a[118:119], v83 offset:9216
    ds_read_b64_tr_b16 a[120:121], v83 offset:16384
    ds_read_b64_tr_b16 a[122:123], v83 offset:17408
    ds_read_b64_tr_b16 a[124:125], v83 offset:24576
    ds_read_b64_tr_b16 a[126:127], v83 offset:25600
    ds_read_b128 a[128:131], v88 offset:0
    ds_read_b128 a[160:163], v84 offset:0
    ds_read_b128 a[132:135], v88 offset:64
    ds_read_b128 a[164:167], v84 offset:64
    ds_read_b128 a[136:139], v89 offset:0
    ds_read_b128 a[168:171], v85 offset:0
    ds_read_b128 a[140:143], v89 offset:64
    ds_read_b128 a[172:175], v85 offset:64
    ds_read_b128 a[144:147], v90 offset:0
    ds_read_b128 a[176:179], v86 offset:0
    ds_read_b128 a[148:151], v90 offset:64
    ds_read_b128 a[180:183], v86 offset:64
    ds_read_b128 a[152:155], v91 offset:0
    ds_read_b128 a[156:159], v91 offset:64
    s_branch L_al
.p2align 12
L_al:
L_pad0:
    s_cbranch_vccnz L_pad4
    s_waitcnt vmcnt(5)
    v_mfma_f32_4x4x4_16b_bf16 v[32:35], a[200:201], v[112:113], 0
    v_mfma_f32_4x4x4_16b_bf16 v[36:39], a[200:201], v[114:115], 0
    s_waitcnt vmcnt(4)
    v_mfma_f32_4x4x4_16b_bf16 v[40:43], a[200:201], v[116:117], 0
    v_mfma_f32_4x4x4_16b_bf16 v[44:47], a[200:201], v[118:119], 0
    s_waitcnt vmcnt(3)
    v_mfma_f32_4x4x4_16b_bf16 v[48:51], a[200:201], v[120:121], 0
    v_mul_f32_dpp v160, v32, v32 row_ror:1 row_mask:0xf bank_mask:0xf
    v_mul_f32_dpp v161, v33, v33 row_ror:1 row_mask:0xf bank_mask:0xf
    v_mfma_f32_4x4x4_16b_bf16 v[52:55], a[200:201], v[122:123], 0
    v_cvt_pk_bf16_f32 v96, v160, v161
    s_waitcnt vmcnt(2)
    v_mfma_f32_4x4x4_16b_bf16 v[56:59], a[200:201], v[124:125], 0
    v_mul_f32_dpp v162, v34, v34 row_ror:1 row_mask:0xf bank_mask:0xf
    v_mfma_f32_4x4x4_16b_bf16 v[60:63], a[200:201], v[126:127], 0
    v_mul_f32_dpp v163, v35, v35 row_ror:1 row_mask:0xf bank_mask:0xf
    v_cvt_pk_bf16_f32 v97, v162, v163
    v_mul_f32_dpp v164, v36, v36 row_ror:1 row_mask:0xf bank_mask:0xf
    v_mul_f32_dpp v165, v37, v37 row_ror:1 row_mask:0xf bank_mask:0xf
    v_cvt_pk_bf16_f32 v98, v164, v165
    s_waitcnt vmcnt(0)
    v_lshl_add_u32 v246, v246, 8, v251
    v_lshl_add_u32 v247, v247, 8, v251
    v_mul_f32_dpp v166, v38, v38 row_ror:1 row_mask:0xf bank_mask:0xf
    v_mul_f32_dpp v167, v39, v39 row_ror:1 row_mask:0xf bank_mask:0xf
    v_cvt_pk_bf16_f32 v99, v166, v167
    v_mul_f32_dpp v160, v40, v40 row_ror:1 row_mask:0xf bank_mask:0xf
    v_mul_f32_dpp v161, v41, v41 row_ror:1 row_mask:0xf bank_mask:0xf
    v_cvt_pk_bf16_f32 v100, v160, v161
    v_mul_f32_dpp v162, v42, v42 row_ror:1 row_mask:0xf bank_mask:0xf
    v_mul_f32_dpp v163, v43, v43 row_ror:1 row_mask:0xf bank_mask:0xf
    global_load_dwordx4 v[80:83], v246, s[6:7] offset:0 nt
    v_cvt_pk_bf16_f32 v101, v162, v163
    v_mul_f32_dpp v164, v44, v44 row_ror:1 row_mask:0xf bank_mask:0xf
    v_mul_f32_dpp v165, v45, v45 row_ror:1 row_mask:0xf bank_mask:0xf
    v_cvt_pk_bf16_f32 v102, v164, v165
    v_mul_f32_dpp v166, v46, v46 row_ror:1 row_mask:0xf bank_mask:0xf
    v_mul_f32_dpp v167, v47, v47 row_ror:1 row_mask:0xf bank_mask:0xf
    v_cvt_pk_bf16_f32 v103, v166, v167
    global_load_dwordx4 v[84:87], v246, s[6:7] offset:64 nt
    v_mul_f32_dpp v160, v48, v48 row_ror:1 row_mask:0xf bank_mask:0xf
    v_mul_f32_dpp v161, v49, v49 row_ror:1 row_mask:0xf bank_mask:0xf
    v_cvt_pk_bf16_f32 v104, v160, v161
    v_mul_f32_dpp v162, v50, v50 row_ror:1 row_mask:0xf bank_mask:0xf
    v_mul_f32_dpp v163, v51, v51 row_ror:1 row_mask:0xf bank_mask:0xf
    global_load_dwordx4 v[88:91], v246, s[6:7] offset:128 nt
    v_cvt_pk_bf16_f32 v105, v162, v163
    v_mul_f32_dpp v164, v52, v52 row_ror:1 row_mask:0xf bank_mask:0xf
    v_mul_f32_dpp v165, v53, v53 row_ror:1 row_mask:0xf bank_mask:0xf
    v_cvt_pk_bf16_f32 v106, v164, v165
    v_mul_f32_dpp v166, v54, v54 row_ror:1 row_mask:0xf bank_mask:0xf
    v_mul_f32_dpp v167, v55, v55 row_ror:1 row_mask:0xf bank_mask:0xf
    v_cvt_pk_bf16_f32 v107, v166, v167
    v_mul_f32_dpp v160, v56, v56 row_ror:1 row_mask:0xf bank_mask:0xf
    global_load_dwordx4 v[92:95], v246, s[6:7] offset:192 nt
    v_mul_f32_dpp v161, v57, v57 row_ror:1 row_mask:0xf bank_mask:0xf
    v_cvt_pk_bf16_f32 v108, v160, v161
    v_mul_f32_dpp v162, v58, v58 row_ror:1 row_mask:0xf bank_mask:0xf
    v_mul_f32_dpp v163, v59, v59 row_ror:1 row_mask:0xf bank_mask:0xf
    v_cvt_pk_bf16_f32 v109, v162, v163
    v_mul_f32_dpp v164, v60, v60 row_ror:1 row_mask:0xf bank_mask:0xf
    v_mul_f32_dpp v165, v61, v61 row_ror:1 row_mask:0xf bank_mask:0xf
    v_cvt_pk_bf16_f32 v110, v164, v165
    v_mul_f32_dpp v166, v62, v62 row_ror:1 row_mask:0xf bank_mask:0xf
    v_mul_f32_dpp v167, v63, v63 row_ror:1 row_mask:0xf bank_mask:0xf
    v_cvt_pk_bf16_f32 v111, v166, v167
    v_mul_f32_dpp v160, v32, v32 row_ror:2 row_mask:0xf bank_mask:0xf
    v_mul_f32_dpp v161, v33, v33 row_ror:2 row_mask:0xf bank_mask:0xf
    v_cvt_pk_bf16_f32 v144, v160, v161
    v_mul_f32_dpp v162, v34, v34 row_ror:2 row_mask:0xf bank_mask:0xf
    v_mul_f32_dpp v163, v35, v35 row_ror:2 row_mask:0xf bank_mask:0xf
    v_cvt_pk_bf16_f32 v145, v162, v163
    v_mul_f32_dpp v164, v36, v36 row_ror:2 row_mask:0xf bank_mask:0xf
    v_mul_f32_dpp v165, v37, v37 row_ror:2 row_mask:0xf bank_mask:0xf
    v_mul_f32_dpp v166, v38, v38 row_ror:2 row_mask:0xf bank_mask:0xf
    s_waitcnt lgkmcnt(0)
L_loop:
    v_mfma_f32_16x16x32_bf16 v[168:171], a[0:3], v[96:99], v[0:3]
    v_cvt_pk_bf16_f32 v146, v164, v165
    v_mul_f32_dpp v167, v39, v39 row_ror:2 row_mask:0xf bank_mask:0xf
    v_mfma_f32_16x16x32_bf16 v[168:171], a[4:7], v[100:103], v[168:171]
    v_cvt_pk_bf16_f32 v147, v166, v167
    v_mul_f32_dpp v160, v40, v40 row_ror:2 row_mask:0xf bank_mask:0xf
    v_mfma_f32_16x16x32_bf16 v[168:171], a[8:11], v[104:107], v[168:171]
    v_cvt_pk_bf16_f32 v198, v180, v181 clamp
    v_cvt_pk_bf16_f32 v199, v182, v183 clamp
    v_mfma_f32_16x16x32_bf16 v[168:171], a[12:15], v[108:111], v[168:171]
    v_mul_f32_dpp v161, v41, v41 row_ror:2 row_mask:0xf bank_mask:0xf
    v_cvt_pk_bf16_f32 v148, v160, v161
    v_mfma_f32_16x16x32_bf16 v[172:175], a[28:31], v[108:111], v[4:7]
    v_mul_f32_dpp v162, v42, v42 row_ror:2 row_mask:0xf bank_mask:0xf
    v_mul_f32_dpp v163, v43, v43 row_ror:2 row_mask:0xf bank_mask:0xf
    v_mfma_f32_16x16x32_bf16 v[172:175], a[24:27], v[104:107], v[172:175]
    v_cvt_pk_bf16_f32 v149, v162, v163
    v_mov_b32 v200, 0
    v_mfma_f32_16x16x32_bf16 v[172:175], a[20:23], v[100:103], v[172:175]
    v_cvt_pk_bf16_f32 v184, v168, v169 clamp
    v_cvt_pk_bf16_f32 v185, v170, v171 clamp
    v_mfma_f32_16x16x32_bf16 v[172:175], a[16:19], v[96:99], v[172:175]
    v_mul_f32_dpp v164, v44, v44 row_ror:2 row_mask:0xf bank_mask:0xf
    v_mul_f32_dpp v165, v45, v45 row_ror:2 row_mask:0xf bank_mask:0xf
    v_mfma_f32_16x16x32_bf16 v[176:179], a[32:35], v[96:99], v[8:11]
    v_cvt_pk_bf16_f32 v150, v164, v165
    v_mov_b32 v201, 0
    v_mfma_f32_16x16x32_bf16 v[176:179], a[36:39], v[100:103], v[176:179]
    v_mul_f32_dpp v166, v46, v46 row_ror:2 row_mask:0xf bank_mask:0xf
    v_mul_f32_dpp v167, v47, v47 row_ror:2 row_mask:0xf bank_mask:0xf
    v_mfma_f32_16x16x32_bf16 v[176:179], a[40:43], v[104:107], v[176:179]
    v_cvt_pk_bf16_f32 v186, v172, v173 clamp
    v_cvt_pk_bf16_f32 v187, v174, v175 clamp
    v_mfma_f32_16x16x32_bf16 v[176:179], a[44:47], v[108:111], v[176:179]
    v_cvt_pk_bf16_f32 v151, v166, v167
    v_mul_f32_dpp v160, v48, v48 row_ror:2 row_mask:0xf bank_mask:0xf
    v_mfma_f32_4x4x4_16b_bf16 v[64:67], a[184:185], v[112:113], 0
    v_mul_f32_dpp v161, v49, v49 row_ror:2 row_mask:0xf bank_mask:0xf
    v_mfma_f32_4x4x4_16b_bf16 v[68:71], a[186:187], v[114:115], 0
    v_cvt_pk_bf16_f32 v152, v160, v161
    v_mfma_f32_4x4x4_16b_bf16 v[72:75], a[188:189], v[116:117], 0
    v_mul_f32_dpp v162, v50, v50 row_ror:2 row_mask:0xf bank_mask:0xf
    v_mfma_f32_4x4x4_16b_bf16 v[76:79], a[190:191], v[118:119], 0
    v_cvt_pk_bf16_f32 v188, v176, v177 clamp
    v_cvt_pk_bf16_f32 v189, v178, v179 clamp
    v_cvt_pk_bf16_f32 v64, v64, v65
    v_mfma_f32_16x16x32_bf16 v[180:183], a[60:63], v[108:111], v[12:15]
    v_cvt_pk_bf16_f32 v65, v66, v67
    v_cvt_pk_bf16_f32 v66, v68, v69
    v_mfma_f32_16x16x32_bf16 v[180:183], a[56:59], v[104:107], v[180:183]
    v_cvt_pk_bf16_f32 v67, v70, v71
    v_cvt_pk_bf16_f32 v68, v72, v73
    v_mfma_f32_16x16x32_bf16 v[180:183], a[52:55], v[100:103], v[180:183]
    v_cvt_pk_bf16_f32 v69, v74, v75
    v_cvt_pk_bf16_f32 v70, v76, v77
    v_mfma_f32_16x16x32_bf16 v[180:183], a[48:51], v[96:99], v[180:183]
    v_cvt_pk_bf16_f32 v71, v78, v79
    v_mul_f32_dpp v163, v51, v51 row_ror:2 row_mask:0xf bank_mask:0xf
    v_mfma_f32_16x16x32_bf16 v[168:171], a[64:67], v[96:99], v[16:19]
    v_cvt_pk_bf16_f32 v153, v162, v163
    v_mul_f32_dpp v164, v52, v52 row_ror:2 row_mask:0xf bank_mask:0xf
    v_mfma_f32_16x16x32_bf16 v[168:171], a[68:71], v[100:103], v[168:171]
    v_mul_f32_dpp v165, v53, v53 row_ror:2 row_mask:0xf bank_mask:0xf
    v_cvt_pk_bf16_f32 v154, v164, v165
    v_mfma_f32_16x16x32_bf16 v[168:171], a[72:75], v[104:107], v[168:171]
    v_cvt_pk_bf16_f32 v190, v180, v181 clamp
    v_cvt_pk_bf16_f32 v191, v182, v183 clamp
    v_mfma_f32_16x16x32_bf16 v[168:171], a[76:79], v[108:111], v[168:171]
    v_mul_f32_dpp v166, v54, v54 row_ror:2 row_mask:0xf bank_mask:0xf
    v_mul_f32_dpp v167, v55, v55 row_ror:2 row_mask:0xf bank_mask:0xf
    v_mfma_f32_16x16x32_bf16 v[172:175], a[92:95], v[108:111], v[20:23]
    v_cvt_pk_bf16_f32 v155, v166, v167
    v_mul_f32_dpp v160, v56, v56 row_ror:2 row_mask:0xf bank_mask:0xf
    v_mfma_f32_16x16x32_bf16 v[172:175], a[88:91], v[104:107], v[172:175]
    v_mul_f32_dpp v161, v57, v57 row_ror:2 row_mask:0xf bank_mask:0xf
    v_cvt_pk_bf16_f32 v156, v160, v161
    v_mfma_f32_16x16x32_bf16 v[172:175], a[84:87], v[100:103], v[172:175]
    v_mul_f32_dpp v162, v58, v58 row_ror:2 row_mask:0xf bank_mask:0xf
    v_mul_f32_dpp v163, v59, v59 row_ror:2 row_mask:0xf bank_mask:0xf
    v_mfma_f32_16x16x32_bf16 v[172:175], a[80:83], v[96:99], v[172:175]
    v_cvt_pk_bf16_f32 v157, v162, v163
    v_mul_f32_dpp v164, v60, v60 row_ror:2 row_mask:0xf bank_mask:0xf
    v_smfmac_f32_16x16x64_bf16 v[204:207], a[156:159], v[192:199], v233
    v_cvt_pk_bf16_f32 v192, v168, v169 clamp
    v_smfmac_f32_16x16x64_bf16 v[200:203], a[128:131], v[184:191], v233
    v_cvt_pk_bf16_f32 v193, v170, v171 clamp
    v_mfma_f32_16x16x32_bf16 v[176:179], a[96:99], v[96:99], v[24:27]
    v_mul_f32_dpp v165, v61, v61 row_ror:2 row_mask:0xf bank_mask:0xf
    v_cvt_pk_bf16_f32 v194, v172, v173 clamp
    v_mfma_f32_16x16x32_bf16 v[176:179], a[100:103], v[100:103], v[176:179]
    v_cvt_pk_bf16_f32 v195, v174, v175 clamp
    v_add_f32 v230, v204, v205
    v_mfma_f32_16x16x32_bf16 v[176:179], a[104:107], v[104:107], v[176:179]
    v_cvt_pk_bf16_f32 v158, v164, v165
    v_mul_f32_dpp v166, v62, v62 row_ror:2 row_mask:0xf bank_mask:0xf
    v_mfma_f32_16x16x32_bf16 v[176:179], a[108:111], v[108:111], v[176:179]
    v_mul_f32_dpp v167, v63, v63 row_ror:2 row_mask:0xf bank_mask:0xf
    v_cvt_pk_bf16_f32 v159, v166, v167
    v_mfma_f32_4x4x4_16b_bf16 v[72:75], a[192:193], v[120:121], 0
    v_mul_f32_dpp v160, v32, v32 row_ror:3 row_mask:0xf bank_mask:0xf
    v_mfma_f32_4x4x4_16b_bf16 v[76:79], a[194:195], v[122:123], 0
    v_mul_f32_dpp v161, v33, v33 row_ror:3 row_mask:0xf bank_mask:0xf
    v_mfma_f32_4x4x4_16b_bf16 v[216:219], a[196:197], v[124:125], 0
    v_cvt_pk_bf16_f32 v128, v160, v161
    v_mfma_f32_4x4x4_16b_bf16 v[204:207], a[198:199], v[126:127], 0
    v_cvt_pk_bf16_f32 v196, v176, v177 clamp
    v_cvt_pk_bf16_f32 v197, v178, v179 clamp
    v_cvt_pk_bf16_f32 v72, v72, v73
    v_mfma_f32_16x16x32_bf16 v[180:183], a[124:127], v[108:111], v[28:31]
    v_cvt_pk_bf16_f32 v73, v74, v75
    v_cvt_pk_bf16_f32 v74, v76, v77
    v_mfma_f32_16x16x32_bf16 v[180:183], a[120:123], v[104:107], v[180:183]
    v_cvt_pk_bf16_f32 v75, v78, v79
    v_cvt_pk_bf16_f32 v76, v216, v217
    v_mfma_f32_16x16x32_bf16 v[180:183], a[116:119], v[100:103], v[180:183]
    v_cvt_pk_bf16_f32 v77, v218, v219
    v_cvt_pk_bf16_f32 v78, v204, v205
    v_mfma_f32_16x16x32_bf16 v[180:183], a[112:115], v[96:99], v[180:183]
    v_cvt_pk_bf16_f32 v79, v206, v207
    v_mul_f32_dpp v162, v34, v34 row_ror:3 row_mask:0xf bank_mask:0xf
    v_mfma_f32_16x16x32_bf16 v[168:171], a[0:3], v[144:147], v[0:3]
    v_mul_f32_dpp v163, v35, v35 row_ror:3 row_mask:0xf bank_mask:0xf
    v_cvt_pk_bf16_f32 v129, v162, v163
    v_mfma_f32_16x16x32_bf16 v[168:171], a[4:7], v[148:151], v[168:171]
    v_mul_f32_dpp v164, v36, v36 row_ror:3 row_mask:0xf bank_mask:0xf
    v_max3_f32 v235, v226, v232, v227
    v_mfma_f32_16x16x32_bf16 v[168:171], a[8:11], v[152:155], v[168:171]
    v_cvt_pk_bf16_f32 v198, v180, v181 clamp
    v_cvt_pk_bf16_f32 v199, v182, v183 clamp
    v_mfma_f32_16x16x32_bf16 v[168:171], a[12:15], v[156:159], v[168:171]
    v_mul_f32_dpp v165, v37, v37 row_ror:3 row_mask:0xf bank_mask:0xf
    v_cvt_pk_bf16_f32 v130, v164, v165
    v_mfma_f32_16x16x32_bf16 v[172:175], a[28:31], v[156:159], v[4:7]
    v_mul_f32_dpp v166, v38, v38 row_ror:3 row_mask:0xf bank_mask:0xf
    v_mul_f32_dpp v167, v39, v39 row_ror:3 row_mask:0xf bank_mask:0xf
    v_mfma_f32_16x16x32_bf16 v[172:175], a[24:27], v[152:155], v[172:175]
    v_cvt_pk_bf16_f32 v131, v166, v167
    v_mul_f32_dpp v160, v40, v40 row_ror:3 row_mask:0xf bank_mask:0xf
    v_mfma_f32_16x16x32_bf16 v[172:175], a[20:23], v[148:151], v[172:175]
    v_cvt_pk_bf16_f32 v184, v168, v169 clamp
    v_cvt_pk_bf16_f32 v185, v170, v171 clamp
    v_mfma_f32_16x16x32_bf16 v[172:175], a[16:19], v[144:147], v[172:175]
    v_mul_f32_dpp v161, v41, v41 row_ror:3 row_mask:0xf bank_mask:0xf
    v_cvt_pk_bf16_f32 v132, v160, v161
    v_mfma_f32_16x16x32_bf16 v[176:179], a[32:35], v[144:147], v[8:11]
    v_max3_f32 v235, v235, v228, v229
    v_mul_f32_dpp v162, v42, v42 row_ror:3 row_mask:0xf bank_mask:0xf
    v_mfma_f32_16x16x32_bf16 v[176:179], a[36:39], v[148:151], v[176:179]
    v_mul_f32_dpp v163, v43, v43 row_ror:3 row_mask:0xf bank_mask:0xf
    v_cvt_pk_bf16_f32 v133, v162, v163
    v_mfma_f32_16x16x32_bf16 v[176:179], a[40:43], v[152:155], v[176:179]
    v_cvt_pk_bf16_f32 v186, v172, v173 clamp
    v_cvt_pk_bf16_f32 v187, v174, v175 clamp
    v_mfma_f32_16x16x32_bf16 v[176:179], a[44:47], v[156:159], v[176:179]
    v_mul_f32_dpp v164, v44, v44 row_ror:3 row_mask:0xf bank_mask:0xf
    v_mul_f32_dpp v165, v45, v45 row_ror:3 row_mask:0xf bank_mask:0xf
    v_mfma_f32_16x16x32_bf16 v[180:183], a[60:63], v[156:159], v[12:15]
    v_cvt_pk_bf16_f32 v134, v164, v165
    v_mul_f32_dpp v166, v46, v46 row_ror:3 row_mask:0xf bank_mask:0xf
    v_mfma_f32_16x16x32_bf16 v[180:183], a[56:59], v[152:155], v[180:183]
    v_max_f32 v235, v235, v230
    v_mul_f32_dpp v167, v47, v47 row_ror:3 row_mask:0xf bank_mask:0xf
    v_mfma_f32_16x16x32_bf16 v[180:183], a[52:55], v[148:151], v[180:183]
    v_cvt_pk_bf16_f32 v188, v176, v177 clamp
    v_cvt_pk_bf16_f32 v189, v178, v179 clamp
    v_mfma_f32_16x16x32_bf16 v[180:183], a[48:51], v[144:147], v[180:183]
    v_cvt_pk_bf16_f32 v135, v166, v167
    v_mul_f32_dpp v160, v48, v48 row_ror:3 row_mask:0xf bank_mask:0xf
    v_mfma_f32_16x16x32_bf16 v[204:207], v[112:115], v[64:67], 0
    v_mul_f32_dpp v161, v49, v49 row_ror:3 row_mask:0xf bank_mask:0xf
    v_cvt_pk_bf16_f32 v136, v160, v161
    v_mfma_f32_16x16x32_bf16 v[204:207], v[116:119], v[68:71], v[204:207]
    v_mul_f32_dpp v162, v50, v50 row_ror:3 row_mask:0xf bank_mask:0xf
    v_mul_f32_dpp v163, v51, v51 row_ror:3 row_mask:0xf bank_mask:0xf
    v_mfma_f32_16x16x32_bf16 v[204:207], v[120:123], v[72:75], v[204:207]
    v_cvt_pk_bf16_f32 v190, v180, v181 clamp
    v_cvt_pk_bf16_f32 v191, v182, v183 clamp
    v_mfma_f32_16x16x32_bf16 v[204:207], v[124:127], v[76:79], v[204:207]
    v_cvt_pk_bf16_f32 v137, v162, v163
    v_max_f32_dpp v235, v235, v235 row_ror:8 row_mask:0xf bank_mask:0xf
    v_mfma_f32_16x16x32_bf16 v[168:171], a[64:67], v[144:147], v[16:19]
    global_load_dwordx4 v[112:115], v247, s[6:7] offset:0
    v_mfma_f32_16x16x32_bf16 v[168:171], a[68:71], v[148:151], v[168:171]
    v_mul_f32_dpp v164, v52, v52 row_ror:3 row_mask:0xf bank_mask:0xf
    v_mul_f32_dpp v165, v53, v53 row_ror:3 row_mask:0xf bank_mask:0xf
    v_mfma_f32_16x16x32_bf16 v[168:171], a[72:75], v[152:155], v[168:171]
    ds_write_b128 v242, v[204:207] offset:0
    v_mfma_f32_16x16x32_bf16 v[168:171], a[76:79], v[156:159], v[168:171]
    v_cvt_pk_bf16_f32 v138, v164, v165
    v_mul_f32_dpp v166, v54, v54 row_ror:3 row_mask:0xf bank_mask:0xf
    v_mfma_f32_16x16x32_bf16 v[172:175], a[92:95], v[156:159], v[20:23]
    v_mul_f32_dpp v167, v55, v55 row_ror:3 row_mask:0xf bank_mask:0xf
    v_cvt_pk_bf16_f32 v139, v166, v167
    v_mfma_f32_16x16x32_bf16 v[172:175], a[88:91], v[152:155], v[172:175]
    v_mul_f32_dpp v160, v56, v56 row_ror:3 row_mask:0xf bank_mask:0xf
    v_max_f32_dpp v235, v235, v235 row_ror:4 row_mask:0xf bank_mask:0xf
    v_mfma_f32_16x16x32_bf16 v[172:175], a[84:87], v[148:151], v[172:175]
    v_mul_f32_dpp v161, v57, v57 row_ror:3 row_mask:0xf bank_mask:0xf
    v_cvt_pk_bf16_f32 v140, v160, v161
    v_mfma_f32_16x16x32_bf16 v[172:175], a[80:83], v[144:147], v[172:175]
    v_mul_f32_dpp v162, v58, v58 row_ror:3 row_mask:0xf bank_mask:0xf
    v_mul_f32_dpp v163, v59, v59 row_ror:3 row_mask:0xf bank_mask:0xf
    v_smfmac_f32_16x16x64_bf16 v[200:203], a[132:135], v[192:199], v233
    v_cvt_pk_bf16_f32 v192, v168, v169 clamp
    v_smfmac_f32_16x16x64_bf16 v[200:203], a[136:139], v[184:191], v233
    v_cvt_pk_bf16_f32 v193, v170, v171 clamp
    v_mfma_f32_16x16x32_bf16 v[176:179], a[96:99], v[144:147], v[24:27]
    global_load_dwordx4 v[116:119], v247, s[6:7] offset:64
    v_mfma_f32_16x16x32_bf16 v[176:179], a[100:103], v[148:151], v[176:179]
    v_cvt_pk_bf16_f32 v194, v172, v173 clamp
    v_cvt_pk_bf16_f32 v141, v162, v163
    v_mfma_f32_16x16x32_bf16 v[176:179], a[104:107], v[152:155], v[176:179]
    v_cvt_pk_bf16_f32 v195, v174, v175 clamp
    v_mul_f32_dpp v164, v60, v60 row_ror:3 row_mask:0xf bank_mask:0xf
    v_mfma_f32_16x16x32_bf16 v[176:179], a[108:111], v[156:159], v[176:179]
    v_mul_f32_dpp v165, v61, v61 row_ror:3 row_mask:0xf bank_mask:0xf
    v_cvt_pk_bf16_f32 v142, v164, v165
    v_mfma_f32_16x16x32_bf16 v[180:183], a[124:127], v[156:159], v[28:31]
    v_max_f32_dpp v235, v235, v235 row_ror:2 row_mask:0xf bank_mask:0xf
    v_mul_f32_dpp v166, v62, v62 row_ror:3 row_mask:0xf bank_mask:0xf
    v_mfma_f32_16x16x32_bf16 v[180:183], a[120:123], v[152:155], v[180:183]
    v_mul_f32_dpp v167, v63, v63 row_ror:3 row_mask:0xf bank_mask:0xf
    v_cvt_pk_bf16_f32 v143, v166, v167
    v_mfma_f32_16x16x32_bf16 v[180:183], a[116:119], v[148:151], v[180:183]
    v_cvt_pk_bf16_f32 v196, v176, v177 clamp
    v_cvt_pk_bf16_f32 v197, v178, v179 clamp
    v_mfma_f32_16x16x32_bf16 v[180:183], a[112:115], v[144:147], v[180:183]
    v_mul_f32_dpp v160, v32, v32 row_ror:4 row_mask:0xf bank_mask:0xf
    v_max_f32_dpp v235, v235, v235 row_ror:1 row_mask:0xf bank_mask:0xf
    v_mfma_f32_16x16x32_bf16 v[168:171], a[0:3], v[128:131], v[0:3]
    v_mul_f32_dpp v161, v33, v33 row_ror:4 row_mask:0xf bank_mask:0xf
    v_cvt_pk_bf16_f32 v144, v160, v161
    v_mfma_f32_16x16x32_bf16 v[168:171], a[4:7], v[132:135], v[168:171]
    global_load_dwordx4 v[120:123], v247, s[6:7] offset:128
    v_mfma_f32_16x16x32_bf16 v[168:171], a[8:11], v[136:139], v[168:171]
    v_cvt_pk_bf16_f32 v198, v180, v181 clamp
    v_mul_f32_dpp v162, v34, v34 row_ror:4 row_mask:0xf bank_mask:0xf
    v_mfma_f32_16x16x32_bf16 v[168:171], a[12:15], v[140:143], v[168:171]
    v_mul_f32_dpp v163, v35, v35 row_ror:4 row_mask:0xf bank_mask:0xf
    v_cvt_pk_bf16_f32 v199, v182, v183 clamp
    v_mfma_f32_16x16x32_bf16 v[172:175], a[28:31], v[140:143], v[4:7]
    v_cvt_pk_bf16_f32 v145, v162, v163
    v_mul_f32_dpp v164, v36, v36 row_ror:4 row_mask:0xf bank_mask:0xf
    v_mfma_f32_16x16x32_bf16 v[172:175], a[24:27], v[136:139], v[172:175]
    ds_read_b32 v224, v243 offset:1280
    v_mfma_f32_16x16x32_bf16 v[172:175], a[20:23], v[132:135], v[172:175]
    v_mul_f32_dpp v165, v37, v37 row_ror:4 row_mask:0xf bank_mask:0xf
    v_cvt_pk_bf16_f32 v146, v164, v165
    v_mfma_f32_16x16x32_bf16 v[172:175], a[16:19], v[128:131], v[172:175]
    v_max_f32_dpp v235, v235, v235 row_bcast:15 row_mask:0xa bank_mask:0xf
    v_cvt_pk_bf16_f32 v184, v168, v169 clamp
    v_mfma_f32_16x16x32_bf16 v[176:179], a[32:35], v[128:131], v[8:11]
    v_mul_f32_dpp v166, v38, v38 row_ror:4 row_mask:0xf bank_mask:0xf
    v_mul_f32_dpp v167, v39, v39 row_ror:4 row_mask:0xf bank_mask:0xf
    v_mfma_f32_16x16x32_bf16 v[176:179], a[36:39], v[132:135], v[176:179]
    v_cvt_pk_bf16_f32 v185, v170, v171 clamp
    v_cvt_pk_bf16_f32 v147, v166, v167
    v_mfma_f32_16x16x32_bf16 v[176:179], a[40:43], v[136:139], v[176:179]
    ds_read_b32 v225, v244 offset:1280
    v_mfma_f32_16x16x32_bf16 v[176:179], a[44:47], v[140:143], v[176:179]
    v_mul_f32_dpp v160, v40, v40 row_ror:4 row_mask:0xf bank_mask:0xf
    v_mul_f32_dpp v161, v41, v41 row_ror:4 row_mask:0xf bank_mask:0xf
    v_mfma_f32_16x16x32_bf16 v[180:183], a[60:63], v[140:143], v[12:15]
    v_cvt_pk_bf16_f32 v148, v160, v161
    v_mul_f32_dpp v162, v42, v42 row_ror:4 row_mask:0xf bank_mask:0xf
    v_mfma_f32_16x16x32_bf16 v[180:183], a[56:59], v[136:139], v[180:183]
    global_load_dwordx4 v[124:127], v247, s[6:7] offset:192
    v_mfma_f32_16x16x32_bf16 v[180:183], a[52:55], v[132:135], v[180:183]
    v_cvt_pk_bf16_f32 v186, v172, v173 clamp
    v_mul_f32_dpp v163, v43, v43 row_ror:4 row_mask:0xf bank_mask:0xf
    v_mfma_f32_16x16x32_bf16 v[180:183], a[48:51], v[128:131], v[180:183]
    v_cvt_pk_bf16_f32 v187, v174, v175 clamp
    v_cvt_pk_bf16_f32 v149, v162, v163
    v_mfma_f32_16x16x32_bf16 v[168:171], a[64:67], v[128:131], v[16:19]
    v_max_f32_dpp v235, v235, v235 row_bcast:31 row_mask:0xc bank_mask:0xf
    v_mul_f32_dpp v164, v44, v44 row_ror:4 row_mask:0xf bank_mask:0xf
    v_mfma_f32_16x16x32_bf16 v[168:171], a[68:71], v[132:135], v[168:171]
    v_mul_f32_dpp v165, v45, v45 row_ror:4 row_mask:0xf bank_mask:0xf
    v_cvt_pk_bf16_f32 v150, v164, v165
    v_mfma_f32_16x16x32_bf16 v[168:171], a[72:75], v[136:139], v[168:171]
    v_mul_f32_dpp v166, v46, v46 row_ror:4 row_mask:0xf bank_mask:0xf
    v_cvt_pk_bf16_f32 v188, v176, v177 clamp
    v_mfma_f32_16x16x32_bf16 v[168:171], a[76:79], v[140:143], v[168:171]
    v_mul_f32_dpp v167, v47, v47 row_ror:4 row_mask:0xf bank_mask:0xf
    v_cvt_pk_bf16_f32 v189, v178, v179 clamp
    v_mfma_f32_16x16x32_bf16 v[172:175], a[92:95], v[140:143], v[20:23]
    v_cvt_pk_bf16_f32 v151, v166, v167
    v_mul_f32_dpp v160, v48, v48 row_ror:4 row_mask:0xf bank_mask:0xf
    v_mfma_f32_16x16x32_bf16 v[172:175], a[88:91], v[136:139], v[172:175]
    v_mul_f32_dpp v161, v49, v49 row_ror:4 row_mask:0xf bank_mask:0xf
    v_mul_f32 v235, v253, v235
    v_mfma_f32_16x16x32_bf16 v[172:175], a[84:87], v[132:135], v[172:175]
    v_cvt_pk_bf16_f32 v152, v160, v161
    v_mul_f32_dpp v162, v50, v50 row_ror:4 row_mask:0xf bank_mask:0xf
    v_mfma_f32_16x16x32_bf16 v[172:175], a[80:83], v[128:131], v[172:175]
    v_cvt_pk_bf16_f32 v190, v180, v181 clamp
    v_mul_f32_dpp v163, v51, v51 row_ror:4 row_mask:0xf bank_mask:0xf
    v_smfmac_f32_16x16x64_bf16 v[200:203], a[140:143], v[192:199], v233
    v_cvt_pk_bf16_f32 v191, v182, v183 clamp
    v_cvt_pk_bf16_f32 v153, v162, v163
    v_mul_f32_dpp v164, v52, v52 row_ror:4 row_mask:0xf bank_mask:0xf
    v_smfmac_f32_16x16x64_bf16 v[200:203], a[144:147], v[184:191], v233
    v_mul_f32_dpp v165, v53, v53 row_ror:4 row_mask:0xf bank_mask:0xf
    v_mfma_f32_16x16x32_bf16 v[176:179], a[96:99], v[128:131], v[24:27]
    v_cvt_pk_bf16_f32 v154, v164, v165
    v_mul_f32_dpp v166, v54, v54 row_ror:4 row_mask:0xf bank_mask:0xf
    v_mfma_f32_16x16x32_bf16 v[176:179], a[100:103], v[132:135], v[176:179]
    s_waitcnt lgkmcnt(0)
    v_mov_b32_dpp v222, v225 quad_perm:[0,1,2,3] row_mask:0x7 bank_mask:0xf
    v_mfma_f32_16x16x32_bf16 v[176:179], a[104:107], v[136:139], v[176:179]
    v_cvt_pk_bf16_f32 v192, v168, v169 clamp
    v_mul_f32_dpp v167, v55, v55 row_ror:4 row_mask:0xf bank_mask:0xf
    v_mfma_f32_16x16x32_bf16 v[176:179], a[108:111], v[140:143], v[176:179]
    v_fma_f32 v235, |v235|, s23, v235
    v_cvt_pk_bf16_f32 v193, v170, v171 clamp
    v_mfma_f32_16x16x32_bf16 v[180:183], a[124:127], v[140:143], v[28:31]
    v_cvt_pk_bf16_f32 v155, v166, v167
    v_mul_f32_dpp v160, v56, v56 row_ror:4 row_mask:0xf bank_mask:0xf
    v_mfma_f32_16x16x32_bf16 v[180:183], a[120:123], v[136:139], v[180:183]
    v_mul_f32_dpp v161, v57, v57 row_ror:4 row_mask:0xf bank_mask:0xf
    v_cvt_pk_bf16_f32 v156, v160, v161
    v_mfma_f32_16x16x32_bf16 v[180:183], a[116:119], v[132:135], v[180:183]
    v_mul_f32_dpp v162, v58, v58 row_ror:4 row_mask:0xf bank_mask:0xf
    v_cvt_pk_bf16_f32 v194, v172, v173 clamp
    v_mfma_f32_16x16x32_bf16 v[180:183], a[112:115], v[128:131], v[180:183]
    v_mul_f32_dpp v163, v59, v59 row_ror:4 row_mask:0xf bank_mask:0xf
    v_cvt_pk_bf16_f32 v195, v174, v175 clamp
    v_mfma_f32_16x16x32_bf16 v[168:171], a[0:3], v[144:147], v[0:3]
    v_cvt_pk_bf16_f32 v157, v162, v163
    v_mul_f32_dpp v164, v60, v60 row_ror:4 row_mask:0xf bank_mask:0xf
    v_mfma_f32_16x16x32_bf16 v[168:171], a[4:7], v[148:151], v[168:171]
    v_readlane_b32 s24, v235, 63
    v_mul_f32_dpp v165, v61, v61 row_ror:4 row_mask:0xf bank_mask:0xf
    v_mfma_f32_16x16x32_bf16 v[168:171], a[8:11], v[152:155], v[168:171]
    v_cvt_pk_bf16_f32 v158, v164, v165
    v_mul_f32_dpp v166, v62, v62 row_ror:4 row_mask:0xf bank_mask:0xf
    v_mul_f32_dpp v167, v63, v63 row_ror:4 row_mask:0xf bank_mask:0xf
    v_cvt_pk_bf16_f32 v159, v166, v167
    v_cvt_pk_bf16_f32 v196, v176, v177 clamp
    v_cvt_pk_bf16_f32 v197, v178, v179 clamp
    v_mfma_f32_16x16x32_bf16 v[168:171], a[12:15], v[156:159], v[168:171]
    v_fma_f32 v226, v226, v253, -s24
    v_mul_f32_dpp v160, v32, v32 row_ror:5 row_mask:0xf bank_mask:0xf
    v_mfma_f32_16x16x32_bf16 v[172:175], a[28:31], v[156:159], v[4:7]
    buffer_load_dword v245, v248, s[36:39], s22 offen offset:0
    v_mfma_f32_16x16x32_bf16 v[172:175], a[24:27], v[152:155], v[172:175]
    v_mul_f32_dpp v161, v33, v33 row_ror:5 row_mask:0xf bank_mask:0xf
    v_cvt_pk_bf16_f32 v128, v160, v161
    v_mfma_f32_16x16x32_bf16 v[172:175], a[20:23], v[148:151], v[172:175]
    v_cvt_pk_bf16_f32 v198, v180, v181 clamp
    v_mul_f32_dpp v162, v34, v34 row_ror:5 row_mask:0xf bank_mask:0xf
    v_mfma_f32_16x16x32_bf16 v[172:175], a[16:19], v[144:147], v[172:175]
    v_cvt_pk_bf16_f32 v199, v182, v183 clamp
    v_mul_f32_dpp v163, v35, v35 row_ror:5 row_mask:0xf bank_mask:0xf
    v_mfma_f32_16x16x32_bf16 v[176:179], a[32:35], v[144:147], v[8:11]
    v_cvt_pk_bf16_f32 v129, v162, v163
    v_mul_f32_dpp v164, v36, v36 row_ror:5 row_mask:0xf bank_mask:0xf
    v_mfma_f32_16x16x32_bf16 v[176:179], a[36:39], v[148:151], v[176:179]
    v_mul_f32_dpp v165, v37, v37 row_ror:5 row_mask:0xf bank_mask:0xf
    v_cvt_pk_bf16_f32 v184, v168, v169 clamp
    v_mfma_f32_16x16x32_bf16 v[176:179], a[40:43], v[152:155], v[176:179]
    v_cvt_pk_bf16_f32 v130, v164, v165
    v_mul_f32_dpp v166, v38, v38 row_ror:5 row_mask:0xf bank_mask:0xf
    v_mfma_f32_16x16x32_bf16 v[176:179], a[44:47], v[156:159], v[176:179]
    v_exp_f32_e64 v226, v226 clamp
    v_mfma_f32_16x16x32_bf16 v[180:183], a[60:63], v[156:159], v[12:15]
    v_cvt_pk_bf16_f32 v185, v170, v171 clamp
    v_mul_f32_dpp v167, v39, v39 row_ror:5 row_mask:0xf bank_mask:0xf
    v_mfma_f32_16x16x32_bf16 v[180:183], a[56:59], v[152:155], v[180:183]
    v_cvt_pk_bf16_f32 v131, v166, v167
    v_mul_f32_dpp v160, v40, v40 row_ror:5 row_mask:0xf bank_mask:0xf
    v_mfma_f32_16x16x32_bf16 v[180:183], a[52:55], v[148:151], v[180:183]
    buffer_load_dword v246, v249, s[36:39], s22 offen offset:64
    v_mfma_f32_16x16x32_bf16 v[180:183], a[48:51], v[144:147], v[180:183]
    v_mul_f32_dpp v161, v41, v41 row_ror:5 row_mask:0xf bank_mask:0xf
    v_cvt_pk_bf16_f32 v186, v172, v173 clamp
    v_mfma_f32_16x16x32_bf16 v[168:171], a[64:67], v[144:147], v[16:19]
    v_cvt_pk_bf16_f32 v132, v160, v161
    v_cvt_pk_bf16_f32 v187, v174, v175 clamp
    v_mfma_f32_16x16x32_bf16 v[168:171], a[68:71], v[148:151], v[168:171]
    v_mul_f32_dpp v162, v42, v42 row_ror:5 row_mask:0xf bank_mask:0xf
    v_mul_f32_dpp v163, v43, v43 row_ror:5 row_mask:0xf bank_mask:0xf
    v_mfma_f32_16x16x32_bf16 v[168:171], a[72:75], v[152:155], v[168:171]
    v_cvt_pk_bf16_f32 v133, v162, v163
    v_mul_f32_dpp v164, v44, v44 row_ror:5 row_mask:0xf bank_mask:0xf
    v_mfma_f32_16x16x32_bf16 v[168:171], a[76:79], v[156:159], v[168:171]
    v_mul_f32 v236, v226, v224
    v_cvt_pk_bf16_f32 v188, v176, v177 clamp
    v_mfma_f32_16x16x32_bf16 v[172:175], a[92:95], v[156:159], v[20:23]
    v_mul_f32_dpp v165, v45, v45 row_ror:5 row_mask:0xf bank_mask:0xf
    v_cvt_pk_bf16_f32 v134, v164, v165
    v_mfma_f32_16x16x32_bf16 v[172:175], a[88:91], v[152:155], v[172:175]
    v_cvt_pk_bf16_f32 v189, v178, v179 clamp
    v_mul_f32_dpp v166, v46, v46 row_ror:5 row_mask:0xf bank_mask:0xf
    v_mfma_f32_16x16x32_bf16 v[172:175], a[84:87], v[148:151], v[172:175]
    v_mul_f32_dpp v167, v47, v47 row_ror:5 row_mask:0xf bank_mask:0xf
    v_cvt_pk_bf16_f32 v135, v166, v167
    v_mfma_f32_16x16x32_bf16 v[172:175], a[80:83], v[144:147], v[172:175]
    v_mul_f32_dpp v160, v48, v48 row_ror:5 row_mask:0xf bank_mask:0xf
    v_cvt_pk_bf16_f32 v190, v180, v181 clamp
    v_smfmac_f32_16x16x64_bf16 v[200:203], a[148:151], v[192:199], v233
    v_mul_f32_dpp v161, v49, v49 row_ror:5 row_mask:0xf bank_mask:0xf
    v_cvt_pk_bf16_f32 v191, v182, v183 clamp
    buffer_load_dword v247, v250, s[36:39], s22 offen offset:64
    v_cvt_pk_bf16_f32 v136, v160, v161
    v_smfmac_f32_16x16x64_bf16 v[200:203], a[152:155], v[184:191], v233
    v_mul_f32_dpp v162, v50, v50 row_ror:5 row_mask:0xf bank_mask:0xf
    v_mfma_f32_16x16x32_bf16 v[176:179], a[96:99], v[144:147], v[24:27]
    v_fma_f32 v232, v232, v253, -s24
    v_mul_f32_dpp v163, v51, v51 row_ror:5 row_mask:0xf bank_mask:0xf
    v_mfma_f32_16x16x32_bf16 v[176:179], a[100:103], v[148:151], v[176:179]
    v_cvt_pk_bf16_f32 v137, v162, v163
    v_cvt_pk_bf16_f32 v192, v168, v169 clamp
    v_mfma_f32_16x16x32_bf16 v[176:179], a[104:107], v[152:155], v[176:179]
    v_mul_f32_dpp v164, v52, v52 row_ror:5 row_mask:0xf bank_mask:0xf
    v_cvt_pk_bf16_f32 v193, v170, v171 clamp
    v_mfma_f32_16x16x32_bf16 v[176:179], a[108:111], v[156:159], v[176:179]
    v_mul_f32_dpp v165, v53, v53 row_ror:5 row_mask:0xf bank_mask:0xf
    v_cvt_pk_bf16_f32 v138, v164, v165
    s_waitcnt vmcnt(7)
    v_mfma_f32_16x16x32_bf16 v[216:219], v[80:83], v[64:67], 0
    v_mul_f32_dpp v166, v54, v54 row_ror:5 row_mask:0xf bank_mask:0xf
    v_mul_f32_dpp v167, v55, v55 row_ror:5 row_mask:0xf bank_mask:0xf
    v_mfma_f32_16x16x32_bf16 v[216:219], v[84:87], v[68:71], v[216:219]
    v_cvt_pk_bf16_f32 v139, v166, v167
    v_cvt_pk_bf16_f32 v194, v172, v173 clamp
    v_mfma_f32_16x16x32_bf16 v[216:219], v[88:91], v[72:75], v[216:219]
    v_mul_f32_dpp v160, v56, v56 row_ror:5 row_mask:0xf bank_mask:0xf
    v_cvt_pk_bf16_f32 v195, v174, v175 clamp
    v_mfma_f32_16x16x32_bf16 v[216:219], v[92:95], v[76:79], v[216:219]
    v_exp_f32_e64 v232, v232 clamp
    v_mfma_f32_16x16x32_bf16 v[180:183], a[124:127], v[156:159], v[28:31]
    v_mul_f32_dpp v161, v57, v57 row_ror:5 row_mask:0xf bank_mask:0xf
    v_cvt_pk_bf16_f32 v140, v160, v161
    v_mfma_f32_16x16x32_bf16 v[180:183], a[120:123], v[152:155], v[180:183]
    v_mul_f32_dpp v162, v58, v58 row_ror:5 row_mask:0xf bank_mask:0xf
    v_mul_f32_dpp v163, v59, v59 row_ror:5 row_mask:0xf bank_mask:0xf
    v_mfma_f32_16x16x32_bf16 v[180:183], a[116:119], v[148:151], v[180:183]
    v_cvt_pk_bf16_f32 v141, v162, v163
    v_mul_f32_dpp v164, v60, v60 row_ror:5 row_mask:0xf bank_mask:0xf
    v_mfma_f32_16x16x32_bf16 v[180:183], a[112:115], v[144:147], v[180:183]
    v_mul_f32_dpp v165, v61, v61 row_ror:5 row_mask:0xf bank_mask:0xf
L_pad1:
    s_cbranch_vccnz L_pad5
    v_cvt_pk_bf16_f32 v196, v176, v177 clamp
    v_mfma_f32_16x16x32_bf16 v[168:171], a[0:3], v[128:131], v[0:3]
    v_cvt_pk_bf16_f32 v142, v164, v165
    v_cvt_pk_bf16_f32 v197, v178, v179 clamp
    v_mfma_f32_16x16x32_bf16 v[168:171], a[4:7], v[132:135], v[168:171]
    v_mul_f32_dpp v166, v62, v62 row_ror:5 row_mask:0xf bank_mask:0xf
    v_fmac_f32 v236, v232, v225
    v_mfma_f32_16x16x32_bf16 v[168:171], a[8:11], v[136:139], v[168:171]
    v_mul_f32_dpp v167, v63, v63 row_ror:5 row_mask:0xf bank_mask:0xf
    v_cvt_pk_bf16_f32 v143, v166, v167
    v_mul_f32_dpp v160, v32, v32 row_ror:6 row_mask:0xf bank_mask:0xf
    v_mul_f32_dpp v161, v33, v33 row_ror:6 row_mask:0xf bank_mask:0xf
    v_mfma_f32_16x16x32_bf16 v[168:171], a[12:15], v[140:143], v[168:171]
    v_cvt_pk_bf16_f32 v144, v160, v161
    v_cvt_pk_bf16_f32 v198, v180, v181 clamp
    v_mfma_f32_16x16x32_bf16 v[172:175], a[28:31], v[140:143], v[4:7]
    v_mul_f32_dpp v162, v34, v34 row_ror:6 row_mask:0xf bank_mask:0xf
    v_add_f32 v237, v226, v232
    v_mfma_f32_16x16x32_bf16 v[172:175], a[24:27], v[136:139], v[172:175]
    v_cvt_pk_bf16_f32 v199, v182, v183 clamp
    v_mul_f32_dpp v163, v35, v35 row_ror:6 row_mask:0xf bank_mask:0xf
    v_mfma_f32_16x16x32_bf16 v[172:175], a[20:23], v[132:135], v[172:175]
    v_cvt_pk_bf16_f32 v145, v162, v163
    v_mul_f32_dpp v164, v36, v36 row_ror:6 row_mask:0xf bank_mask:0xf
    v_mfma_f32_16x16x32_bf16 v[172:175], a[16:19], v[128:131], v[172:175]
    v_mul_f32_dpp v165, v37, v37 row_ror:6 row_mask:0xf bank_mask:0xf
    v_cvt_pk_bf16_f32 v184, v168, v169 clamp
    v_mfma_f32_16x16x32_bf16 v[176:179], a[32:35], v[128:131], v[8:11]
    v_cvt_pk_bf16_f32 v146, v164, v165
    v_cvt_pk_bf16_f32 v185, v170, v171 clamp
    v_mfma_f32_16x16x32_bf16 v[176:179], a[36:39], v[132:135], v[176:179]
    v_mul_f32_dpp v166, v38, v38 row_ror:6 row_mask:0xf bank_mask:0xf
    v_mul_f32_dpp v167, v39, v39 row_ror:6 row_mask:0xf bank_mask:0xf
    v_mfma_f32_16x16x32_bf16 v[176:179], a[40:43], v[136:139], v[176:179]
    v_cvt_pk_bf16_f32 v147, v166, v167
    v_fma_f32 v227, v227, v253, -s24
    v_mfma_f32_16x16x32_bf16 v[176:179], a[44:47], v[140:143], v[176:179]
    v_mul_f32_dpp v160, v40, v40 row_ror:6 row_mask:0xf bank_mask:0xf
    v_cvt_pk_bf16_f32 v186, v172, v173 clamp
    v_mfma_f32_16x16x32_bf16 v[180:183], a[60:63], v[140:143], v[12:15]
    v_mul_f32_dpp v161, v41, v41 row_ror:6 row_mask:0xf bank_mask:0xf
    v_mov_b32 v208, 0
    v_mfma_f32_16x16x32_bf16 v[180:183], a[56:59], v[136:139], v[180:183]
    v_cvt_pk_bf16_f32 v187, v174, v175 clamp
    v_cvt_pk_bf16_f32 v148, v160, v161
    v_mfma_f32_16x16x32_bf16 v[180:183], a[52:55], v[132:135], v[180:183]
    v_mul_f32_dpp v162, v42, v42 row_ror:6 row_mask:0xf bank_mask:0xf
    v_mov_b32 v209, 0
    v_mfma_f32_16x16x32_bf16 v[180:183], a[48:51], v[128:131], v[180:183]
    v_mul_f32_dpp v163, v43, v43 row_ror:6 row_mask:0xf bank_mask:0xf
    v_cvt_pk_bf16_f32 v188, v176, v177 clamp
    v_mfma_f32_16x16x32_bf16 v[168:171], a[64:67], v[128:131], v[16:19]
    v_cvt_pk_bf16_f32 v149, v162, v163
    v_mul_f32_dpp v164, v44, v44 row_ror:6 row_mask:0xf bank_mask:0xf
    v_mfma_f32_16x16x32_bf16 v[168:171], a[68:71], v[132:135], v[168:171]
    v_cvt_pk_bf16_f32 v189, v178, v179 clamp
    v_mul_f32_dpp v165, v45, v45 row_ror:6 row_mask:0xf bank_mask:0xf
    v_mfma_f32_16x16x32_bf16 v[168:171], a[72:75], v[136:139], v[168:171]
    v_exp_f32_e64 v227, v227 clamp
    v_mfma_f32_16x16x32_bf16 v[168:171], a[76:79], v[140:143], v[168:171]
    v_cvt_pk_bf16_f32 v150, v164, v165
    v_mul_f32_dpp v166, v46, v46 row_ror:6 row_mask:0xf bank_mask:0xf
    v_mfma_f32_16x16x32_bf16 v[172:175], a[92:95], v[140:143], v[20:23]
    v_cvt_pk_bf16_f32 v190, v180, v181 clamp
    v_mul_f32_dpp v167, v47, v47 row_ror:6 row_mask:0xf bank_mask:0xf
    v_mfma_f32_16x16x32_bf16 v[172:175], a[88:91], v[136:139], v[172:175]
    v_cvt_pk_bf16_f32 v191, v182, v183 clamp
    v_cvt_pk_bf16_f32 v151, v166, v167
    v_mfma_f32_16x16x32_bf16 v[172:175], a[84:87], v[132:135], v[172:175]
    v_mul_f32_dpp v160, v48, v48 row_ror:6 row_mask:0xf bank_mask:0xf
    v_mul_f32_dpp v161, v49, v49 row_ror:6 row_mask:0xf bank_mask:0xf
    v_mfma_f32_16x16x32_bf16 v[172:175], a[80:83], v[128:131], v[172:175]
    v_cvt_pk_bf16_f32 v152, v160, v161
    v_mul_f32_dpp v162, v50, v50 row_ror:6 row_mask:0xf bank_mask:0xf
    v_smfmac_f32_16x16x64_bf16 v[200:203], a[156:159], v[192:199], v233
    v_cvt_pk_bf16_f32 v192, v168, v169 clamp
    v_smfmac_f32_16x16x64_bf16 v[208:211], a[128:131], v[184:191], v233
    v_fmac_f32 v236, v227, v222
    v_mfma_f32_16x16x32_bf16 v[176:179], a[96:99], v[128:131], v[24:27]
    v_cvt_pk_bf16_f32 v193, v170, v171 clamp
    v_mul_f32_dpp v163, v51, v51 row_ror:6 row_mask:0xf bank_mask:0xf
    v_mfma_f32_16x16x32_bf16 v[176:179], a[100:103], v[132:135], v[176:179]
    v_cvt_pk_bf16_f32 v153, v162, v163
    v_mul_f32_dpp v164, v52, v52 row_ror:6 row_mask:0xf bank_mask:0xf
    v_mfma_f32_16x16x32_bf16 v[176:179], a[104:107], v[136:139], v[176:179]
    v_mul_f32_dpp v165, v53, v53 row_ror:6 row_mask:0xf bank_mask:0xf
    v_cvt_pk_bf16_f32 v194, v172, v173 clamp
    v_mfma_f32_16x16x32_bf16 v[176:179], a[108:111], v[140:143], v[176:179]
    v_cvt_pk_bf16_f32 v154, v164, v165
    v_cvt_pk_bf16_f32 v195, v174, v175 clamp
    v_mfma_f32_4x4x4_16b_bf16 v[64:67], a[200:201], v[80:81], 0
    v_mul_f32_dpp v166, v54, v54 row_ror:6 row_mask:0xf bank_mask:0xf
    v_mfma_f32_4x4x4_16b_bf16 v[68:71], a[200:201], v[82:83], 0
    v_mul_f32_dpp v167, v55, v55 row_ror:6 row_mask:0xf bank_mask:0xf
    v_mfma_f32_4x4x4_16b_bf16 v[72:75], a[200:201], v[84:85], 0
    v_add_f32 v226, v200, v201
    v_mfma_f32_4x4x4_16b_bf16 v[76:79], a[200:201], v[86:87], 0
    v_cvt_pk_bf16_f32 v155, v166, v167
    v_mfma_f32_4x4x4_16b_bf16 v[80:83], a[200:201], v[88:89], 0
    v_mul_f32_dpp v160, v56, v56 row_ror:6 row_mask:0xf bank_mask:0xf
    v_mfma_f32_4x4x4_16b_bf16 v[84:87], a[200:201], v[90:91], 0
    v_add_f32 v237, v237, v227
    v_mfma_f32_4x4x4_16b_bf16 v[88:91], a[200:201], v[92:93], 0
    v_mul_f32_dpp v161, v57, v57 row_ror:6 row_mask:0xf bank_mask:0xf
    v_mfma_f32_4x4x4_16b_bf16 v[92:95], a[200:201], v[94:95], 0
    v_cvt_pk_bf16_f32 v156, v160, v161
    v_cvt_pk_bf16_f32 v196, v176, v177 clamp
    v_mul_f32_dpp v162, v58, v58 row_ror:6 row_mask:0xf bank_mask:0xf
    v_mfma_f32_16x16x32_bf16 v[180:183], a[124:127], v[140:143], v[28:31]
    v_cvt_pk_bf16_f32 v197, v178, v179 clamp
    v_mul_f32_dpp v163, v59, v59 row_ror:6 row_mask:0xf bank_mask:0xf
    v_mfma_f32_16x16x32_bf16 v[180:183], a[120:123], v[136:139], v[180:183]
    v_cvt_pk_bf16_f32 v157, v162, v163
    v_mul_f32_dpp v164, v60, v60 row_ror:6 row_mask:0xf bank_mask:0xf
    v_mfma_f32_16x16x32_bf16 v[180:183], a[116:119], v[132:135], v[180:183]
    v_mul_f32_dpp v165, v61, v61 row_ror:6 row_mask:0xf bank_mask:0xf
    v_cvt_pk_bf16_f32 v158, v164, v165
    v_mfma_f32_16x16x32_bf16 v[180:183], a[112:115], v[128:131], v[180:183]
    v_fma_f32 v228, v228, v253, -s24
    v_mul_f32_dpp v166, v62, v62 row_ror:6 row_mask:0xf bank_mask:0xf
    v_mfma_f32_16x16x32_bf16 v[168:171], a[0:3], v[144:147], v[0:3]
    v_mul_f32_dpp v167, v63, v63 row_ror:6 row_mask:0xf bank_mask:0xf
    v_cvt_pk_bf16_f32 v159, v166, v167
    v_mfma_f32_16x16x32_bf16 v[168:171], a[4:7], v[148:151], v[168:171]
    v_mul_f32_dpp v160, v32, v32 row_ror:7 row_mask:0xf bank_mask:0xf
    v_mul_f32_dpp v161, v33, v33 row_ror:7 row_mask:0xf bank_mask:0xf
    v_mfma_f32_16x16x32_bf16 v[168:171], a[8:11], v[152:155], v[168:171]
    v_exp_f32_e64 v228, v228 clamp
    v_mfma_f32_16x16x32_bf16 v[168:171], a[12:15], v[156:159], v[168:171]
    v_cvt_pk_bf16_f32 v128, v160, v161
    v_cvt_pk_bf16_f32 v198, v180, v181 clamp
    v_mfma_f32_16x16x32_bf16 v[172:175], a[28:31], v[156:159], v[4:7]
    v_mul_f32_dpp v162, v34, v34 row_ror:7 row_mask:0xf bank_mask:0xf
    v_mul_f32_dpp v163, v35, v35 row_ror:7 row_mask:0xf bank_mask:0xf
    v_mfma_f32_16x16x32_bf16 v[172:175], a[24:27], v[152:155], v[172:175]
    v_cvt_pk_bf16_f32 v199, v182, v183 clamp
    v_cvt_pk_bf16_f32 v129, v162, v163
    v_mfma_f32_16x16x32_bf16 v[172:175], a[20:23], v[148:151], v[172:175]
    v_mul_f32_dpp v164, v36, v36 row_ror:7 row_mask:0xf bank_mask:0xf
    v_mul_f32_dpp v165, v37, v37 row_ror:7 row_mask:0xf bank_mask:0xf
    v_mfma_f32_16x16x32_bf16 v[172:175], a[16:19], v[144:147], v[172:175]
    v_cvt_pk_bf16_f32 v130, v164, v165
    v_cvt_pk_bf16_f32 v184, v168, v169 clamp
    v_mfma_f32_16x16x32_bf16 v[176:179], a[32:35], v[144:147], v[8:11]
    v_mul_f32_dpp v166, v38, v38 row_ror:7 row_mask:0xf bank_mask:0xf
    v_mul_f32_dpp v167, v39, v39 row_ror:7 row_mask:0xf bank_mask:0xf
    v_mfma_f32_16x16x32_bf16 v[176:179], a[36:39], v[148:151], v[176:179]
    v_cvt_pk_bf16_f32 v185, v170, v171 clamp
    v_cvt_pk_bf16_f32 v131, v166, v167
    v_mfma_f32_16x16x32_bf16 v[176:179], a[40:43], v[152:155], v[176:179]
    v_mul_f32_dpp v160, v40, v40 row_ror:7 row_mask:0xf bank_mask:0xf
    v_fmac_f32 v236, v228, v223
    v_mfma_f32_16x16x32_bf16 v[176:179], a[44:47], v[156:159], v[176:179]
    v_mul_f32_dpp v161, v41, v41 row_ror:7 row_mask:0xf bank_mask:0xf
    v_cvt_pk_bf16_f32 v132, v160, v161
    v_mfma_f32_16x16x32_bf16 v[180:183], a[60:63], v[156:159], v[12:15]
    v_mul_f32_dpp v162, v42, v42 row_ror:7 row_mask:0xf bank_mask:0xf
    v_cvt_pk_bf16_f32 v186, v172, v173 clamp
    v_mfma_f32_16x16x32_bf16 v[180:183], a[56:59], v[152:155], v[180:183]
    v_mul_f32_dpp v163, v43, v43 row_ror:7 row_mask:0xf bank_mask:0xf
    v_cvt_pk_bf16_f32 v187, v174, v175 clamp
    v_mfma_f32_16x16x32_bf16 v[180:183], a[52:55], v[148:151], v[180:183]
    v_cvt_pk_bf16_f32 v133, v162, v163
    v_mul_f32_dpp v164, v44, v44 row_ror:7 row_mask:0xf bank_mask:0xf
    v_mfma_f32_16x16x32_bf16 v[180:183], a[48:51], v[144:147], v[180:183]
    v_mul_f32_dpp v165, v45, v45 row_ror:7 row_mask:0xf bank_mask:0xf
    v_cvt_pk_bf16_f32 v134, v164, v165
    v_mfma_f32_16x16x32_bf16 v[168:171], a[64:67], v[144:147], v[16:19]
    v_mul_f32_dpp v166, v46, v46 row_ror:7 row_mask:0xf bank_mask:0xf
    v_cvt_pk_bf16_f32 v188, v176, v177 clamp
    v_mfma_f32_16x16x32_bf16 v[168:171], a[68:71], v[148:151], v[168:171]
    v_mul_f32_dpp v167, v47, v47 row_ror:7 row_mask:0xf bank_mask:0xf
    v_add_f32 v237, v237, v228
    v_mfma_f32_16x16x32_bf16 v[168:171], a[72:75], v[152:155], v[168:171]
    v_cvt_pk_bf16_f32 v189, v178, v179 clamp
    v_cvt_pk_bf16_f32 v135, v166, v167
    v_mfma_f32_16x16x32_bf16 v[168:171], a[76:79], v[156:159], v[168:171]
    v_mul_f32_dpp v160, v48, v48 row_ror:7 row_mask:0xf bank_mask:0xf
    v_mul_f32_dpp v161, v49, v49 row_ror:7 row_mask:0xf bank_mask:0xf
    v_mfma_f32_16x16x32_bf16 v[172:175], a[92:95], v[156:159], v[20:23]
    v_cvt_pk_bf16_f32 v136, v160, v161
    v_mul_f32_dpp v162, v50, v50 row_ror:7 row_mask:0xf bank_mask:0xf
    v_mfma_f32_16x16x32_bf16 v[172:175], a[88:91], v[152:155], v[172:175]
    v_cvt_pk_bf16_f32 v190, v180, v181 clamp
    v_mul_f32_dpp v163, v51, v51 row_ror:7 row_mask:0xf bank_mask:0xf
    v_mfma_f32_16x16x32_bf16 v[172:175], a[84:87], v[148:151], v[172:175]
    v_cvt_pk_bf16_f32 v191, v182, v183 clamp
    v_cvt_pk_bf16_f32 v137, v162, v163
    v_mfma_f32_16x16x32_bf16 v[172:175], a[80:83], v[144:147], v[172:175]
    v_mul_f32_dpp v164, v52, v52 row_ror:7 row_mask:0xf bank_mask:0xf
    v_mul_f32_dpp v165, v53, v53 row_ror:7 row_mask:0xf bank_mask:0xf
    v_smfmac_f32_16x16x64_bf16 v[208:211], a[132:135], v[192:199], v233
    v_cvt_pk_bf16_f32 v138, v164, v165
    v_smfmac_f32_16x16x64_bf16 v[208:211], a[136:139], v[184:191], v233
    v_fma_f32 v229, v229, v253, -s24
    v_mfma_f32_16x16x32_bf16 v[176:179], a[96:99], v[144:147], v[24:27]
    v_mul_f32_dpp v166, v54, v54 row_ror:7 row_mask:0xf bank_mask:0xf
    v_cvt_pk_bf16_f32 v192, v168, v169 clamp
    v_mfma_f32_16x16x32_bf16 v[176:179], a[100:103], v[148:151], v[176:179]
    v_mul_f32_dpp v167, v55, v55 row_ror:7 row_mask:0xf bank_mask:0xf
    v_cvt_pk_bf16_f32 v193, v170, v171 clamp
    v_mfma_f32_16x16x32_bf16 v[176:179], a[104:107], v[152:155], v[176:179]
    v_cvt_pk_bf16_f32 v139, v166, v167
    v_mul_f32_dpp v160, v56, v56 row_ror:7 row_mask:0xf bank_mask:0xf
    v_mfma_f32_16x16x32_bf16 v[176:179], a[108:111], v[156:159], v[176:179]
    v_mul_f32_dpp v161, v57, v57 row_ror:7 row_mask:0xf bank_mask:0xf
    v_cvt_pk_bf16_f32 v140, v160, v161
    v_mfma_f32_16x16x32_bf16 v[180:183], a[124:127], v[156:159], v[28:31]
    v_mul_f32_dpp v162, v58, v58 row_ror:7 row_mask:0xf bank_mask:0xf
    v_cvt_pk_bf16_f32 v194, v172, v173 clamp
    v_mfma_f32_16x16x32_bf16 v[180:183], a[120:123], v[152:155], v[180:183]
    v_mul_f32_dpp v163, v59, v59 row_ror:7 row_mask:0xf bank_mask:0xf
    v_cvt_pk_bf16_f32 v195, v174, v175 clamp
    v_mfma_f32_16x16x32_bf16 v[180:183], a[116:119], v[148:151], v[180:183]
    v_cvt_pk_bf16_f32 v141, v162, v163
    v_mul_f32_dpp v164, v60, v60 row_ror:7 row_mask:0xf bank_mask:0xf
    v_mfma_f32_16x16x32_bf16 v[180:183], a[112:115], v[144:147], v[180:183]
    v_mul_f32_dpp v165, v61, v61 row_ror:7 row_mask:0xf bank_mask:0xf
    v_cvt_pk_bf16_f32 v142, v164, v165
    v_mfma_f32_16x16x32_bf16 v[168:171], a[0:3], v[128:131], v[0:3]
    v_exp_f32_e64 v229, v229 clamp
    v_mfma_f32_16x16x32_bf16 v[168:171], a[4:7], v[132:135], v[168:171]
    v_mul_f32_dpp v166, v62, v62 row_ror:7 row_mask:0xf bank_mask:0xf
    v_mul_f32_dpp v167, v63, v63 row_ror:7 row_mask:0xf bank_mask:0xf
    v_mfma_f32_16x16x32_bf16 v[168:171], a[8:11], v[136:139], v[168:171]
    v_cvt_pk_bf16_f32 v143, v166, v167
    v_cvt_pk_bf16_f32 v196, v176, v177 clamp
    v_cvt_pk_bf16_f32 v197, v178, v179 clamp
    v_mfma_f32_16x16x32_bf16 v[168:171], a[12:15], v[140:143], v[168:171]
    v_mul_f32_dpp v160, v64, v32 row_newbcast:14 row_mask:0xf bank_mask:0xf
    v_mul_f32_dpp v161, v65, v33 row_newbcast:14 row_mask:0xf bank_mask:0xf
    v_mfma_f32_16x16x32_bf16 v[172:175], a[28:31], v[140:143], v[4:7]
    v_fmac_f32 v236, v229, v220
    v_cvt_pk_bf16_f32 v144, v160, v161
    v_mfma_f32_16x16x32_bf16 v[172:175], a[24:27], v[136:139], v[172:175]
    v_cvt_pk_bf16_f32 v198, v180, v181 clamp
    v_mul_f32_dpp v162, v66, v34 row_newbcast:14 row_mask:0xf bank_mask:0xf
    v_mfma_f32_16x16x32_bf16 v[172:175], a[20:23], v[132:135], v[172:175]
    v_cvt_pk_bf16_f32 v199, v182, v183 clamp
    v_mul_f32_dpp v163, v67, v35 row_newbcast:14 row_mask:0xf bank_mask:0xf
    v_mfma_f32_16x16x32_bf16 v[172:175], a[16:19], v[128:131], v[172:175]
    v_cvt_pk_bf16_f32 v145, v162, v163
    s_waitcnt vmcnt(3)
    v_mfma_f32_4x4x4_16b_bf16 v[96:99], a[200:201], v[112:113], 0
    v_mul_f32_dpp v164, v68, v36 row_newbcast:14 row_mask:0xf bank_mask:0xf
    v_mfma_f32_4x4x4_16b_bf16 v[100:103], a[200:201], v[114:115], 0
    v_mul_f32_dpp v165, v69, v37 row_newbcast:14 row_mask:0xf bank_mask:0xf
    v_mfma_f32_4x4x4_16b_bf16 v[104:107], a[200:201], v[116:117], 0
    v_cvt_pk_bf16_f32 v184, v168, v169 clamp
    v_mfma_f32_4x4x4_16b_bf16 v[108:111], a[200:201], v[118:119], 0
    v_cvt_pk_bf16_f32 v146, v164, v165
    v_mfma_f32_4x4x4_16b_bf16 v[112:115], a[200:201], v[120:121], 0
    v_cvt_pk_bf16_f32 v185, v170, v171 clamp
    v_mfma_f32_4x4x4_16b_bf16 v[116:119], a[200:201], v[122:123], 0
    v_mul_f32_dpp v166, v70, v38 row_newbcast:14 row_mask:0xf bank_mask:0xf
    v_mfma_f32_4x4x4_16b_bf16 v[120:123], a[200:201], v[124:125], 0
    v_add_f32 v237, v237, v229
    v_mfma_f32_4x4x4_16b_bf16 v[124:127], a[200:201], v[126:127], 0
    v_mul_f32_dpp v167, v71, v39 row_newbcast:14 row_mask:0xf bank_mask:0xf
    v_cvt_pk_bf16_f32 v147, v166, v167
    v_mul_f32_dpp v160, v72, v40 row_newbcast:14 row_mask:0xf bank_mask:0xf
    v_mfma_f32_16x16x32_bf16 v[176:179], a[32:35], v[128:131], v[8:11]
    v_cvt_pk_bf16_f32 v186, v172, v173 clamp
    v_mul_f32_dpp v161, v73, v41 row_newbcast:14 row_mask:0xf bank_mask:0xf
    v_mfma_f32_16x16x32_bf16 v[176:179], a[36:39], v[132:135], v[176:179]
    v_cvt_pk_bf16_f32 v187, v174, v175 clamp
    v_cvt_pk_bf16_f32 v148, v160, v161
    v_mfma_f32_16x16x32_bf16 v[176:179], a[40:43], v[136:139], v[176:179]
    v_mul_f32_dpp v162, v74, v42 row_newbcast:14 row_mask:0xf bank_mask:0xf
    v_mul_f32_dpp v163, v75, v43 row_newbcast:14 row_mask:0xf bank_mask:0xf
    v_mfma_f32_16x16x32_bf16 v[176:179], a[44:47], v[140:143], v[176:179]
    v_cvt_pk_bf16_f32 v149, v162, v163
    v_fma_f32 v230, v230, v253, -s24
    v_mfma_f32_16x16x32_bf16 v[180:183], a[60:63], v[140:143], v[12:15]
    v_mul_f32_dpp v164, v76, v44 row_newbcast:14 row_mask:0xf bank_mask:0xf
    v_mul_f32_dpp v165, v77, v45 row_newbcast:14 row_mask:0xf bank_mask:0xf
    v_mfma_f32_16x16x32_bf16 v[180:183], a[56:59], v[136:139], v[180:183]
    v_cvt_pk_bf16_f32 v150, v164, v165
    v_mul_f32_dpp v166, v78, v46 row_newbcast:14 row_mask:0xf bank_mask:0xf
    v_mfma_f32_16x16x32_bf16 v[180:183], a[52:55], v[132:135], v[180:183]
    v_mul_f32_dpp v167, v79, v47 row_newbcast:14 row_mask:0xf bank_mask:0xf
    v_cvt_pk_bf16_f32 v151, v166, v167
    v_mfma_f32_16x16x32_bf16 v[180:183], a[48:51], v[128:131], v[180:183]
    v_mul_f32_dpp v160, v80, v48 row_newbcast:14 row_mask:0xf bank_mask:0xf
    v_mul_f32_dpp v161, v81, v49 row_newbcast:14 row_mask:0xf bank_mask:0xf
    v_mfma_f32_16x16x32_bf16 v[168:171], a[64:67], v[128:131], v[16:19]
    v_cvt_pk_bf16_f32 v152, v160, v161
    v_cvt_pk_bf16_f32 v188, v176, v177 clamp
    v_mfma_f32_16x16x32_bf16 v[168:171], a[68:71], v[132:135], v[168:171]
    v_exp_f32_e64 v230, v230 clamp
    v_mfma_f32_16x16x32_bf16 v[168:171], a[72:75], v[136:139], v[168:171]
    v_mul_f32_dpp v162, v82, v50 row_newbcast:14 row_mask:0xf bank_mask:0xf
    v_cvt_pk_bf16_f32 v189, v178, v179 clamp
    v_mfma_f32_16x16x32_bf16 v[168:171], a[76:79], v[140:143], v[168:171]
    v_mul_f32_dpp v163, v83, v51 row_newbcast:14 row_mask:0xf bank_mask:0xf
    v_cvt_pk_bf16_f32 v153, v162, v163
    v_mfma_f32_16x16x32_bf16 v[172:175], a[92:95], v[140:143], v[20:23]
    v_mul_f32_dpp v164, v84, v52 row_newbcast:14 row_mask:0xf bank_mask:0xf
    v_mul_f32_dpp v165, v85, v53 row_newbcast:14 row_mask:0xf bank_mask:0xf
    v_mfma_f32_16x16x32_bf16 v[172:175], a[88:91], v[136:139], v[172:175]
    v_cvt_pk_bf16_f32 v190, v180, v181 clamp
    v_cvt_pk_bf16_f32 v154, v164, v165
    v_mfma_f32_16x16x32_bf16 v[172:175], a[84:87], v[132:135], v[172:175]
    v_cvt_pk_bf16_f32 v191, v182, v183 clamp
    v_mul_f32_dpp v166, v86, v54 row_newbcast:14 row_mask:0xf bank_mask:0xf
    v_mfma_f32_16x16x32_bf16 v[172:175], a[80:83], v[128:131], v[172:175]
    v_mul_f32_dpp v167, v87, v55 row_newbcast:14 row_mask:0xf bank_mask:0xf
    v_fmac_f32 v236, v230, v221
    v_smfmac_f32_16x16x64_bf16 v[208:211], a[140:143], v[192:199], v233
    v_cvt_pk_bf16_f32 v155, v166, v167
    v_smfmac_f32_16x16x64_bf16 v[208:211], a[144:147], v[184:191], v233
    v_mul_f32_dpp v160, v88, v56 row_newbcast:14 row_mask:0xf bank_mask:0xf
    v_mfma_f32_16x16x32_bf16 v[176:179], a[96:99], v[128:131], v[24:27]
    v_cvt_pk_bf16_f32 v192, v168, v169 clamp
    v_mul_f32_dpp v161, v89, v57 row_newbcast:14 row_mask:0xf bank_mask:0xf
    v_mfma_f32_16x16x32_bf16 v[176:179], a[100:103], v[132:135], v[176:179]
    v_cvt_pk_bf16_f32 v193, v170, v171 clamp
    v_cvt_pk_bf16_f32 v156, v160, v161
    v_mfma_f32_16x16x32_bf16 v[176:179], a[104:107], v[136:139], v[176:179]
    v_mul_f32_dpp v162, v90, v58 row_newbcast:14 row_mask:0xf bank_mask:0xf
    v_mul_f32_dpp v163, v91, v59 row_newbcast:14 row_mask:0xf bank_mask:0xf
    v_mfma_f32_16x16x32_bf16 v[176:179], a[108:111], v[140:143], v[176:179]
    v_cvt_pk_bf16_f32 v157, v162, v163
    v_cvt_pk_bf16_f32 v194, v172, v173 clamp
    v_mfma_f32_16x16x32_bf16 v[180:183], a[124:127], v[140:143], v[28:31]
    v_mul_f32_dpp v164, v92, v60 row_newbcast:14 row_mask:0xf bank_mask:0xf
    v_cvt_pk_bf16_f32 v195, v174, v175 clamp
    v_mfma_f32_16x16x32_bf16 v[180:183], a[120:123], v[136:139], v[180:183]
    v_add_f32 v237, v237, v230
    v_mul_f32_dpp v165, v93, v61 row_newbcast:14 row_mask:0xf bank_mask:0xf
    v_mfma_f32_16x16x32_bf16 v[180:183], a[116:119], v[132:135], v[180:183]
    v_cvt_pk_bf16_f32 v158, v164, v165
    v_mul_f32_dpp v166, v94, v62 row_newbcast:14 row_mask:0xf bank_mask:0xf
    v_mfma_f32_16x16x32_bf16 v[180:183], a[112:115], v[128:131], v[180:183]
    v_mul_f32_dpp v167, v95, v63 row_newbcast:14 row_mask:0xf bank_mask:0xf
    v_cvt_pk_bf16_f32 v159, v166, v167
    v_mfma_f32_16x16x32_bf16 v[168:171], a[0:3], v[144:147], v[0:3]
    v_cvt_pk_bf16_f32 v196, v176, v177 clamp
    v_cvt_pk_bf16_f32 v197, v178, v179 clamp
    v_mfma_f32_16x16x32_bf16 v[168:171], a[4:7], v[148:151], v[168:171]
    v_permlane32_swap_b32 v236, v237
    v_mfma_f32_16x16x32_bf16 v[168:171], a[8:11], v[152:155], v[168:171]
    v_mul_f32 v160, v64, v96
    v_mul_f32 v161, v65, v97
    v_mfma_f32_16x16x32_bf16 v[168:171], a[12:15], v[156:159], v[168:171]
    v_cvt_pk_bf16_f32 v128, v160, v161
    v_cvt_pk_bf16_f32 v198, v180, v181 clamp
    v_mfma_f32_16x16x32_bf16 v[172:175], a[28:31], v[156:159], v[4:7]
    v_mul_f32 v162, v66, v98
    v_mul_f32 v163, v67, v99
    v_mfma_f32_16x16x32_bf16 v[172:175], a[24:27], v[152:155], v[172:175]
    v_cvt_pk_bf16_f32 v199, v182, v183 clamp
    v_cvt_pk_bf16_f32 v129, v162, v163
    v_mfma_f32_16x16x32_bf16 v[172:175], a[20:23], v[148:151], v[172:175]
    v_mul_f32 v164, v68, v100
    v_mul_f32 v165, v69, v101
    v_mfma_f32_16x16x32_bf16 v[172:175], a[16:19], v[144:147], v[172:175]
    v_cvt_pk_bf16_f32 v130, v164, v165
    v_cvt_pk_bf16_f32 v184, v168, v169 clamp
    v_mfma_f32_16x16x32_bf16 v[176:179], a[32:35], v[144:147], v[8:11]
    v_mul_f32 v166, v70, v102
    v_mul_f32 v167, v71, v103
    v_mfma_f32_16x16x32_bf16 v[176:179], a[36:39], v[148:151], v[176:179]
    v_add_f32 v239, v236, v237
    v_cvt_pk_bf16_f32 v185, v170, v171 clamp
    v_mfma_f32_16x16x32_bf16 v[176:179], a[40:43], v[152:155], v[176:179]
    v_cvt_pk_bf16_f32 v131, v166, v167
    v_mul_f32 v160, v72, v104
    v_mfma_f32_16x16x32_bf16 v[176:179], a[44:47], v[156:159], v[176:179]
    v_mul_f32 v161, v73, v105
    v_cvt_pk_bf16_f32 v132, v160, v161
    v_mfma_f32_16x16x32_bf16 v[180:183], a[60:63], v[156:159], v[12:15]
    v_mul_f32 v162, v74, v106
    v_cvt_pk_bf16_f32 v186, v172, v173 clamp
    v_mfma_f32_16x16x32_bf16 v[180:183], a[56:59], v[152:155], v[180:183]
    v_mul_f32 v163, v75, v107
    v_cvt_pk_bf16_f32 v187, v174, v175 clamp
    v_mfma_f32_16x16x32_bf16 v[180:183], a[52:55], v[148:151], v[180:183]
    v_cvt_pk_bf16_f32 v133, v162, v163
    v_mul_f32 v164, v76, v108
    v_mfma_f32_16x16x32_bf16 v[180:183], a[48:51], v[144:147], v[180:183]
    v_mul_f32 v165, v77, v109
    v_cvt_pk_bf16_f32 v134, v164, v165
    v_mfma_f32_16x16x32_bf16 v[168:171], a[64:67], v[144:147], v[16:19]
    v_mul_f32 v166, v78, v110
    v_cvt_pk_bf16_f32 v188, v176, v177 clamp
    v_mfma_f32_16x16x32_bf16 v[168:171], a[68:71], v[148:151], v[168:171]
    v_mul_f32 v167, v79, v111
    v_cvt_pk_bf16_f32 v189, v178, v179 clamp
    v_mfma_f32_16x16x32_bf16 v[168:171], a[72:75], v[152:155], v[168:171]
    v_cvt_pk_bf16_f32 v135, v166, v167
    v_mul_f32 v160, v80, v112
    v_mfma_f32_16x16x32_bf16 v[168:171], a[76:79], v[156:159], v[168:171]
    v_mul_f32 v161, v81, v113
    v_cvt_pk_bf16_f32 v136, v160, v161
    v_mfma_f32_16x16x32_bf16 v[172:175], a[92:95], v[156:159], v[20:23]
    v_mul_f32 v162, v82, v114
    v_cvt_pk_bf16_f32 v190, v180, v181 clamp
    v_mfma_f32_16x16x32_bf16 v[172:175], a[88:91], v[152:155], v[172:175]
    v_mul_f32 v163, v83, v115
    v_cvt_pk_bf16_f32 v191, v182, v183 clamp
    v_mfma_f32_16x16x32_bf16 v[172:175], a[84:87], v[148:151], v[172:175]
    v_cvt_pk_bf16_f32 v137, v162, v163
    v_mul_f32 v164, v84, v116
    v_mfma_f32_16x16x32_bf16 v[172:175], a[80:83], v[144:147], v[172:175]
    v_mul_f32 v165, v85, v117
    v_cvt_pk_bf16_f32 v138, v164, v165
    v_smfmac_f32_16x16x64_bf16 v[208:211], a[148:151], v[192:199], v233
    v_mul_f32 v166, v86, v118
    v_smfmac_f32_16x16x64_bf16 v[208:211], a[152:155], v[184:191], v233
    v_cvt_pk_bf16_f32 v192, v168, v169 clamp
    v_mfma_f32_16x16x32_bf16 v[176:179], a[96:99], v[144:147], v[24:27]
    v_mul_f32 v167, v87, v119
    v_cvt_pk_bf16_f32 v193, v170, v171 clamp
    v_mfma_f32_16x16x32_bf16 v[176:179], a[100:103], v[148:151], v[176:179]
    v_cvt_pk_bf16_f32 v139, v166, v167
    v_mul_f32 v160, v88, v120
    v_mfma_f32_16x16x32_bf16 v[176:179], a[104:107], v[152:155], v[176:179]
    v_mul_f32 v161, v89, v121
    v_cvt_pk_bf16_f32 v140, v160, v161
    v_mfma_f32_16x16x32_bf16 v[176:179], a[108:111], v[156:159], v[176:179]
    v_mul_f32 v162, v90, v122
    v_cvt_pk_bf16_f32 v194, v172, v173 clamp
    v_mfma_f32_16x16x32_bf16 v[180:183], a[124:127], v[156:159], v[28:31]
    v_mul_f32 v163, v91, v123
    v_cvt_pk_bf16_f32 v195, v174, v175 clamp
    v_mfma_f32_16x16x32_bf16 v[180:183], a[120:123], v[152:155], v[180:183]
    v_cvt_pk_bf16_f32 v141, v162, v163
    v_mul_f32 v164, v92, v124
    v_mfma_f32_16x16x32_bf16 v[180:183], a[116:119], v[148:151], v[180:183]
    v_mul_f32 v165, v93, v125
    v_cvt_pk_bf16_f32 v142, v164, v165
    v_mfma_f32_16x16x32_bf16 v[180:183], a[112:115], v[144:147], v[180:183]
    v_mul_f32 v166, v94, v126
    v_mul_f32 v167, v95, v127
    v_mfma_f32_16x16x32_bf16 v[168:171], a[0:3], v[128:131], v[0:3]
    v_cvt_pk_bf16_f32 v143, v166, v167
    v_cvt_pk_bf16_f32 v196, v176, v177 clamp
    v_mfma_f32_16x16x32_bf16 v[168:171], a[4:7], v[132:135], v[168:171]
    v_cvt_pk_bf16_f32 v197, v178, v179 clamp
    v_mul_f32_dpp v160, v64, v96 quad_perm:[1,0,3,2] row_mask:0xf bank_mask:0xf
    v_mfma_f32_16x16x32_bf16 v[168:171], a[8:11], v[136:139], v[168:171]
    v_mul_f32_dpp v161, v65, v97 quad_perm:[1,0,3,2] row_mask:0xf bank_mask:0xf
    v_cvt_pk_bf16_f32 v144, v160, v161
    v_mfma_f32_16x16x32_bf16 v[168:171], a[12:15], v[140:143], v[168:171]
    v_cvt_pk_bf16_f32 v198, v180, v181 clamp
    v_mul_f32_dpp v162, v66, v98 quad_perm:[1,0,3,2] row_mask:0xf bank_mask:0xf
    v_mfma_f32_16x16x32_bf16 v[172:175], a[28:31], v[140:143], v[4:7]
    v_mul_f32_dpp v163, v67, v99 quad_perm:[1,0,3,2] row_mask:0xf bank_mask:0xf
    v_cvt_pk_bf16_f32 v199, v182, v183 clamp
    v_mfma_f32_16x16x32_bf16 v[172:175], a[24:27], v[136:139], v[172:175]
    v_cvt_pk_bf16_f32 v145, v162, v163
    v_mul_f32_dpp v164, v68, v100 quad_perm:[1,0,3,2] row_mask:0xf bank_mask:0xf
    v_mfma_f32_16x16x32_bf16 v[172:175], a[20:23], v[132:135], v[172:175]
    v_mul_f32_dpp v165, v69, v101 quad_perm:[1,0,3,2] row_mask:0xf bank_mask:0xf
    v_cvt_pk_bf16_f32 v146, v164, v165
    v_mfma_f32_16x16x32_bf16 v[172:175], a[16:19], v[128:131], v[172:175]
    v_cvt_pk_bf16_f32 v184, v168, v169 clamp
    v_mul_f32_dpp v166, v70, v102 quad_perm:[1,0,3,2] row_mask:0xf bank_mask:0xf
    v_mfma_f32_16x16x32_bf16 v[176:179], a[32:35], v[128:131], v[8:11]
    v_cvt_pk_bf16_f32 v185, v170, v171 clamp
    v_mul_f32_dpp v167, v71, v103 quad_perm:[1,0,3,2] row_mask:0xf bank_mask:0xf
    v_mfma_f32_16x16x32_bf16 v[176:179], a[36:39], v[132:135], v[176:179]
    v_cvt_pk_bf16_f32 v147, v166, v167
    v_mul_f32_dpp v160, v72, v104 quad_perm:[1,0,3,2] row_mask:0xf bank_mask:0xf
    v_mfma_f32_16x16x32_bf16 v[176:179], a[40:43], v[136:139], v[176:179]
    v_mul_f32_dpp v161, v73, v105 quad_perm:[1,0,3,2] row_mask:0xf bank_mask:0xf
    v_cvt_pk_bf16_f32 v186, v172, v173 clamp
    v_mfma_f32_16x16x32_bf16 v[176:179], a[44:47], v[140:143], v[176:179]
    v_cvt_pk_bf16_f32 v148, v160, v161
    v_mul_f32_dpp v162, v74, v106 quad_perm:[1,0,3,2] row_mask:0xf bank_mask:0xf
    v_mfma_f32_16x16x32_bf16 v[180:183], a[60:63], v[140:143], v[12:15]
    v_cvt_pk_bf16_f32 v187, v174, v175 clamp
    v_mul_f32_dpp v163, v75, v107 quad_perm:[1,0,3,2] row_mask:0xf bank_mask:0xf
    v_mfma_f32_16x16x32_bf16 v[180:183], a[56:59], v[136:139], v[180:183]
    v_cvt_pk_bf16_f32 v149, v162, v163
    v_mul_f32_dpp v164, v76, v108 quad_perm:[1,0,3,2] row_mask:0xf bank_mask:0xf
    v_mfma_f32_16x16x32_bf16 v[180:183], a[52:55], v[132:135], v[180:183]
    v_mul_f32_dpp v165, v77, v109 quad_perm:[1,0,3,2] row_mask:0xf bank_mask:0xf
    v_cvt_pk_bf16_f32 v188, v176, v177 clamp
    v_mfma_f32_16x16x32_bf16 v[180:183], a[48:51], v[128:131], v[180:183]
    v_cvt_pk_bf16_f32 v150, v164, v165
    v_cvt_pk_bf16_f32 v189, v178, v179 clamp
    v_mfma_f32_16x16x32_bf16 v[168:171], a[64:67], v[128:131], v[16:19]
    v_mul_f32_dpp v166, v78, v110 quad_perm:[1,0,3,2] row_mask:0xf bank_mask:0xf
    v_mul_f32_dpp v167, v79, v111 quad_perm:[1,0,3,2] row_mask:0xf bank_mask:0xf
    v_mfma_f32_16x16x32_bf16 v[168:171], a[68:71], v[132:135], v[168:171]
    v_cvt_pk_bf16_f32 v151, v166, v167
    v_mul_f32_dpp v160, v80, v112 quad_perm:[1,0,3,2] row_mask:0xf bank_mask:0xf
    v_mfma_f32_16x16x32_bf16 v[168:171], a[72:75], v[136:139], v[168:171]
    v_cvt_pk_bf16_f32 v190, v180, v181 clamp
    v_mul_f32_dpp v161, v81, v113 quad_perm:[1,0,3,2] row_mask:0xf bank_mask:0xf
    v_mfma_f32_16x16x32_bf16 v[168:171], a[76:79], v[140:143], v[168:171]
    v_cvt_pk_bf16_f32 v152, v160, v161
    v_cvt_pk_bf16_f32 v191, v182, v183 clamp
    v_mfma_f32_16x16x32_bf16 v[172:175], a[92:95], v[140:143], v[20:23]
    v_mul_f32_dpp v162, v82, v114 quad_perm:[1,0,3,2] row_mask:0xf bank_mask:0xf
    v_mul_f32_dpp v163, v83, v115 quad_perm:[1,0,3,2] row_mask:0xf bank_mask:0xf
    v_mfma_f32_16x16x32_bf16 v[172:175], a[88:91], v[136:139], v[172:175]
    v_cvt_pk_bf16_f32 v153, v162, v163
    v_mul_f32_dpp v164, v84, v116 quad_perm:[1,0,3,2] row_mask:0xf bank_mask:0xf
    v_mfma_f32_16x16x32_bf16 v[172:175], a[84:87], v[132:135], v[172:175]
    v_mul_f32_dpp v165, v85, v117 quad_perm:[1,0,3,2] row_mask:0xf bank_mask:0xf
    v_cvt_pk_bf16_f32 v154, v164, v165
    v_mfma_f32_16x16x32_bf16 v[172:175], a[80:83], v[128:131], v[172:175]
    v_mul_f32_dpp v166, v86, v118 quad_perm:[1,0,3,2] row_mask:0xf bank_mask:0xf
    v_mul_f32_dpp v167, v87, v119 quad_perm:[1,0,3,2] row_mask:0xf bank_mask:0xf
    v_mfma_f32_4x4x4_16b_bf16 v[200:203], a[204:205], v[128:129], v[212:215]
    v_cvt_pk_bf16_f32 v155, v166, v167
    v_mul_f32_dpp v160, v88, v120 quad_perm:[1,0,3,2] row_mask:0xf bank_mask:0xf
    v_mul_f32_dpp v161, v89, v121 quad_perm:[1,0,3,2] row_mask:0xf bank_mask:0xf
    v_smfmac_f32_16x16x64_bf16 v[208:211], a[156:159], v[192:199], v233
    v_cvt_pk_bf16_f32 v192, v168, v169 clamp
    v_smfmac_f32_16x16x64_bf16 v[200:203], a[160:163], v[128:135], v233
    v_cvt_pk_bf16_f32 v193, v170, v171 clamp
    v_smfmac_f32_16x16x64_bf16 v[200:203], a[164:167], v[136:143], v233
    v_cvt_pk_bf16_f32 v194, v172, v173 clamp
    v_smfmac_f32_16x16x64_bf16 v[200:203], a[128:131], v[184:191], v233
    v_cvt_pk_bf16_f32 v195, v174, v175 clamp
    v_mfma_f32_16x16x32_bf16 v[176:179], a[96:99], v[128:131], v[24:27]
    v_cvt_pk_bf16_f32 v156, v160, v161
    v_mul_f32_dpp v162, v90, v122 quad_perm:[1,0,3,2] row_mask:0xf bank_mask:0xf
    v_mfma_f32_16x16x32_bf16 v[176:179], a[100:103], v[132:135], v[176:179]
    v_mul_f32_dpp v163, v91, v123 quad_perm:[1,0,3,2] row_mask:0xf bank_mask:0xf
    v_cvt_pk_bf16_f32 v157, v162, v163
    v_mfma_f32_16x16x32_bf16 v[176:179], a[104:107], v[136:139], v[176:179]
    v_add_f32 v227, v208, v209
    v_mul_f32_dpp v164, v92, v124 quad_perm:[1,0,3,2] row_mask:0xf bank_mask:0xf
    v_mfma_f32_16x16x32_bf16 v[176:179], a[108:111], v[140:143], v[176:179]
    v_mul_f32_dpp v165, v93, v125 quad_perm:[1,0,3,2] row_mask:0xf bank_mask:0xf
    v_cvt_pk_bf16_f32 v158, v164, v165
    v_mfma_f32_16x16x32_bf16 v[180:183], a[124:127], v[140:143], v[28:31]
    v_mul_f32_dpp v166, v94, v126 quad_perm:[1,0,3,2] row_mask:0xf bank_mask:0xf
    v_mul_f32_dpp v167, v95, v127 quad_perm:[1,0,3,2] row_mask:0xf bank_mask:0xf
    v_mfma_f32_16x16x32_bf16 v[180:183], a[120:123], v[136:139], v[180:183]
    v_cvt_pk_bf16_f32 v159, v166, v167
L_pad2:
    s_cbranch_vccnz L_pad6
    v_mul_f32_dpp v160, v64, v96 quad_perm:[2,3,0,1] row_mask:0xf bank_mask:0xf
    v_mfma_f32_16x16x32_bf16 v[180:183], a[116:119], v[132:135], v[180:183]
    v_cvt_pk_bf16_f32 v196, v176, v177 clamp
    v_cvt_pk_bf16_f32 v197, v178, v179 clamp
    v_mfma_f32_16x16x32_bf16 v[180:183], a[112:115], v[128:131], v[180:183]
    v_mul_f32_dpp v161, v65, v97 quad_perm:[2,3,0,1] row_mask:0xf bank_mask:0xf
    v_cvt_pk_bf16_f32 v128, v160, v161
    v_mfma_f32_16x16x32_bf16 v[168:171], a[0:3], v[144:147], v[0:3]
    v_mul_f32_dpp v162, v66, v98 quad_perm:[2,3,0,1] row_mask:0xf bank_mask:0xf
    v_mul_f32_dpp v163, v67, v99 quad_perm:[2,3,0,1] row_mask:0xf bank_mask:0xf
    v_mfma_f32_16x16x32_bf16 v[168:171], a[4:7], v[148:151], v[168:171]
    v_cvt_pk_bf16_f32 v129, v162, v163
    v_mul_f32_dpp v164, v68, v100 quad_perm:[2,3,0,1] row_mask:0xf bank_mask:0xf
    v_mfma_f32_16x16x32_bf16 v[168:171], a[8:11], v[152:155], v[168:171]
    v_cvt_pk_bf16_f32 v198, v180, v181 clamp
    v_cvt_pk_bf16_f32 v199, v182, v183 clamp
    v_mfma_f32_16x16x32_bf16 v[168:171], a[12:15], v[156:159], v[168:171]
    v_mul_f32_dpp v165, v69, v101 quad_perm:[2,3,0,1] row_mask:0xf bank_mask:0xf
    v_cvt_pk_bf16_f32 v130, v164, v165
    v_mfma_f32_16x16x32_bf16 v[172:175], a[28:31], v[156:159], v[4:7]
    v_mul_f32_dpp v166, v70, v102 quad_perm:[2,3,0,1] row_mask:0xf bank_mask:0xf
    v_mul_f32_dpp v167, v71, v103 quad_perm:[2,3,0,1] row_mask:0xf bank_mask:0xf
    v_mfma_f32_16x16x32_bf16 v[172:175], a[24:27], v[152:155], v[172:175]
    v_cvt_pk_bf16_f32 v131, v166, v167
    v_mul_f32_dpp v160, v72, v104 quad_perm:[2,3,0,1] row_mask:0xf bank_mask:0xf
    v_mfma_f32_16x16x32_bf16 v[172:175], a[20:23], v[148:151], v[172:175]
    v_cvt_pk_bf16_f32 v184, v168, v169 clamp
    v_cvt_pk_bf16_f32 v185, v170, v171 clamp
    v_mfma_f32_16x16x32_bf16 v[172:175], a[16:19], v[144:147], v[172:175]
    v_mul_f32_dpp v161, v73, v105 quad_perm:[2,3,0,1] row_mask:0xf bank_mask:0xf
    v_cvt_pk_bf16_f32 v132, v160, v161
    v_mfma_f32_16x16x32_bf16 v[176:179], a[32:35], v[144:147], v[8:11]
    v_mul_f32_dpp v162, v74, v106 quad_perm:[2,3,0,1] row_mask:0xf bank_mask:0xf
    v_mul_f32_dpp v163, v75, v107 quad_perm:[2,3,0,1] row_mask:0xf bank_mask:0xf
    v_mfma_f32_16x16x32_bf16 v[176:179], a[36:39], v[148:151], v[176:179]
    v_cvt_pk_bf16_f32 v133, v162, v163
    v_mul_f32_dpp v164, v76, v108 quad_perm:[2,3,0,1] row_mask:0xf bank_mask:0xf
    v_mfma_f32_16x16x32_bf16 v[176:179], a[40:43], v[152:155], v[176:179]
    v_cvt_pk_bf16_f32 v186, v172, v173 clamp
    v_cvt_pk_bf16_f32 v187, v174, v175 clamp
    v_mfma_f32_16x16x32_bf16 v[176:179], a[44:47], v[156:159], v[176:179]
    v_mul_f32_dpp v165, v77, v109 quad_perm:[2,3,0,1] row_mask:0xf bank_mask:0xf
    v_cvt_pk_bf16_f32 v134, v164, v165
    v_mfma_f32_16x16x32_bf16 v[180:183], a[60:63], v[156:159], v[12:15]
    v_mul_f32_dpp v166, v78, v110 quad_perm:[2,3,0,1] row_mask:0xf bank_mask:0xf
    v_mul_f32_dpp v167, v79, v111 quad_perm:[2,3,0,1] row_mask:0xf bank_mask:0xf
    v_mfma_f32_16x16x32_bf16 v[180:183], a[56:59], v[152:155], v[180:183]
    v_cvt_pk_bf16_f32 v135, v166, v167
    v_mul_f32_dpp v160, v80, v112 quad_perm:[2,3,0,1] row_mask:0xf bank_mask:0xf
    v_mfma_f32_16x16x32_bf16 v[180:183], a[52:55], v[148:151], v[180:183]
    v_cvt_pk_bf16_f32 v188, v176, v177 clamp
    v_cvt_pk_bf16_f32 v189, v178, v179 clamp
    v_mfma_f32_16x16x32_bf16 v[180:183], a[48:51], v[144:147], v[180:183]
    v_mul_f32_dpp v161, v81, v113 quad_perm:[2,3,0,1] row_mask:0xf bank_mask:0xf
    v_cvt_pk_bf16_f32 v136, v160, v161
    v_mfma_f32_16x16x32_bf16 v[168:171], a[64:67], v[144:147], v[16:19]
    v_mul_f32_dpp v162, v82, v114 quad_perm:[2,3,0,1] row_mask:0xf bank_mask:0xf
    v_mul_f32_dpp v163, v83, v115 quad_perm:[2,3,0,1] row_mask:0xf bank_mask:0xf
    v_mfma_f32_16x16x32_bf16 v[168:171], a[68:71], v[148:151], v[168:171]
    v_cvt_pk_bf16_f32 v137, v162, v163
    v_mul_f32_dpp v164, v84, v116 quad_perm:[2,3,0,1] row_mask:0xf bank_mask:0xf
    v_mfma_f32_16x16x32_bf16 v[168:171], a[72:75], v[152:155], v[168:171]
    v_cvt_pk_bf16_f32 v190, v180, v181 clamp
    v_cvt_pk_bf16_f32 v191, v182, v183 clamp
    v_mfma_f32_16x16x32_bf16 v[168:171], a[76:79], v[156:159], v[168:171]
    v_mul_f32_dpp v165, v85, v117 quad_perm:[2,3,0,1] row_mask:0xf bank_mask:0xf
    v_cvt_pk_bf16_f32 v138, v164, v165
    v_mfma_f32_16x16x32_bf16 v[172:175], a[92:95], v[156:159], v[20:23]
    v_mul_f32_dpp v166, v86, v118 quad_perm:[2,3,0,1] row_mask:0xf bank_mask:0xf
    v_mul_f32_dpp v167, v87, v119 quad_perm:[2,3,0,1] row_mask:0xf bank_mask:0xf
    v_mfma_f32_16x16x32_bf16 v[172:175], a[88:91], v[152:155], v[172:175]
    v_cvt_pk_bf16_f32 v139, v166, v167
    v_mul_f32_dpp v160, v88, v120 quad_perm:[2,3,0,1] row_mask:0xf bank_mask:0xf
    v_mfma_f32_16x16x32_bf16 v[172:175], a[84:87], v[148:151], v[172:175]
    v_mul_f32_dpp v161, v89, v121 quad_perm:[2,3,0,1] row_mask:0xf bank_mask:0xf
    v_cvt_pk_bf16_f32 v140, v160, v161
    v_mfma_f32_16x16x32_bf16 v[172:175], a[80:83], v[144:147], v[172:175]
    v_mul_f32_dpp v162, v90, v122 quad_perm:[2,3,0,1] row_mask:0xf bank_mask:0xf
    v_mul_f32_dpp v163, v91, v123 quad_perm:[2,3,0,1] row_mask:0xf bank_mask:0xf
    v_smfmac_f32_16x16x64_bf16 v[200:203], a[132:135], v[192:199], v233
    v_cvt_pk_bf16_f32 v192, v168, v169 clamp
    v_smfmac_f32_16x16x64_bf16 v[200:203], a[168:171], v[144:151], v233
    v_cvt_pk_bf16_f32 v193, v170, v171 clamp
    v_smfmac_f32_16x16x64_bf16 v[200:203], a[172:175], v[152:159], v233
    v_cvt_pk_bf16_f32 v141, v162, v163
    v_smfmac_f32_16x16x64_bf16 v[200:203], a[136:139], v[184:191], v233
    v_cvt_pk_bf16_f32 v194, v172, v173 clamp
    v_mfma_f32_16x16x32_bf16 v[176:179], a[96:99], v[144:147], v[24:27]
    v_cvt_pk_bf16_f32 v195, v174, v175 clamp
    v_mul_f32_dpp v164, v92, v124 quad_perm:[2,3,0,1] row_mask:0xf bank_mask:0xf
    v_mfma_f32_16x16x32_bf16 v[176:179], a[100:103], v[148:151], v[176:179]
    v_mul_f32_dpp v165, v93, v125 quad_perm:[2,3,0,1] row_mask:0xf bank_mask:0xf
    v_cvt_pk_bf16_f32 v142, v164, v165
    v_mfma_f32_16x16x32_bf16 v[176:179], a[104:107], v[152:155], v[176:179]
    v_mul_f32_dpp v166, v94, v126 quad_perm:[2,3,0,1] row_mask:0xf bank_mask:0xf
    v_mul_f32_dpp v167, v95, v127 quad_perm:[2,3,0,1] row_mask:0xf bank_mask:0xf
    v_mfma_f32_16x16x32_bf16 v[176:179], a[108:111], v[156:159], v[176:179]
    v_cvt_pk_bf16_f32 v143, v166, v167
    v_mul_f32_dpp v160, v64, v32 row_newbcast:15 row_mask:0xf bank_mask:0xf
    v_mfma_f32_16x16x32_bf16 v[180:183], a[124:127], v[156:159], v[28:31]
    v_mul_f32_dpp v161, v65, v33 row_newbcast:15 row_mask:0xf bank_mask:0xf
    v_mul_f32_dpp v162, v66, v34 row_newbcast:15 row_mask:0xf bank_mask:0xf
    v_mfma_f32_16x16x32_bf16 v[180:183], a[120:123], v[152:155], v[180:183]
    v_mul_f32_dpp v163, v67, v35 row_newbcast:15 row_mask:0xf bank_mask:0xf
    v_mul_f32_dpp v164, v68, v36 row_newbcast:15 row_mask:0xf bank_mask:0xf
    v_mfma_f32_16x16x32_bf16 v[180:183], a[116:119], v[148:151], v[180:183]
    v_cvt_pk_bf16_f32 v196, v176, v177 clamp
    v_cvt_pk_bf16_f32 v197, v178, v179 clamp
    v_mfma_f32_16x16x32_bf16 v[180:183], a[112:115], v[144:147], v[180:183]
    v_cvt_pk_bf16_f32 v144, v160, v161
    v_cvt_pk_bf16_f32 v145, v162, v163
    v_mfma_f32_16x16x32_bf16 v[168:171], a[0:3], v[128:131], v[0:3]
    v_mul_f32_dpp v165, v69, v37 row_newbcast:15 row_mask:0xf bank_mask:0xf
    v_cvt_pk_bf16_f32 v146, v164, v165
    v_mfma_f32_16x16x32_bf16 v[168:171], a[4:7], v[132:135], v[168:171]
    v_mul_f32_dpp v166, v70, v38 row_newbcast:15 row_mask:0xf bank_mask:0xf
    v_mul_f32_dpp v167, v71, v39 row_newbcast:15 row_mask:0xf bank_mask:0xf
    v_mfma_f32_16x16x32_bf16 v[168:171], a[8:11], v[136:139], v[168:171]
    v_cvt_pk_bf16_f32 v198, v180, v181 clamp
    v_cvt_pk_bf16_f32 v199, v182, v183 clamp
    v_mfma_f32_16x16x32_bf16 v[168:171], a[12:15], v[140:143], v[168:171]
    s_waitcnt vmcnt(0)
    v_lshl_add_u32 v245, v245, 8, v251
    v_mfma_f32_16x16x32_bf16 v[172:175], a[28:31], v[140:143], v[4:7]
    v_cvt_pk_bf16_f32 v147, v166, v167
    v_mul_f32_dpp v160, v72, v40 row_newbcast:15 row_mask:0xf bank_mask:0xf
    v_mfma_f32_16x16x32_bf16 v[172:175], a[24:27], v[136:139], v[172:175]
    v_lshl_add_u32 v246, v246, 8, v251
    v_mul_f32_dpp v161, v73, v41 row_newbcast:15 row_mask:0xf bank_mask:0xf
    v_mfma_f32_16x16x32_bf16 v[172:175], a[20:23], v[132:135], v[172:175]
    v_cvt_pk_bf16_f32 v184, v168, v169 clamp
    v_cvt_pk_bf16_f32 v185, v170, v171 clamp
    v_mfma_f32_16x16x32_bf16 v[172:175], a[16:19], v[128:131], v[172:175]
    v_cvt_pk_bf16_f32 v148, v160, v161
    v_mul_f32_dpp v162, v74, v42 row_newbcast:15 row_mask:0xf bank_mask:0xf
    v_mfma_f32_16x16x32_bf16 v[176:179], a[32:35], v[128:131], v[8:11]
    v_lshl_add_u32 v247, v247, 8, v251
    v_mul_f32_dpp v163, v75, v43 row_newbcast:15 row_mask:0xf bank_mask:0xf
    v_mfma_f32_16x16x32_bf16 v[176:179], a[36:39], v[132:135], v[176:179]
    v_cvt_pk_bf16_f32 v149, v162, v163
    v_mul_f32_dpp v164, v76, v44 row_newbcast:15 row_mask:0xf bank_mask:0xf
    v_mfma_f32_16x16x32_bf16 v[176:179], a[40:43], v[136:139], v[176:179]
    v_cvt_pk_bf16_f32 v186, v172, v173 clamp
    v_cvt_pk_bf16_f32 v187, v174, v175 clamp
    v_mfma_f32_16x16x32_bf16 v[176:179], a[44:47], v[140:143], v[176:179]
    v_mul_f32_dpp v165, v77, v45 row_newbcast:15 row_mask:0xf bank_mask:0xf
    v_cvt_pk_bf16_f32 v150, v164, v165
    v_mfma_f32_16x16x32_bf16 v[180:183], a[60:63], v[140:143], v[12:15]
    v_mul_f32_dpp v166, v78, v46 row_newbcast:15 row_mask:0xf bank_mask:0xf
    v_mul_f32_dpp v167, v79, v47 row_newbcast:15 row_mask:0xf bank_mask:0xf
    v_mfma_f32_16x16x32_bf16 v[180:183], a[56:59], v[136:139], v[180:183]
    global_load_dwordx4 v[112:115], v245, s[6:7] offset:0
    v_mfma_f32_16x16x32_bf16 v[180:183], a[52:55], v[132:135], v[180:183]
    v_cvt_pk_bf16_f32 v188, v176, v177 clamp
    v_cvt_pk_bf16_f32 v189, v178, v179 clamp
    v_mfma_f32_16x16x32_bf16 v[180:183], a[48:51], v[128:131], v[180:183]
    v_cvt_pk_bf16_f32 v151, v166, v167
    v_mul_f32_dpp v160, v80, v48 row_newbcast:15 row_mask:0xf bank_mask:0xf
    v_mfma_f32_16x16x32_bf16 v[168:171], a[64:67], v[128:131], v[16:19]
    v_mul_f32_dpp v161, v81, v49 row_newbcast:15 row_mask:0xf bank_mask:0xf
    v_cvt_pk_bf16_f32 v152, v160, v161
    v_mfma_f32_16x16x32_bf16 v[168:171], a[68:71], v[132:135], v[168:171]
    v_mul_f32_dpp v162, v82, v50 row_newbcast:15 row_mask:0xf bank_mask:0xf
    v_mul_f32_dpp v163, v83, v51 row_newbcast:15 row_mask:0xf bank_mask:0xf
    v_mfma_f32_16x16x32_bf16 v[168:171], a[72:75], v[136:139], v[168:171]
    v_cvt_pk_bf16_f32 v190, v180, v181 clamp
    v_cvt_pk_bf16_f32 v191, v182, v183 clamp
    v_mfma_f32_16x16x32_bf16 v[168:171], a[76:79], v[140:143], v[168:171]
    v_cvt_pk_bf16_f32 v153, v162, v163
    v_mul_f32_dpp v164, v84, v52 row_newbcast:15 row_mask:0xf bank_mask:0xf
    v_mfma_f32_16x16x32_bf16 v[172:175], a[92:95], v[140:143], v[20:23]
    v_mul_f32_dpp v165, v85, v53 row_newbcast:15 row_mask:0xf bank_mask:0xf
    v_cvt_pk_bf16_f32 v154, v164, v165
    v_mfma_f32_16x16x32_bf16 v[172:175], a[88:91], v[136:139], v[172:175]
    v_mul_f32_dpp v166, v86, v54 row_newbcast:15 row_mask:0xf bank_mask:0xf
    v_mul_f32_dpp v167, v87, v55 row_newbcast:15 row_mask:0xf bank_mask:0xf
    v_mfma_f32_16x16x32_bf16 v[172:175], a[84:87], v[132:135], v[172:175]
    global_load_dwordx4 v[116:119], v245, s[6:7] offset:64
    v_mfma_f32_16x16x32_bf16 v[172:175], a[80:83], v[128:131], v[172:175]
    v_cvt_pk_bf16_f32 v155, v166, v167
    v_mul_f32_dpp v160, v88, v56 row_newbcast:15 row_mask:0xf bank_mask:0xf
    v_smfmac_f32_16x16x64_bf16 v[200:203], a[140:143], v[192:199], v233
    v_cvt_pk_bf16_f32 v192, v168, v169 clamp
    v_smfmac_f32_16x16x64_bf16 v[200:203], a[176:179], v[128:135], v233
    v_cvt_pk_bf16_f32 v193, v170, v171 clamp
    v_smfmac_f32_16x16x64_bf16 v[200:203], a[180:183], v[136:143], v233
    v_mul_f32_dpp v161, v89, v57 row_newbcast:15 row_mask:0xf bank_mask:0xf
    v_smfmac_f32_16x16x64_bf16 v[200:203], a[144:147], v[184:191], v233
    v_cvt_pk_bf16_f32 v194, v172, v173 clamp
    v_mfma_f32_16x16x32_bf16 v[176:179], a[96:99], v[128:131], v[24:27]
    v_cvt_pk_bf16_f32 v156, v160, v161
    v_cvt_pk_bf16_f32 v195, v174, v175 clamp
    v_mfma_f32_16x16x32_bf16 v[176:179], a[100:103], v[132:135], v[176:179]
    v_mul_f32_dpp v162, v90, v58 row_newbcast:15 row_mask:0xf bank_mask:0xf
    v_mul_f32_dpp v163, v91, v59 row_newbcast:15 row_mask:0xf bank_mask:0xf
    v_mfma_f32_16x16x32_bf16 v[176:179], a[104:107], v[136:139], v[176:179]
    v_cvt_pk_bf16_f32 v157, v162, v163
    v_mul_f32_dpp v164, v92, v60 row_newbcast:15 row_mask:0xf bank_mask:0xf
    v_mfma_f32_16x16x32_bf16 v[176:179], a[108:111], v[140:143], v[176:179]
    v_mul_f32_dpp v165, v93, v61 row_newbcast:15 row_mask:0xf bank_mask:0xf
    v_cvt_pk_bf16_f32 v158, v164, v165
    v_mfma_f32_16x16x32_bf16 v[180:183], a[124:127], v[140:143], v[28:31]
    global_load_dwordx4 v[120:123], v245, s[6:7] offset:128
    v_mfma_f32_16x16x32_bf16 v[180:183], a[120:123], v[136:139], v[180:183]
    v_mul_f32_dpp v166, v94, v62 row_newbcast:15 row_mask:0xf bank_mask:0xf
    v_mul_f32_dpp v167, v95, v63 row_newbcast:15 row_mask:0xf bank_mask:0xf
    v_mfma_f32_16x16x32_bf16 v[180:183], a[116:119], v[132:135], v[180:183]
    v_cvt_pk_bf16_f32 v159, v166, v167
    v_cvt_pk_bf16_f32 v196, v176, v177 clamp
    v_mfma_f32_16x16x32_bf16 v[180:183], a[112:115], v[128:131], v[180:183]
    v_cvt_pk_bf16_f32 v197, v178, v179 clamp
    v_mul_f32_dpp v160, v64, v32 row_newbcast:0 row_mask:0xf bank_mask:0xf
    v_mfma_f32_16x16x32_bf16 v[168:171], a[0:3], v[144:147], v[0:3]
    v_mul_f32_dpp v161, v65, v33 row_newbcast:0 row_mask:0xf bank_mask:0xf
    v_cvt_pk_bf16_f32 v128, v160, v161
    v_mfma_f32_16x16x32_bf16 v[168:171], a[4:7], v[148:151], v[168:171]
    v_mul_f32_dpp v162, v66, v34 row_newbcast:0 row_mask:0xf bank_mask:0xf
    v_mul_f32_dpp v163, v67, v35 row_newbcast:0 row_mask:0xf bank_mask:0xf
    v_mfma_f32_16x16x32_bf16 v[168:171], a[8:11], v[152:155], v[168:171]
    v_cvt_pk_bf16_f32 v198, v180, v181 clamp
    v_cvt_pk_bf16_f32 v199, v182, v183 clamp
    v_mfma_f32_16x16x32_bf16 v[168:171], a[12:15], v[156:159], v[168:171]
    v_cvt_pk_bf16_f32 v129, v162, v163
    v_mul_f32_dpp v164, v68, v36 row_newbcast:0 row_mask:0xf bank_mask:0xf
    v_mfma_f32_16x16x32_bf16 v[172:175], a[28:31], v[156:159], v[4:7]
    global_load_dwordx4 v[124:127], v245, s[6:7] offset:192
    v_mfma_f32_16x16x32_bf16 v[172:175], a[24:27], v[152:155], v[172:175]
    v_mul_f32_dpp v165, v69, v37 row_newbcast:0 row_mask:0xf bank_mask:0xf
    v_cvt_pk_bf16_f32 v130, v164, v165
    v_mfma_f32_16x16x32_bf16 v[172:175], a[20:23], v[148:151], v[172:175]
    v_cvt_pk_bf16_f32 v184, v168, v169 clamp
    v_mul_f32_dpp v166, v70, v38 row_newbcast:0 row_mask:0xf bank_mask:0xf
    v_mfma_f32_16x16x32_bf16 v[172:175], a[16:19], v[144:147], v[172:175]
    v_mul_f32_dpp v167, v71, v39 row_newbcast:0 row_mask:0xf bank_mask:0xf
    v_cvt_pk_bf16_f32 v185, v170, v171 clamp
    v_mfma_f32_16x16x32_bf16 v[176:179], a[32:35], v[144:147], v[8:11]
    v_cvt_pk_bf16_f32 v131, v166, v167
    v_mul_f32_dpp v160, v72, v40 row_newbcast:0 row_mask:0xf bank_mask:0xf
    v_mfma_f32_16x16x32_bf16 v[176:179], a[36:39], v[148:151], v[176:179]
    v_mul_f32_dpp v161, v73, v41 row_newbcast:0 row_mask:0xf bank_mask:0xf
    v_cvt_pk_bf16_f32 v132, v160, v161
    v_mfma_f32_16x16x32_bf16 v[176:179], a[40:43], v[152:155], v[176:179]
    v_mul_f32_dpp v162, v74, v42 row_newbcast:0 row_mask:0xf bank_mask:0xf
    v_cvt_pk_bf16_f32 v186, v172, v173 clamp
    v_mfma_f32_16x16x32_bf16 v[176:179], a[44:47], v[156:159], v[176:179]
    v_mul_f32_dpp v163, v75, v43 row_newbcast:0 row_mask:0xf bank_mask:0xf
    v_cvt_pk_bf16_f32 v187, v174, v175 clamp
    v_mfma_f32_16x16x32_bf16 v[180:183], a[60:63], v[156:159], v[12:15]
    v_cvt_pk_bf16_f32 v133, v162, v163
    v_mul_f32_dpp v164, v76, v44 row_newbcast:0 row_mask:0xf bank_mask:0xf
    v_mfma_f32_16x16x32_bf16 v[180:183], a[56:59], v[152:155], v[180:183]
    v_mul_f32_dpp v165, v77, v45 row_newbcast:0 row_mask:0xf bank_mask:0xf
    v_cvt_pk_bf16_f32 v134, v164, v165
    v_mfma_f32_16x16x32_bf16 v[180:183], a[52:55], v[148:151], v[180:183]
    v_mul_f32_dpp v166, v78, v46 row_newbcast:0 row_mask:0xf bank_mask:0xf
    v_cvt_pk_bf16_f32 v188, v176, v177 clamp
    v_mfma_f32_16x16x32_bf16 v[180:183], a[48:51], v[144:147], v[180:183]
    v_mul_f32_dpp v167, v79, v47 row_newbcast:0 row_mask:0xf bank_mask:0xf
    v_cvt_pk_bf16_f32 v189, v178, v179 clamp
    v_mfma_f32_16x16x32_bf16 v[168:171], a[64:67], v[144:147], v[16:19]
    v_cvt_pk_bf16_f32 v135, v166, v167
    v_mul_f32_dpp v160, v80, v48 row_newbcast:0 row_mask:0xf bank_mask:0xf
    v_mfma_f32_16x16x32_bf16 v[168:171], a[68:71], v[148:151], v[168:171]
    v_mul_f32_dpp v161, v81, v49 row_newbcast:0 row_mask:0xf bank_mask:0xf
    v_cvt_pk_bf16_f32 v136, v160, v161
    v_mfma_f32_16x16x32_bf16 v[168:171], a[72:75], v[152:155], v[168:171]
    v_mul_f32_dpp v162, v82, v50 row_newbcast:0 row_mask:0xf bank_mask:0xf
    v_cvt_pk_bf16_f32 v190, v180, v181 clamp
    v_mfma_f32_16x16x32_bf16 v[168:171], a[76:79], v[156:159], v[168:171]
    v_mul_f32_dpp v163, v83, v51 row_newbcast:0 row_mask:0xf bank_mask:0xf
    v_cvt_pk_bf16_f32 v191, v182, v183 clamp
    v_mfma_f32_16x16x32_bf16 v[172:175], a[92:95], v[156:159], v[20:23]
    v_cvt_pk_bf16_f32 v137, v162, v163
    v_mul_f32_dpp v164, v84, v52 row_newbcast:0 row_mask:0xf bank_mask:0xf
    v_mfma_f32_16x16x32_bf16 v[172:175], a[88:91], v[152:155], v[172:175]
    v_mul_f32_dpp v165, v85, v53 row_newbcast:0 row_mask:0xf bank_mask:0xf
    v_cvt_pk_bf16_f32 v138, v164, v165
    v_mfma_f32_16x16x32_bf16 v[172:175], a[84:87], v[148:151], v[172:175]
    v_mul_f32_dpp v166, v86, v54 row_newbcast:0 row_mask:0xf bank_mask:0xf
    v_mul_f32_dpp v167, v87, v55 row_newbcast:0 row_mask:0xf bank_mask:0xf
    v_mfma_f32_16x16x32_bf16 v[172:175], a[80:83], v[144:147], v[172:175]
    v_cvt_pk_bf16_f32 v139, v166, v167
    v_mul_f32_dpp v160, v88, v56 row_newbcast:0 row_mask:0xf bank_mask:0xf
    v_smfmac_f32_16x16x64_bf16 v[200:203], a[148:151], v[192:199], v233
    v_cvt_pk_bf16_f32 v192, v168, v169 clamp
    v_smfmac_f32_16x16x64_bf16 v[200:203], a[152:155], v[184:191], v233
    v_cvt_pk_bf16_f32 v193, v170, v171 clamp
    v_mfma_f32_16x16x32_bf16 v[176:179], a[96:99], v[144:147], v[24:27]
    v_mul_f32_dpp v161, v89, v57 row_newbcast:0 row_mask:0xf bank_mask:0xf
    v_cvt_pk_bf16_f32 v140, v160, v161
    v_mfma_f32_16x16x32_bf16 v[176:179], a[100:103], v[148:151], v[176:179]
    v_mul_f32_dpp v162, v90, v58 row_newbcast:0 row_mask:0xf bank_mask:0xf
    v_cvt_pk_bf16_f32 v194, v172, v173 clamp
    v_mfma_f32_16x16x32_bf16 v[176:179], a[104:107], v[152:155], v[176:179]
    v_mul_f32_dpp v163, v91, v59 row_newbcast:0 row_mask:0xf bank_mask:0xf
    v_cvt_pk_bf16_f32 v195, v174, v175 clamp
    v_mfma_f32_16x16x32_bf16 v[176:179], a[108:111], v[156:159], v[176:179]
    v_cvt_pk_bf16_f32 v141, v162, v163
    v_mul_f32_dpp v164, v92, v60 row_newbcast:0 row_mask:0xf bank_mask:0xf
    v_mfma_f32_16x16x32_bf16 v[180:183], a[124:127], v[156:159], v[28:31]
    v_mul_f32_dpp v165, v93, v61 row_newbcast:0 row_mask:0xf bank_mask:0xf
    v_cvt_pk_bf16_f32 v142, v164, v165
    v_mfma_f32_16x16x32_bf16 v[180:183], a[120:123], v[152:155], v[180:183]
    v_mul_f32_dpp v166, v94, v62 row_newbcast:0 row_mask:0xf bank_mask:0xf
    v_mul_f32_dpp v167, v95, v63 row_newbcast:0 row_mask:0xf bank_mask:0xf
    v_mfma_f32_16x16x32_bf16 v[180:183], a[116:119], v[148:151], v[180:183]
    v_cvt_pk_bf16_f32 v143, v166, v167
    v_cvt_pk_bf16_f32 v196, v176, v177 clamp
    v_mfma_f32_16x16x32_bf16 v[180:183], a[112:115], v[144:147], v[180:183]
    v_cvt_pk_bf16_f32 v197, v178, v179 clamp
    v_mul_f32_dpp v160, v64, v32 row_newbcast:4 row_mask:0xf bank_mask:0xf
    v_mfma_f32_16x16x32_bf16 v[168:171], a[0:3], v[128:131], v[0:3]
    v_mul_f32_dpp v161, v65, v33 row_newbcast:4 row_mask:0xf bank_mask:0xf
    v_cvt_pk_bf16_f32 v144, v160, v161
    v_mfma_f32_16x16x32_bf16 v[168:171], a[4:7], v[132:135], v[168:171]
    v_mul_f32_dpp v162, v66, v34 row_newbcast:4 row_mask:0xf bank_mask:0xf
    v_mul_f32_dpp v163, v67, v35 row_newbcast:4 row_mask:0xf bank_mask:0xf
    v_mfma_f32_16x16x32_bf16 v[168:171], a[8:11], v[136:139], v[168:171]
    v_cvt_pk_bf16_f32 v198, v180, v181 clamp
    v_cvt_pk_bf16_f32 v199, v182, v183 clamp
    v_mfma_f32_16x16x32_bf16 v[168:171], a[12:15], v[140:143], v[168:171]
    v_cvt_pk_bf16_f32 v145, v162, v163
    v_mul_f32_dpp v164, v68, v36 row_newbcast:4 row_mask:0xf bank_mask:0xf
    v_mfma_f32_16x16x32_bf16 v[172:175], a[28:31], v[140:143], v[4:7]
    v_mul_f32_dpp v165, v69, v37 row_newbcast:4 row_mask:0xf bank_mask:0xf
    v_cvt_pk_bf16_f32 v146, v164, v165
    v_mfma_f32_16x16x32_bf16 v[172:175], a[24:27], v[136:139], v[172:175]
    v_mul_f32_dpp v166, v70, v38 row_newbcast:4 row_mask:0xf bank_mask:0xf
    v_mul_f32_dpp v167, v71, v39 row_newbcast:4 row_mask:0xf bank_mask:0xf
    v_mfma_f32_16x16x32_bf16 v[172:175], a[20:23], v[132:135], v[172:175]
    v_cvt_pk_bf16_f32 v184, v168, v169 clamp
    v_cvt_pk_bf16_f32 v185, v170, v171 clamp
    v_mfma_f32_16x16x32_bf16 v[172:175], a[16:19], v[128:131], v[172:175]
    v_cvt_pk_bf16_f32 v147, v166, v167
    v_mul_f32_dpp v160, v72, v40 row_newbcast:4 row_mask:0xf bank_mask:0xf
    v_mfma_f32_16x16x32_bf16 v[176:179], a[32:35], v[128:131], v[8:11]
    v_mul_f32_dpp v161, v73, v41 row_newbcast:4 row_mask:0xf bank_mask:0xf
    v_cvt_pk_bf16_f32 v148, v160, v161
    v_mfma_f32_16x16x32_bf16 v[176:179], a[36:39], v[132:135], v[176:179]
    v_mul_f32_dpp v162, v74, v42 row_newbcast:4 row_mask:0xf bank_mask:0xf
    v_mul_f32_dpp v163, v75, v43 row_newbcast:4 row_mask:0xf bank_mask:0xf
    v_mfma_f32_16x16x32_bf16 v[176:179], a[40:43], v[136:139], v[176:179]
    v_cvt_pk_bf16_f32 v186, v172, v173 clamp
    v_mov_b32 v204, 0
    v_mfma_f32_16x16x32_bf16 v[176:179], a[44:47], v[140:143], v[176:179]
    v_cvt_pk_bf16_f32 v187, v174, v175 clamp
    v_cvt_pk_bf16_f32 v149, v162, v163
    v_mfma_f32_16x16x32_bf16 v[180:183], a[60:63], v[140:143], v[12:15]
    v_mul_f32_dpp v164, v76, v44 row_newbcast:4 row_mask:0xf bank_mask:0xf
    v_mul_f32_dpp v165, v77, v45 row_newbcast:4 row_mask:0xf bank_mask:0xf
    v_mfma_f32_16x16x32_bf16 v[180:183], a[56:59], v[136:139], v[180:183]
    v_mov_b32 v205, 0
    v_cvt_pk_bf16_f32 v150, v164, v165
    v_mfma_f32_16x16x32_bf16 v[180:183], a[52:55], v[132:135], v[180:183]
    v_mul_f32_dpp v166, v78, v46 row_newbcast:4 row_mask:0xf bank_mask:0xf
    v_cvt_pk_bf16_f32 v188, v176, v177 clamp
    v_mfma_f32_16x16x32_bf16 v[180:183], a[48:51], v[128:131], v[180:183]
    v_mul_f32_dpp v167, v79, v47 row_newbcast:4 row_mask:0xf bank_mask:0xf
    v_cvt_pk_bf16_f32 v189, v178, v179 clamp
    v_mfma_f32_16x16x32_bf16 v[168:171], a[64:67], v[128:131], v[16:19]
    v_cvt_pk_bf16_f32 v151, v166, v167
    v_mul_f32_dpp v160, v80, v48 row_newbcast:4 row_mask:0xf bank_mask:0xf
    v_mfma_f32_16x16x32_bf16 v[168:171], a[68:71], v[132:135], v[168:171]
    v_mul_f32_dpp v161, v81, v49 row_newbcast:4 row_mask:0xf bank_mask:0xf
    v_cvt_pk_bf16_f32 v152, v160, v161
    v_mfma_f32_16x16x32_bf16 v[168:171], a[72:75], v[136:139], v[168:171]
    v_mul_f32_dpp v162, v82, v50 row_newbcast:4 row_mask:0xf bank_mask:0xf
    v_cvt_pk_bf16_f32 v190, v180, v181 clamp
    v_mfma_f32_16x16x32_bf16 v[168:171], a[76:79], v[140:143], v[168:171]
    v_mul_f32_dpp v163, v83, v51 row_newbcast:4 row_mask:0xf bank_mask:0xf
    v_cvt_pk_bf16_f32 v191, v182, v183 clamp
    v_mfma_f32_16x16x32_bf16 v[172:175], a[92:95], v[140:143], v[20:23]
    v_cvt_pk_bf16_f32 v153, v162, v163
    v_mul_f32_dpp v164, v84, v52 row_newbcast:4 row_mask:0xf bank_mask:0xf
    v_mfma_f32_16x16x32_bf16 v[172:175], a[88:91], v[136:139], v[172:175]
    v_mul_f32_dpp v165, v85, v53 row_newbcast:4 row_mask:0xf bank_mask:0xf
    v_cvt_pk_bf16_f32 v154, v164, v165
    v_mfma_f32_16x16x32_bf16 v[172:175], a[84:87], v[132:135], v[172:175]
    v_mul_f32_dpp v166, v86, v54 row_newbcast:4 row_mask:0xf bank_mask:0xf
    v_mul_f32_dpp v167, v87, v55 row_newbcast:4 row_mask:0xf bank_mask:0xf
    v_mfma_f32_16x16x32_bf16 v[172:175], a[80:83], v[128:131], v[172:175]
    v_cvt_pk_bf16_f32 v155, v166, v167
    v_mul_f32_dpp v160, v88, v56 row_newbcast:4 row_mask:0xf bank_mask:0xf
    v_smfmac_f32_16x16x64_bf16 v[200:203], a[156:159], v[192:199], v233
    v_cvt_pk_bf16_f32 v192, v168, v169 clamp
    v_smfmac_f32_16x16x64_bf16 v[204:207], a[128:131], v[184:191], v233
    v_cvt_pk_bf16_f32 v193, v170, v171 clamp
    v_mfma_f32_16x16x32_bf16 v[176:179], a[96:99], v[128:131], v[24:27]
    v_mul_f32_dpp v161, v89, v57 row_newbcast:4 row_mask:0xf bank_mask:0xf
    v_cvt_pk_bf16_f32 v156, v160, v161
    v_mfma_f32_16x16x32_bf16 v[176:179], a[100:103], v[132:135], v[176:179]
    v_mul_f32_dpp v162, v90, v58 row_newbcast:4 row_mask:0xf bank_mask:0xf
    v_cvt_pk_bf16_f32 v194, v172, v173 clamp
    v_mfma_f32_16x16x32_bf16 v[176:179], a[104:107], v[136:139], v[176:179]
    v_mul_f32_dpp v163, v91, v59 row_newbcast:4 row_mask:0xf bank_mask:0xf
    v_cvt_pk_bf16_f32 v195, v174, v175 clamp
    v_mfma_f32_16x16x32_bf16 v[176:179], a[108:111], v[140:143], v[176:179]
    v_cvt_pk_bf16_f32 v157, v162, v163
    v_mul_f32_dpp v164, v92, v60 row_newbcast:4 row_mask:0xf bank_mask:0xf
    v_mfma_f32_16x16x32_bf16 v[180:183], a[124:127], v[140:143], v[28:31]
    v_mul_f32_dpp v165, v93, v61 row_newbcast:4 row_mask:0xf bank_mask:0xf
    v_add_f32 v228, v200, v201
    v_mfma_f32_16x16x32_bf16 v[180:183], a[120:123], v[136:139], v[180:183]
    v_cvt_pk_bf16_f32 v158, v164, v165
    v_mul_f32_dpp v166, v94, v62 row_newbcast:4 row_mask:0xf bank_mask:0xf
    v_mfma_f32_16x16x32_bf16 v[180:183], a[116:119], v[132:135], v[180:183]
    v_mul_f32_dpp v167, v95, v63 row_newbcast:4 row_mask:0xf bank_mask:0xf
    v_cvt_pk_bf16_f32 v159, v166, v167
    v_mfma_f32_16x16x32_bf16 v[180:183], a[112:115], v[128:131], v[180:183]
    v_add_f32 v202, v202, v203
    v_cvt_pk_bf16_f32 v196, v176, v177 clamp
    v_mfma_f32_16x16x32_bf16 v[168:171], a[0:3], v[144:147], v[0:3]
    v_cvt_pk_bf16_f32 v197, v178, v179 clamp
    v_mul_f32_dpp v160, v64, v32 row_newbcast:8 row_mask:0xf bank_mask:0xf
    v_mfma_f32_16x16x32_bf16 v[168:171], a[4:7], v[148:151], v[168:171]
    v_mul_f32_dpp v161, v65, v33 row_newbcast:8 row_mask:0xf bank_mask:0xf
    v_mul_f32_dpp v219, v202, v241 quad_perm:[0,1,2,3] row_mask:0x7 bank_mask:0xf
    v_mfma_f32_16x16x32_bf16 v[168:171], a[8:11], v[152:155], v[168:171]
    v_cvt_pk_bf16_f32 v128, v160, v161
    v_cvt_pk_bf16_f32 v198, v180, v181 clamp
    v_mfma_f32_16x16x32_bf16 v[168:171], a[12:15], v[156:159], v[168:171]
    v_mul_f32_dpp v162, v66, v34 row_newbcast:8 row_mask:0xf bank_mask:0xf
    v_mul_f32_dpp v163, v67, v35 row_newbcast:8 row_mask:0xf bank_mask:0xf
    v_mfma_f32_16x16x32_bf16 v[172:175], a[28:31], v[156:159], v[4:7]
    v_cvt_pk_bf16_f32 v199, v182, v183 clamp
    v_cvt_pk_bf16_f32 v129, v162, v163
    v_mfma_f32_16x16x32_bf16 v[172:175], a[24:27], v[152:155], v[172:175]
    v_mul_f32_dpp v164, v68, v36 row_newbcast:8 row_mask:0xf bank_mask:0xf
    v_mul_f32_dpp v165, v69, v37 row_newbcast:8 row_mask:0xf bank_mask:0xf
    v_mfma_f32_16x16x32_bf16 v[172:175], a[20:23], v[148:151], v[172:175]
    v_cvt_pk_bf16_f32 v130, v164, v165
    v_cvt_pk_bf16_f32 v184, v168, v169 clamp
    v_mfma_f32_16x16x32_bf16 v[172:175], a[16:19], v[144:147], v[172:175]
    v_mul_f32_dpp v166, v70, v38 row_newbcast:8 row_mask:0xf bank_mask:0xf
    v_mul_f32_dpp v167, v71, v39 row_newbcast:8 row_mask:0xf bank_mask:0xf
    v_mfma_f32_16x16x32_bf16 v[176:179], a[32:35], v[144:147], v[8:11]
    v_cvt_pk_bf16_f32 v185, v170, v171 clamp
    v_cvt_pk_bf16_f32 v131, v166, v167
    v_mfma_f32_16x16x32_bf16 v[176:179], a[36:39], v[148:151], v[176:179]
    v_mul_f32_dpp v160, v72, v40 row_newbcast:8 row_mask:0xf bank_mask:0xf
    v_mul_f32_dpp v161, v73, v41 row_newbcast:8 row_mask:0xf bank_mask:0xf
    v_mfma_f32_16x16x32_bf16 v[176:179], a[40:43], v[152:155], v[176:179]
    v_cvt_pk_bf16_f32 v132, v160, v161
    v_mul_f32_dpp v162, v74, v42 row_newbcast:8 row_mask:0xf bank_mask:0xf
    v_mfma_f32_16x16x32_bf16 v[176:179], a[44:47], v[156:159], v[176:179]
    v_cvt_pk_bf16_f32 v186, v172, v173 clamp
    v_mul_f32_dpp v163, v75, v43 row_newbcast:8 row_mask:0xf bank_mask:0xf
    v_mfma_f32_16x16x32_bf16 v[180:183], a[60:63], v[156:159], v[12:15]
    v_cvt_pk_bf16_f32 v187, v174, v175 clamp
    v_cvt_pk_bf16_f32 v133, v162, v163
    v_mfma_f32_16x16x32_bf16 v[180:183], a[56:59], v[152:155], v[180:183]
    v_mul_f32_dpp v164, v76, v44 row_newbcast:8 row_mask:0xf bank_mask:0xf
    v_mul_f32_dpp v165, v77, v45 row_newbcast:8 row_mask:0xf bank_mask:0xf
    v_mfma_f32_16x16x32_bf16 v[180:183], a[52:55], v[148:151], v[180:183]
    v_cvt_pk_bf16_f32 v134, v164, v165
    v_mul_f32_dpp v166, v78, v46 row_newbcast:8 row_mask:0xf bank_mask:0xf
    v_mfma_f32_16x16x32_bf16 v[180:183], a[48:51], v[144:147], v[180:183]
    v_cvt_pk_bf16_f32 v188, v176, v177 clamp
    v_mul_f32_dpp v167, v79, v47 row_newbcast:8 row_mask:0xf bank_mask:0xf
    v_mfma_f32_16x16x32_bf16 v[168:171], a[64:67], v[144:147], v[16:19]
    v_cvt_pk_bf16_f32 v189, v178, v179 clamp
    v_cvt_pk_bf16_f32 v135, v166, v167
    v_mfma_f32_16x16x32_bf16 v[168:171], a[68:71], v[148:151], v[168:171]
    v_mul_f32_dpp v160, v80, v48 row_newbcast:8 row_mask:0xf bank_mask:0xf
    v_mul_f32_dpp v161, v81, v49 row_newbcast:8 row_mask:0xf bank_mask:0xf
    v_mfma_f32_16x16x32_bf16 v[168:171], a[72:75], v[152:155], v[168:171]
    v_cvt_pk_bf16_f32 v136, v160, v161
    v_mul_f32_dpp v162, v82, v50 row_newbcast:8 row_mask:0xf bank_mask:0xf
    v_mfma_f32_16x16x32_bf16 v[168:171], a[76:79], v[156:159], v[168:171]
    v_cvt_pk_bf16_f32 v190, v180, v181 clamp
    v_mul_f32_dpp v163, v83, v51 row_newbcast:8 row_mask:0xf bank_mask:0xf
    v_mfma_f32_16x16x32_bf16 v[172:175], a[92:95], v[156:159], v[20:23]
    v_cvt_pk_bf16_f32 v191, v182, v183 clamp
    v_cvt_pk_bf16_f32 v137, v162, v163
    v_mfma_f32_16x16x32_bf16 v[172:175], a[88:91], v[152:155], v[172:175]
    v_mul_f32_dpp v164, v84, v52 row_newbcast:8 row_mask:0xf bank_mask:0xf
    v_mul_f32_dpp v165, v85, v53 row_newbcast:8 row_mask:0xf bank_mask:0xf
    v_mfma_f32_16x16x32_bf16 v[172:175], a[84:87], v[148:151], v[172:175]
    v_cvt_pk_bf16_f32 v138, v164, v165
    v_mul_f32_dpp v166, v86, v54 row_newbcast:8 row_mask:0xf bank_mask:0xf
    v_mfma_f32_16x16x32_bf16 v[172:175], a[80:83], v[144:147], v[172:175]
    v_mul_f32_dpp v167, v87, v55 row_newbcast:8 row_mask:0xf bank_mask:0xf
    v_cvt_pk_bf16_f32 v139, v166, v167
    v_smfmac_f32_16x16x64_bf16 v[204:207], a[132:135], v[192:199], v233
    v_cvt_pk_bf16_f32 v192, v168, v169 clamp
    v_smfmac_f32_16x16x64_bf16 v[204:207], a[136:139], v[184:191], v233
    v_cvt_pk_bf16_f32 v193, v170, v171 clamp
    v_mfma_f32_16x16x32_bf16 v[176:179], a[96:99], v[144:147], v[24:27]
    v_mul_f32_dpp v160, v88, v56 row_newbcast:8 row_mask:0xf bank_mask:0xf
    v_mul_f32_dpp v161, v89, v57 row_newbcast:8 row_mask:0xf bank_mask:0xf
    v_mfma_f32_16x16x32_bf16 v[176:179], a[100:103], v[148:151], v[176:179]
    v_cvt_pk_bf16_f32 v140, v160, v161
    v_mul_f32_dpp v162, v90, v58 row_newbcast:8 row_mask:0xf bank_mask:0xf
    v_mfma_f32_16x16x32_bf16 v[176:179], a[104:107], v[152:155], v[176:179]
    v_cvt_pk_bf16_f32 v194, v172, v173 clamp
    v_mul_f32_dpp v163, v91, v59 row_newbcast:8 row_mask:0xf bank_mask:0xf
    v_mfma_f32_16x16x32_bf16 v[176:179], a[108:111], v[156:159], v[176:179]
    v_cvt_pk_bf16_f32 v195, v174, v175 clamp
    v_cvt_pk_bf16_f32 v141, v162, v163
    v_mfma_f32_16x16x32_bf16 v[180:183], a[124:127], v[156:159], v[28:31]
    v_mul_f32_dpp v164, v92, v60 row_newbcast:8 row_mask:0xf bank_mask:0xf
    v_mul_f32_dpp v165, v93, v61 row_newbcast:8 row_mask:0xf bank_mask:0xf
    v_mfma_f32_16x16x32_bf16 v[180:183], a[120:123], v[152:155], v[180:183]
    v_cvt_pk_bf16_f32 v142, v164, v165
    v_mul_f32_dpp v166, v94, v62 row_newbcast:8 row_mask:0xf bank_mask:0xf
    v_mfma_f32_16x16x32_bf16 v[180:183], a[116:119], v[148:151], v[180:183]
    v_mul_f32_dpp v167, v95, v63 row_newbcast:8 row_mask:0xf bank_mask:0xf
    v_cvt_pk_bf16_f32 v143, v166, v167
    v_mfma_f32_16x16x32_bf16 v[180:183], a[112:115], v[144:147], v[180:183]
    v_cvt_pk_bf16_f32 v196, v176, v177 clamp
    v_cvt_pk_bf16_f32 v197, v178, v179 clamp
    v_mfma_f32_16x16x32_bf16 v[168:171], a[0:3], v[128:131], v[0:3]
    v_mul_f32_dpp v160, v64, v32 row_newbcast:12 row_mask:0xf bank_mask:0xf
    v_mul_f32_dpp v161, v65, v33 row_newbcast:12 row_mask:0xf bank_mask:0xf
L_pad3:
    s_cbranch_vccnz L_pad7
    v_mfma_f32_16x16x32_bf16 v[168:171], a[4:7], v[132:135], v[168:171]
    v_cvt_pk_bf16_f32 v144, v160, v161
    v_mul_f32_dpp v162, v66, v34 row_newbcast:12 row_mask:0xf bank_mask:0xf
    v_mfma_f32_16x16x32_bf16 v[168:171], a[8:11], v[136:139], v[168:171]
    v_cvt_pk_bf16_f32 v198, v180, v181 clamp
    v_mul_f32_dpp v163, v67, v35 row_newbcast:12 row_mask:0xf bank_mask:0xf
    v_mfma_f32_16x16x32_bf16 v[168:171], a[12:15], v[140:143], v[168:171]
    v_cvt_pk_bf16_f32 v199, v182, v183 clamp
    v_cvt_pk_bf16_f32 v145, v162, v163
    v_mfma_f32_16x16x32_bf16 v[172:175], a[28:31], v[140:143], v[4:7]
    v_mul_f32_dpp v164, v68, v36 row_newbcast:12 row_mask:0xf bank_mask:0xf
    v_mul_f32_dpp v165, v69, v37 row_newbcast:12 row_mask:0xf bank_mask:0xf
    v_mfma_f32_16x16x32_bf16 v[172:175], a[24:27], v[136:139], v[172:175]
    v_cvt_pk_bf16_f32 v146, v164, v165
    v_mul_f32_dpp v166, v70, v38 row_newbcast:12 row_mask:0xf bank_mask:0xf
    v_mfma_f32_16x16x32_bf16 v[172:175], a[20:23], v[132:135], v[172:175]
    v_cvt_pk_bf16_f32 v184, v168, v169 clamp
    v_mul_f32_dpp v167, v71, v39 row_newbcast:12 row_mask:0xf bank_mask:0xf
    v_mfma_f32_16x16x32_bf16 v[172:175], a[16:19], v[128:131], v[172:175]
    v_cvt_pk_bf16_f32 v185, v170, v171 clamp
    v_cvt_pk_bf16_f32 v147, v166, v167
    v_mfma_f32_16x16x32_bf16 v[176:179], a[32:35], v[128:131], v[8:11]
    v_mul_f32_dpp v160, v72, v40 row_newbcast:12 row_mask:0xf bank_mask:0xf
    v_mul_f32_dpp v161, v73, v41 row_newbcast:12 row_mask:0xf bank_mask:0xf
    v_mfma_f32_16x16x32_bf16 v[176:179], a[36:39], v[132:135], v[176:179]
    v_cvt_pk_bf16_f32 v148, v160, v161
    v_mul_f32_dpp v162, v74, v42 row_newbcast:12 row_mask:0xf bank_mask:0xf
    v_mfma_f32_16x16x32_bf16 v[176:179], a[40:43], v[136:139], v[176:179]
    v_cvt_pk_bf16_f32 v186, v172, v173 clamp
    v_mul_f32_dpp v163, v75, v43 row_newbcast:12 row_mask:0xf bank_mask:0xf
    v_mfma_f32_16x16x32_bf16 v[176:179], a[44:47], v[140:143], v[176:179]
    v_cvt_pk_bf16_f32 v187, v174, v175 clamp
    v_cvt_pk_bf16_f32 v149, v162, v163
    v_mfma_f32_16x16x32_bf16 v[180:183], a[60:63], v[140:143], v[12:15]
    v_mul_f32_dpp v164, v76, v44 row_newbcast:12 row_mask:0xf bank_mask:0xf
    v_mul_f32_dpp v165, v77, v45 row_newbcast:12 row_mask:0xf bank_mask:0xf
    v_mfma_f32_16x16x32_bf16 v[180:183], a[56:59], v[136:139], v[180:183]
    v_cvt_pk_bf16_f32 v150, v164, v165
    v_mul_f32_dpp v166, v78, v46 row_newbcast:12 row_mask:0xf bank_mask:0xf
    v_mfma_f32_16x16x32_bf16 v[180:183], a[52:55], v[132:135], v[180:183]
    v_cvt_pk_bf16_f32 v188, v176, v177 clamp
    v_mul_f32_dpp v167, v79, v47 row_newbcast:12 row_mask:0xf bank_mask:0xf
    v_mfma_f32_16x16x32_bf16 v[180:183], a[48:51], v[128:131], v[180:183]
    v_cvt_pk_bf16_f32 v189, v178, v179 clamp
    v_cvt_pk_bf16_f32 v151, v166, v167
    v_mfma_f32_16x16x32_bf16 v[168:171], a[64:67], v[128:131], v[16:19]
    v_mul_f32_dpp v160, v80, v48 row_newbcast:12 row_mask:0xf bank_mask:0xf
    v_mul_f32_dpp v161, v81, v49 row_newbcast:12 row_mask:0xf bank_mask:0xf
    v_mfma_f32_16x16x32_bf16 v[168:171], a[68:71], v[132:135], v[168:171]
    v_cvt_pk_bf16_f32 v152, v160, v161
    v_mul_f32_dpp v162, v82, v50 row_newbcast:12 row_mask:0xf bank_mask:0xf
    v_mfma_f32_16x16x32_bf16 v[168:171], a[72:75], v[136:139], v[168:171]
    v_cvt_pk_bf16_f32 v190, v180, v181 clamp
    v_mul_f32_dpp v163, v83, v51 row_newbcast:12 row_mask:0xf bank_mask:0xf
    v_mfma_f32_16x16x32_bf16 v[168:171], a[76:79], v[140:143], v[168:171]
    v_cvt_pk_bf16_f32 v191, v182, v183 clamp
    v_cvt_pk_bf16_f32 v153, v162, v163
    v_mfma_f32_16x16x32_bf16 v[172:175], a[92:95], v[140:143], v[20:23]
    v_mul_f32_dpp v164, v84, v52 row_newbcast:12 row_mask:0xf bank_mask:0xf
    v_mul_f32_dpp v165, v85, v53 row_newbcast:12 row_mask:0xf bank_mask:0xf
    v_mfma_f32_16x16x32_bf16 v[172:175], a[88:91], v[136:139], v[172:175]
    v_cvt_pk_bf16_f32 v154, v164, v165
    v_mul_f32_dpp v166, v86, v54 row_newbcast:12 row_mask:0xf bank_mask:0xf
    v_mfma_f32_16x16x32_bf16 v[172:175], a[84:87], v[132:135], v[172:175]
    v_mul_f32_dpp v167, v87, v55 row_newbcast:12 row_mask:0xf bank_mask:0xf
    v_cvt_pk_bf16_f32 v155, v166, v167
    v_mfma_f32_16x16x32_bf16 v[172:175], a[80:83], v[128:131], v[172:175]
    v_mul_f32_dpp v160, v88, v56 row_newbcast:12 row_mask:0xf bank_mask:0xf
    v_mul_f32_dpp v161, v89, v57 row_newbcast:12 row_mask:0xf bank_mask:0xf
    v_smfmac_f32_16x16x64_bf16 v[204:207], a[140:143], v[192:199], v233
    v_cvt_pk_bf16_f32 v192, v168, v169 clamp
    v_smfmac_f32_16x16x64_bf16 v[204:207], a[144:147], v[184:191], v233
    v_cvt_pk_bf16_f32 v193, v170, v171 clamp
    v_mfma_f32_16x16x32_bf16 v[176:179], a[96:99], v[128:131], v[24:27]
    v_cvt_pk_bf16_f32 v156, v160, v161
    v_mul_f32_dpp v162, v90, v58 row_newbcast:12 row_mask:0xf bank_mask:0xf
    v_mfma_f32_16x16x32_bf16 v[176:179], a[100:103], v[132:135], v[176:179]
    v_cvt_pk_bf16_f32 v194, v172, v173 clamp
    v_mul_f32_dpp v163, v91, v59 row_newbcast:12 row_mask:0xf bank_mask:0xf
    v_mfma_f32_16x16x32_bf16 v[176:179], a[104:107], v[136:139], v[176:179]
    v_cvt_pk_bf16_f32 v195, v174, v175 clamp
    v_cvt_pk_bf16_f32 v157, v162, v163
    v_mfma_f32_16x16x32_bf16 v[176:179], a[108:111], v[140:143], v[176:179]
    v_mul_f32_dpp v164, v92, v60 row_newbcast:12 row_mask:0xf bank_mask:0xf
    v_mul_f32_dpp v165, v93, v61 row_newbcast:12 row_mask:0xf bank_mask:0xf
    v_mfma_f32_16x16x32_bf16 v[180:183], a[124:127], v[140:143], v[28:31]
    v_cvt_pk_bf16_f32 v158, v164, v165
    v_mul_f32_dpp v166, v94, v62 row_newbcast:12 row_mask:0xf bank_mask:0xf
    v_mfma_f32_16x16x32_bf16 v[180:183], a[120:123], v[136:139], v[180:183]
    v_mul_f32_dpp v167, v95, v63 row_newbcast:12 row_mask:0xf bank_mask:0xf
    v_cvt_pk_bf16_f32 v159, v166, v167
    v_mfma_f32_16x16x32_bf16 v[180:183], a[116:119], v[132:135], v[180:183]
    v_cvt_pk_bf16_f32 v196, v176, v177 clamp
    v_cvt_pk_bf16_f32 v197, v178, v179 clamp
    v_mfma_f32_16x16x32_bf16 v[180:183], a[112:115], v[128:131], v[180:183]
    v_mul_f32_dpp v160, v64, v32 row_newbcast:1 row_mask:0xf bank_mask:0xf
    v_mul_f32_dpp v161, v65, v33 row_newbcast:1 row_mask:0xf bank_mask:0xf
    v_mfma_f32_16x16x32_bf16 v[168:171], a[0:3], v[144:147], v[0:3]
    v_cvt_pk_bf16_f32 v128, v160, v161
    v_mul_f32_dpp v162, v66, v34 row_newbcast:1 row_mask:0xf bank_mask:0xf
    v_mfma_f32_16x16x32_bf16 v[168:171], a[4:7], v[148:151], v[168:171]
    v_mul_f32_dpp v163, v67, v35 row_newbcast:1 row_mask:0xf bank_mask:0xf
    v_cvt_pk_bf16_f32 v129, v162, v163
    v_mfma_f32_16x16x32_bf16 v[168:171], a[8:11], v[152:155], v[168:171]
    v_cvt_pk_bf16_f32 v198, v180, v181 clamp
    v_cvt_pk_bf16_f32 v199, v182, v183 clamp
    v_mfma_f32_16x16x32_bf16 v[168:171], a[12:15], v[156:159], v[168:171]
    v_mul_f32_dpp v164, v68, v36 row_newbcast:1 row_mask:0xf bank_mask:0xf
    v_mul_f32_dpp v165, v69, v37 row_newbcast:1 row_mask:0xf bank_mask:0xf
    v_mfma_f32_16x16x32_bf16 v[172:175], a[28:31], v[156:159], v[4:7]
    v_cvt_pk_bf16_f32 v130, v164, v165
    v_mul_f32_dpp v166, v70, v38 row_newbcast:1 row_mask:0xf bank_mask:0xf
    v_mfma_f32_16x16x32_bf16 v[172:175], a[24:27], v[152:155], v[172:175]
    v_mul_f32_dpp v167, v71, v39 row_newbcast:1 row_mask:0xf bank_mask:0xf
    v_cvt_pk_bf16_f32 v131, v166, v167
    v_mfma_f32_16x16x32_bf16 v[172:175], a[20:23], v[148:151], v[172:175]
    v_cvt_pk_bf16_f32 v184, v168, v169 clamp
    v_cvt_pk_bf16_f32 v185, v170, v171 clamp
    v_mfma_f32_16x16x32_bf16 v[172:175], a[16:19], v[144:147], v[172:175]
    v_mul_f32_dpp v160, v72, v40 row_newbcast:1 row_mask:0xf bank_mask:0xf
    v_mul_f32_dpp v161, v73, v41 row_newbcast:1 row_mask:0xf bank_mask:0xf
    v_mfma_f32_16x16x32_bf16 v[176:179], a[32:35], v[144:147], v[8:11]
    v_cvt_pk_bf16_f32 v132, v160, v161
    v_mul_f32_dpp v162, v74, v42 row_newbcast:1 row_mask:0xf bank_mask:0xf
    v_mfma_f32_16x16x32_bf16 v[176:179], a[36:39], v[148:151], v[176:179]
    v_mul_f32_dpp v163, v75, v43 row_newbcast:1 row_mask:0xf bank_mask:0xf
    v_cvt_pk_bf16_f32 v133, v162, v163
    v_mfma_f32_16x16x32_bf16 v[176:179], a[40:43], v[152:155], v[176:179]
    v_cvt_pk_bf16_f32 v186, v172, v173 clamp
    v_cvt_pk_bf16_f32 v187, v174, v175 clamp
    v_mfma_f32_16x16x32_bf16 v[176:179], a[44:47], v[156:159], v[176:179]
    v_mul_f32_dpp v164, v76, v44 row_newbcast:1 row_mask:0xf bank_mask:0xf
    v_mul_f32_dpp v165, v77, v45 row_newbcast:1 row_mask:0xf bank_mask:0xf
    v_mfma_f32_16x16x32_bf16 v[180:183], a[60:63], v[156:159], v[12:15]
    v_cvt_pk_bf16_f32 v134, v164, v165
    v_mul_f32_dpp v166, v78, v46 row_newbcast:1 row_mask:0xf bank_mask:0xf
    v_mfma_f32_16x16x32_bf16 v[180:183], a[56:59], v[152:155], v[180:183]
    v_mul_f32_dpp v167, v79, v47 row_newbcast:1 row_mask:0xf bank_mask:0xf
    v_cvt_pk_bf16_f32 v135, v166, v167
    v_mfma_f32_16x16x32_bf16 v[180:183], a[52:55], v[148:151], v[180:183]
    v_cvt_pk_bf16_f32 v188, v176, v177 clamp
    v_cvt_pk_bf16_f32 v189, v178, v179 clamp
    v_mfma_f32_16x16x32_bf16 v[180:183], a[48:51], v[144:147], v[180:183]
    v_mul_f32_dpp v160, v80, v48 row_newbcast:1 row_mask:0xf bank_mask:0xf
    v_mul_f32_dpp v161, v81, v49 row_newbcast:1 row_mask:0xf bank_mask:0xf
    v_mfma_f32_16x16x32_bf16 v[168:171], a[64:67], v[144:147], v[16:19]
    v_cvt_pk_bf16_f32 v136, v160, v161
    v_mul_f32_dpp v162, v82, v50 row_newbcast:1 row_mask:0xf bank_mask:0xf
    v_mfma_f32_16x16x32_bf16 v[168:171], a[68:71], v[148:151], v[168:171]
    v_mul_f32_dpp v163, v83, v51 row_newbcast:1 row_mask:0xf bank_mask:0xf
    v_cvt_pk_bf16_f32 v137, v162, v163
    v_mfma_f32_16x16x32_bf16 v[168:171], a[72:75], v[152:155], v[168:171]
    v_cvt_pk_bf16_f32 v190, v180, v181 clamp
    v_cvt_pk_bf16_f32 v191, v182, v183 clamp
    v_mfma_f32_16x16x32_bf16 v[168:171], a[76:79], v[156:159], v[168:171]
    v_mul_f32_dpp v164, v84, v52 row_newbcast:1 row_mask:0xf bank_mask:0xf
    v_mul_f32_dpp v165, v85, v53 row_newbcast:1 row_mask:0xf bank_mask:0xf
    v_mfma_f32_16x16x32_bf16 v[172:175], a[92:95], v[156:159], v[20:23]
    v_cvt_pk_bf16_f32 v138, v164, v165
    v_mul_f32_dpp v166, v86, v54 row_newbcast:1 row_mask:0xf bank_mask:0xf
    v_mfma_f32_16x16x32_bf16 v[172:175], a[88:91], v[152:155], v[172:175]
    v_mul_f32_dpp v167, v87, v55 row_newbcast:1 row_mask:0xf bank_mask:0xf
    v_cvt_pk_bf16_f32 v139, v166, v167
    v_mfma_f32_16x16x32_bf16 v[172:175], a[84:87], v[148:151], v[172:175]
    v_mul_f32_dpp v160, v88, v56 row_newbcast:1 row_mask:0xf bank_mask:0xf
    v_mul_f32_dpp v161, v89, v57 row_newbcast:1 row_mask:0xf bank_mask:0xf
    v_mfma_f32_16x16x32_bf16 v[172:175], a[80:83], v[144:147], v[172:175]
    v_cvt_pk_bf16_f32 v140, v160, v161
    v_mul_f32_dpp v162, v90, v58 row_newbcast:1 row_mask:0xf bank_mask:0xf
    v_smfmac_f32_16x16x64_bf16 v[204:207], a[148:151], v[192:199], v233
    v_cvt_pk_bf16_f32 v192, v168, v169 clamp
    v_smfmac_f32_16x16x64_bf16 v[204:207], a[152:155], v[184:191], v233
    v_cvt_pk_bf16_f32 v193, v170, v171 clamp
    v_mfma_f32_16x16x32_bf16 v[176:179], a[96:99], v[144:147], v[24:27]
    v_mul_f32_dpp v163, v91, v59 row_newbcast:1 row_mask:0xf bank_mask:0xf
    v_cvt_pk_bf16_f32 v194, v172, v173 clamp
    v_mfma_f32_16x16x32_bf16 v[176:179], a[100:103], v[148:151], v[176:179]
    v_cvt_pk_bf16_f32 v195, v174, v175 clamp
    v_cvt_pk_bf16_f32 v141, v162, v163
    v_mfma_f32_16x16x32_bf16 v[176:179], a[104:107], v[152:155], v[176:179]
    v_mul_f32_dpp v164, v92, v60 row_newbcast:1 row_mask:0xf bank_mask:0xf
    v_mul_f32_dpp v165, v93, v61 row_newbcast:1 row_mask:0xf bank_mask:0xf
    v_mfma_f32_16x16x32_bf16 v[176:179], a[108:111], v[156:159], v[176:179]
    v_cvt_pk_bf16_f32 v142, v164, v165
    v_mul_f32_dpp v166, v94, v62 row_newbcast:1 row_mask:0xf bank_mask:0xf
    v_mfma_f32_16x16x32_bf16 v[180:183], a[124:127], v[156:159], v[28:31]
    v_mul_f32_dpp v167, v95, v63 row_newbcast:1 row_mask:0xf bank_mask:0xf
    v_cvt_pk_bf16_f32 v143, v166, v167
    v_mfma_f32_16x16x32_bf16 v[180:183], a[120:123], v[152:155], v[180:183]
    v_mul_f32_dpp v160, v64, v32 row_newbcast:5 row_mask:0xf bank_mask:0xf
    v_mul_f32_dpp v161, v65, v33 row_newbcast:5 row_mask:0xf bank_mask:0xf
    v_mfma_f32_16x16x32_bf16 v[180:183], a[116:119], v[148:151], v[180:183]
    v_cvt_pk_bf16_f32 v196, v176, v177 clamp
    v_cvt_pk_bf16_f32 v197, v178, v179 clamp
    v_mfma_f32_16x16x32_bf16 v[180:183], a[112:115], v[144:147], v[180:183]
    v_cvt_pk_bf16_f32 v144, v160, v161
    v_mul_f32_dpp v162, v66, v34 row_newbcast:5 row_mask:0xf bank_mask:0xf
    v_mfma_f32_16x16x32_bf16 v[168:171], a[0:3], v[128:131], v[0:3]
    v_mul_f32_dpp v163, v67, v35 row_newbcast:5 row_mask:0xf bank_mask:0xf
    v_cvt_pk_bf16_f32 v145, v162, v163
    v_mfma_f32_16x16x32_bf16 v[168:171], a[4:7], v[132:135], v[168:171]
    v_mul_f32_dpp v164, v68, v36 row_newbcast:5 row_mask:0xf bank_mask:0xf
    v_mul_f32_dpp v165, v69, v37 row_newbcast:5 row_mask:0xf bank_mask:0xf
    v_mfma_f32_16x16x32_bf16 v[168:171], a[8:11], v[136:139], v[168:171]
    v_cvt_pk_bf16_f32 v198, v180, v181 clamp
    v_cvt_pk_bf16_f32 v199, v182, v183 clamp
    v_mfma_f32_16x16x32_bf16 v[168:171], a[12:15], v[140:143], v[168:171]
    v_cvt_pk_bf16_f32 v146, v164, v165
    v_mul_f32_dpp v166, v70, v38 row_newbcast:5 row_mask:0xf bank_mask:0xf
    v_mfma_f32_16x16x32_bf16 v[172:175], a[28:31], v[140:143], v[4:7]
    v_mul_f32_dpp v167, v71, v39 row_newbcast:5 row_mask:0xf bank_mask:0xf
    v_cvt_pk_bf16_f32 v147, v166, v167
    v_mfma_f32_16x16x32_bf16 v[172:175], a[24:27], v[136:139], v[172:175]
    v_mul_f32_dpp v160, v72, v40 row_newbcast:5 row_mask:0xf bank_mask:0xf
    v_mul_f32_dpp v161, v73, v41 row_newbcast:5 row_mask:0xf bank_mask:0xf
    v_mfma_f32_16x16x32_bf16 v[172:175], a[20:23], v[132:135], v[172:175]
    v_cvt_pk_bf16_f32 v184, v168, v169 clamp
    v_cvt_pk_bf16_f32 v185, v170, v171 clamp
    v_mfma_f32_16x16x32_bf16 v[172:175], a[16:19], v[128:131], v[172:175]
    v_cvt_pk_bf16_f32 v148, v160, v161
    v_mul_f32_dpp v162, v74, v42 row_newbcast:5 row_mask:0xf bank_mask:0xf
    v_mfma_f32_16x16x32_bf16 v[176:179], a[32:35], v[128:131], v[8:11]
    v_mul_f32_dpp v163, v75, v43 row_newbcast:5 row_mask:0xf bank_mask:0xf
    v_mov_b32 v208, 0
    v_mfma_f32_16x16x32_bf16 v[176:179], a[36:39], v[132:135], v[176:179]
    v_cvt_pk_bf16_f32 v149, v162, v163
    v_mul_f32_dpp v164, v76, v44 row_newbcast:5 row_mask:0xf bank_mask:0xf
    v_mfma_f32_16x16x32_bf16 v[176:179], a[40:43], v[136:139], v[176:179]
    v_cvt_pk_bf16_f32 v186, v172, v173 clamp
    v_cvt_pk_bf16_f32 v187, v174, v175 clamp
    v_mfma_f32_16x16x32_bf16 v[176:179], a[44:47], v[140:143], v[176:179]
    v_mul_f32_dpp v165, v77, v45 row_newbcast:5 row_mask:0xf bank_mask:0xf
    v_mov_b32 v209, 0
    v_mfma_f32_16x16x32_bf16 v[180:183], a[60:63], v[140:143], v[12:15]
    v_cvt_pk_bf16_f32 v150, v164, v165
    v_mul_f32_dpp v166, v78, v46 row_newbcast:5 row_mask:0xf bank_mask:0xf
    v_mfma_f32_16x16x32_bf16 v[180:183], a[56:59], v[136:139], v[180:183]
    v_mul_f32_dpp v167, v79, v47 row_newbcast:5 row_mask:0xf bank_mask:0xf
    v_cvt_pk_bf16_f32 v151, v166, v167
    v_mfma_f32_16x16x32_bf16 v[180:183], a[52:55], v[132:135], v[180:183]
    v_cvt_pk_bf16_f32 v188, v176, v177 clamp
    v_cvt_pk_bf16_f32 v189, v178, v179 clamp
    v_mfma_f32_16x16x32_bf16 v[180:183], a[48:51], v[128:131], v[180:183]
    v_mul_f32_dpp v160, v80, v48 row_newbcast:5 row_mask:0xf bank_mask:0xf
    v_mul_f32_dpp v161, v81, v49 row_newbcast:5 row_mask:0xf bank_mask:0xf
    v_mfma_f32_16x16x32_bf16 v[168:171], a[64:67], v[128:131], v[16:19]
    v_cvt_pk_bf16_f32 v152, v160, v161
    v_mul_f32_dpp v162, v82, v50 row_newbcast:5 row_mask:0xf bank_mask:0xf
    v_mfma_f32_16x16x32_bf16 v[168:171], a[68:71], v[132:135], v[168:171]
    v_mul_f32_dpp v163, v83, v51 row_newbcast:5 row_mask:0xf bank_mask:0xf
    v_cvt_pk_bf16_f32 v153, v162, v163
    v_mfma_f32_16x16x32_bf16 v[168:171], a[72:75], v[136:139], v[168:171]
    v_cvt_pk_bf16_f32 v190, v180, v181 clamp
    v_cvt_pk_bf16_f32 v191, v182, v183 clamp
    v_mfma_f32_16x16x32_bf16 v[168:171], a[76:79], v[140:143], v[168:171]
    v_mul_f32_dpp v164, v84, v52 row_newbcast:5 row_mask:0xf bank_mask:0xf
    v_mul_f32_dpp v165, v85, v53 row_newbcast:5 row_mask:0xf bank_mask:0xf
    v_mfma_f32_16x16x32_bf16 v[172:175], a[92:95], v[140:143], v[20:23]
    v_cvt_pk_bf16_f32 v154, v164, v165
    v_mul_f32_dpp v166, v86, v54 row_newbcast:5 row_mask:0xf bank_mask:0xf
    v_mfma_f32_16x16x32_bf16 v[172:175], a[88:91], v[136:139], v[172:175]
    v_mul_f32_dpp v167, v87, v55 row_newbcast:5 row_mask:0xf bank_mask:0xf
    v_cvt_pk_bf16_f32 v155, v166, v167
    v_mfma_f32_16x16x32_bf16 v[172:175], a[84:87], v[132:135], v[172:175]
    v_mul_f32_dpp v160, v88, v56 row_newbcast:5 row_mask:0xf bank_mask:0xf
    v_mul_f32_dpp v161, v89, v57 row_newbcast:5 row_mask:0xf bank_mask:0xf
    v_mfma_f32_16x16x32_bf16 v[172:175], a[80:83], v[128:131], v[172:175]
    v_cvt_pk_bf16_f32 v156, v160, v161
    v_mul_f32_dpp v162, v90, v58 row_newbcast:5 row_mask:0xf bank_mask:0xf
    v_smfmac_f32_16x16x64_bf16 v[204:207], a[156:159], v[192:199], v233
    v_cvt_pk_bf16_f32 v192, v168, v169 clamp
    v_smfmac_f32_16x16x64_bf16 v[208:211], a[128:131], v[184:191], v233
    v_cvt_pk_bf16_f32 v193, v170, v171 clamp
    v_mfma_f32_16x16x32_bf16 v[176:179], a[96:99], v[128:131], v[24:27]
    v_mul_f32_dpp v163, v91, v59 row_newbcast:5 row_mask:0xf bank_mask:0xf
    v_cvt_pk_bf16_f32 v194, v172, v173 clamp
    v_mfma_f32_16x16x32_bf16 v[176:179], a[100:103], v[132:135], v[176:179]
    v_cvt_pk_bf16_f32 v195, v174, v175 clamp
    v_cvt_pk_bf16_f32 v157, v162, v163
    v_mfma_f32_16x16x32_bf16 v[176:179], a[104:107], v[136:139], v[176:179]
    v_mul_f32_dpp v164, v92, v60 row_newbcast:5 row_mask:0xf bank_mask:0xf
    v_mul_f32_dpp v165, v93, v61 row_newbcast:5 row_mask:0xf bank_mask:0xf
    v_mfma_f32_16x16x32_bf16 v[176:179], a[108:111], v[140:143], v[176:179]
    v_add_f32 v229, v204, v205
    v_cvt_pk_bf16_f32 v158, v164, v165
    v_mfma_f32_16x16x32_bf16 v[180:183], a[124:127], v[140:143], v[28:31]
    v_mul_f32_dpp v166, v94, v62 row_newbcast:5 row_mask:0xf bank_mask:0xf
    v_mul_f32_dpp v167, v95, v63 row_newbcast:5 row_mask:0xf bank_mask:0xf
    v_mfma_f32_16x16x32_bf16 v[180:183], a[120:123], v[136:139], v[180:183]
    v_cvt_pk_bf16_f32 v159, v166, v167
    v_mul_f32_dpp v160, v64, v32 row_newbcast:9 row_mask:0xf bank_mask:0xf
    v_mfma_f32_16x16x32_bf16 v[180:183], a[116:119], v[132:135], v[180:183]
    v_cvt_pk_bf16_f32 v196, v176, v177 clamp
    v_cvt_pk_bf16_f32 v197, v178, v179 clamp
    v_mfma_f32_16x16x32_bf16 v[180:183], a[112:115], v[128:131], v[180:183]
    v_mul_f32_dpp v161, v65, v33 row_newbcast:9 row_mask:0xf bank_mask:0xf
    v_cvt_pk_bf16_f32 v128, v160, v161
    v_mfma_f32_16x16x32_bf16 v[168:171], a[0:3], v[144:147], v[0:3]
    v_mul_f32_dpp v162, v66, v34 row_newbcast:9 row_mask:0xf bank_mask:0xf
    v_mul_f32_dpp v163, v67, v35 row_newbcast:9 row_mask:0xf bank_mask:0xf
    v_mfma_f32_16x16x32_bf16 v[168:171], a[4:7], v[148:151], v[168:171]
    v_cvt_pk_bf16_f32 v129, v162, v163
    v_mul_f32_dpp v164, v68, v36 row_newbcast:9 row_mask:0xf bank_mask:0xf
    v_mfma_f32_16x16x32_bf16 v[168:171], a[8:11], v[152:155], v[168:171]
    v_cvt_pk_bf16_f32 v198, v180, v181 clamp
    v_cvt_pk_bf16_f32 v199, v182, v183 clamp
    v_mfma_f32_16x16x32_bf16 v[168:171], a[12:15], v[156:159], v[168:171]
    v_mul_f32_dpp v165, v69, v37 row_newbcast:9 row_mask:0xf bank_mask:0xf
    v_cvt_pk_bf16_f32 v130, v164, v165
    v_mfma_f32_16x16x32_bf16 v[172:175], a[28:31], v[156:159], v[4:7]
    v_mul_f32_dpp v166, v70, v38 row_newbcast:9 row_mask:0xf bank_mask:0xf
    v_mul_f32_dpp v167, v71, v39 row_newbcast:9 row_mask:0xf bank_mask:0xf
    v_mfma_f32_16x16x32_bf16 v[172:175], a[24:27], v[152:155], v[172:175]
    v_cvt_pk_bf16_f32 v131, v166, v167
    v_mul_f32_dpp v160, v72, v40 row_newbcast:9 row_mask:0xf bank_mask:0xf
    v_mfma_f32_16x16x32_bf16 v[172:175], a[20:23], v[148:151], v[172:175]
    v_cvt_pk_bf16_f32 v184, v168, v169 clamp
    v_cvt_pk_bf16_f32 v185, v170, v171 clamp
    v_mfma_f32_16x16x32_bf16 v[172:175], a[16:19], v[144:147], v[172:175]
    v_mul_f32_dpp v161, v73, v41 row_newbcast:9 row_mask:0xf bank_mask:0xf
    v_cvt_pk_bf16_f32 v132, v160, v161
    v_mfma_f32_16x16x32_bf16 v[176:179], a[32:35], v[144:147], v[8:11]
    v_mul_f32_dpp v162, v74, v42 row_newbcast:9 row_mask:0xf bank_mask:0xf
    v_mul_f32_dpp v163, v75, v43 row_newbcast:9 row_mask:0xf bank_mask:0xf
    v_mfma_f32_16x16x32_bf16 v[176:179], a[36:39], v[148:151], v[176:179]
    v_cvt_pk_bf16_f32 v133, v162, v163
    v_mul_f32_dpp v164, v76, v44 row_newbcast:9 row_mask:0xf bank_mask:0xf
    v_mfma_f32_16x16x32_bf16 v[176:179], a[40:43], v[152:155], v[176:179]
    v_cvt_pk_bf16_f32 v186, v172, v173 clamp
    v_cvt_pk_bf16_f32 v187, v174, v175 clamp
    v_mfma_f32_16x16x32_bf16 v[176:179], a[44:47], v[156:159], v[176:179]
    v_mul_f32_dpp v165, v77, v45 row_newbcast:9 row_mask:0xf bank_mask:0xf
    v_cvt_pk_bf16_f32 v134, v164, v165
    v_mfma_f32_16x16x32_bf16 v[180:183], a[60:63], v[156:159], v[12:15]
    v_mul_f32_dpp v166, v78, v46 row_newbcast:9 row_mask:0xf bank_mask:0xf
    v_mul_f32_dpp v167, v79, v47 row_newbcast:9 row_mask:0xf bank_mask:0xf
    v_mfma_f32_16x16x32_bf16 v[180:183], a[56:59], v[152:155], v[180:183]
    v_cvt_pk_bf16_f32 v135, v166, v167
    v_mul_f32_dpp v160, v80, v48 row_newbcast:9 row_mask:0xf bank_mask:0xf
    v_mfma_f32_16x16x32_bf16 v[180:183], a[52:55], v[148:151], v[180:183]
    v_cvt_pk_bf16_f32 v188, v176, v177 clamp
    v_cvt_pk_bf16_f32 v189, v178, v179 clamp
    v_mfma_f32_16x16x32_bf16 v[180:183], a[48:51], v[144:147], v[180:183]
    v_mul_f32_dpp v161, v81, v49 row_newbcast:9 row_mask:0xf bank_mask:0xf
    v_cvt_pk_bf16_f32 v136, v160, v161
    v_mfma_f32_16x16x32_bf16 v[168:171], a[64:67], v[144:147], v[16:19]
    v_mul_f32_dpp v162, v82, v50 row_newbcast:9 row_mask:0xf bank_mask:0xf
    v_mul_f32_dpp v163, v83, v51 row_newbcast:9 row_mask:0xf bank_mask:0xf
    v_mfma_f32_16x16x32_bf16 v[168:171], a[68:71], v[148:151], v[168:171]
    v_cvt_pk_bf16_f32 v137, v162, v163
    v_mul_f32_dpp v164, v84, v52 row_newbcast:9 row_mask:0xf bank_mask:0xf
    v_mfma_f32_16x16x32_bf16 v[168:171], a[72:75], v[152:155], v[168:171]
    v_cvt_pk_bf16_f32 v190, v180, v181 clamp
    v_cvt_pk_bf16_f32 v191, v182, v183 clamp
    v_mfma_f32_16x16x32_bf16 v[168:171], a[76:79], v[156:159], v[168:171]
    v_mul_f32_dpp v165, v85, v53 row_newbcast:9 row_mask:0xf bank_mask:0xf
    v_cvt_pk_bf16_f32 v138, v164, v165
    v_mfma_f32_16x16x32_bf16 v[172:175], a[92:95], v[156:159], v[20:23]
    v_mul_f32_dpp v166, v86, v54 row_newbcast:9 row_mask:0xf bank_mask:0xf
    v_mul_f32_dpp v167, v87, v55 row_newbcast:9 row_mask:0xf bank_mask:0xf
    v_mfma_f32_16x16x32_bf16 v[172:175], a[88:91], v[152:155], v[172:175]
    v_cvt_pk_bf16_f32 v139, v166, v167
    v_mul_f32_dpp v160, v88, v56 row_newbcast:9 row_mask:0xf bank_mask:0xf
    v_mfma_f32_16x16x32_bf16 v[172:175], a[84:87], v[148:151], v[172:175]
    v_mul_f32_dpp v161, v89, v57 row_newbcast:9 row_mask:0xf bank_mask:0xf
    v_cvt_pk_bf16_f32 v140, v160, v161
    v_mfma_f32_16x16x32_bf16 v[172:175], a[80:83], v[144:147], v[172:175]
    v_mul_f32_dpp v162, v90, v58 row_newbcast:9 row_mask:0xf bank_mask:0xf
    v_mul_f32_dpp v163, v91, v59 row_newbcast:9 row_mask:0xf bank_mask:0xf
    v_smfmac_f32_16x16x64_bf16 v[208:211], a[132:135], v[192:199], v233
    v_cvt_pk_bf16_f32 v192, v168, v169 clamp
    v_smfmac_f32_16x16x64_bf16 v[208:211], a[136:139], v[184:191], v233
    v_cvt_pk_bf16_f32 v193, v170, v171 clamp
    v_mfma_f32_16x16x32_bf16 v[176:179], a[96:99], v[144:147], v[24:27]
    v_cvt_pk_bf16_f32 v141, v162, v163
    v_cvt_pk_bf16_f32 v194, v172, v173 clamp
    v_mfma_f32_16x16x32_bf16 v[176:179], a[100:103], v[148:151], v[176:179]
    v_cvt_pk_bf16_f32 v195, v174, v175 clamp
    v_mul_f32_dpp v164, v92, v60 row_newbcast:9 row_mask:0xf bank_mask:0xf
    v_mfma_f32_16x16x32_bf16 v[176:179], a[104:107], v[152:155], v[176:179]
    v_mul_f32_dpp v165, v93, v61 row_newbcast:9 row_mask:0xf bank_mask:0xf
    v_cvt_pk_bf16_f32 v142, v164, v165
    v_mfma_f32_16x16x32_bf16 v[176:179], a[108:111], v[156:159], v[176:179]
    v_mul_f32_dpp v166, v94, v62 row_newbcast:9 row_mask:0xf bank_mask:0xf
    v_mul_f32_dpp v167, v95, v63 row_newbcast:9 row_mask:0xf bank_mask:0xf
    v_mfma_f32_16x16x32_bf16 v[180:183], a[124:127], v[156:159], v[28:31]
    v_cvt_pk_bf16_f32 v143, v166, v167
    v_mul_f32_dpp v160, v64, v32 row_newbcast:13 row_mask:0xf bank_mask:0xf
    v_mfma_f32_16x16x32_bf16 v[180:183], a[120:123], v[152:155], v[180:183]
    v_mul_f32_dpp v161, v65, v33 row_newbcast:13 row_mask:0xf bank_mask:0xf
    v_mul_f32_dpp v162, v66, v34 row_newbcast:13 row_mask:0xf bank_mask:0xf
    v_mfma_f32_16x16x32_bf16 v[180:183], a[116:119], v[148:151], v[180:183]
    v_cvt_pk_bf16_f32 v196, v176, v177 clamp
    v_cvt_pk_bf16_f32 v197, v178, v179 clamp
    v_mfma_f32_16x16x32_bf16 v[180:183], a[112:115], v[144:147], v[180:183]
    v_cvt_pk_bf16_f32 v144, v160, v161
    v_mul_f32_dpp v163, v67, v35 row_newbcast:13 row_mask:0xf bank_mask:0xf
    v_mfma_f32_16x16x32_bf16 v[168:171], a[0:3], v[128:131], v[0:3]
    v_mul_f32_dpp v64, v32, v32 row_shl:8 row_mask:0xf bank_mask:0xf bound_ctrl:0
    v_cvt_pk_bf16_f32 v145, v162, v163
    v_mfma_f32_16x16x32_bf16 v[168:171], a[4:7], v[132:135], v[168:171]
    v_mul_f32_dpp v65, v33, v33 row_shl:8 row_mask:0xf bank_mask:0xf bound_ctrl:0
    v_mul_f32_dpp v164, v68, v36 row_newbcast:13 row_mask:0xf bank_mask:0xf
    v_mfma_f32_16x16x32_bf16 v[168:171], a[8:11], v[136:139], v[168:171]
    v_cvt_pk_bf16_f32 v198, v180, v181 clamp
    v_cvt_pk_bf16_f32 v199, v182, v183 clamp
    v_mfma_f32_16x16x32_bf16 v[168:171], a[12:15], v[140:143], v[168:171]
    v_mul_f32_dpp v66, v34, v34 row_shl:8 row_mask:0xf bank_mask:0xf bound_ctrl:0
    v_mul_f32_dpp v165, v69, v37 row_newbcast:13 row_mask:0xf bank_mask:0xf
    v_mfma_f32_16x16x32_bf16 v[172:175], a[28:31], v[140:143], v[4:7]
    v_mul_f32_dpp v67, v35, v35 row_shl:8 row_mask:0xf bank_mask:0xf bound_ctrl:0
    v_cvt_pk_bf16_f32 v146, v164, v165
    v_mfma_f32_16x16x32_bf16 v[172:175], a[24:27], v[136:139], v[172:175]
    v_mul_f32_dpp v68, v36, v36 row_shl:8 row_mask:0xf bank_mask:0xf bound_ctrl:0
    v_mul_f32_dpp v166, v70, v38 row_newbcast:13 row_mask:0xf bank_mask:0xf
    v_mfma_f32_16x16x32_bf16 v[172:175], a[20:23], v[132:135], v[172:175]
    v_cvt_pk_bf16_f32 v184, v168, v169 clamp
    v_mul_f32_dpp v69, v37, v37 row_shl:8 row_mask:0xf bank_mask:0xf bound_ctrl:0
    v_mfma_f32_16x16x32_bf16 v[172:175], a[16:19], v[128:131], v[172:175]
    v_cvt_pk_bf16_f32 v185, v170, v171 clamp
    v_mul_f32_dpp v167, v71, v39 row_newbcast:13 row_mask:0xf bank_mask:0xf
    v_mfma_f32_16x16x32_bf16 v[176:179], a[32:35], v[128:131], v[8:11]
    v_mul_f32_dpp v70, v38, v38 row_shl:8 row_mask:0xf bank_mask:0xf bound_ctrl:0
    v_mul_f32_dpp v71, v39, v39 row_shl:8 row_mask:0xf bank_mask:0xf bound_ctrl:0
    v_mfma_f32_16x16x32_bf16 v[176:179], a[36:39], v[132:135], v[176:179]
    v_cvt_pk_bf16_f32 v147, v166, v167
    v_mul_f32_dpp v160, v72, v40 row_newbcast:13 row_mask:0xf bank_mask:0xf
    v_mfma_f32_16x16x32_bf16 v[176:179], a[40:43], v[136:139], v[176:179]
    v_mul_f32_dpp v161, v73, v41 row_newbcast:13 row_mask:0xf bank_mask:0xf
    v_cvt_pk_bf16_f32 v186, v172, v173 clamp
    v_mfma_f32_16x16x32_bf16 v[176:179], a[44:47], v[140:143], v[176:179]
    v_cvt_pk_bf16_f32 v148, v160, v161
    v_cvt_pk_bf16_f32 v187, v174, v175 clamp
    v_mfma_f32_16x16x32_bf16 v[180:183], a[60:63], v[140:143], v[12:15]
    v_mul_f32_dpp v162, v74, v42 row_newbcast:13 row_mask:0xf bank_mask:0xf
    v_mul_f32_dpp v163, v75, v43 row_newbcast:13 row_mask:0xf bank_mask:0xf
    v_mfma_f32_16x16x32_bf16 v[180:183], a[56:59], v[136:139], v[180:183]
    v_cvt_pk_bf16_f32 v149, v162, v163
    v_mul_f32_dpp v72, v40, v40 row_shl:8 row_mask:0xf bank_mask:0xf bound_ctrl:0
    v_mfma_f32_16x16x32_bf16 v[180:183], a[52:55], v[132:135], v[180:183]
    v_mul_f32_dpp v164, v76, v44 row_newbcast:13 row_mask:0xf bank_mask:0xf
    v_mul_f32_dpp v73, v41, v41 row_shl:8 row_mask:0xf bank_mask:0xf bound_ctrl:0
    v_mfma_f32_16x16x32_bf16 v[180:183], a[48:51], v[128:131], v[180:183]
    v_cvt_pk_bf16_f32 v188, v176, v177 clamp
    v_mul_f32_dpp v165, v77, v45 row_newbcast:13 row_mask:0xf bank_mask:0xf
    v_mfma_f32_16x16x32_bf16 v[168:171], a[64:67], v[128:131], v[16:19]
    v_mul_f32_dpp v74, v42, v42 row_shl:8 row_mask:0xf bank_mask:0xf bound_ctrl:0
    v_cvt_pk_bf16_f32 v150, v164, v165
    v_mfma_f32_16x16x32_bf16 v[168:171], a[68:71], v[132:135], v[168:171]
    v_mul_f32_dpp v75, v43, v43 row_shl:8 row_mask:0xf bank_mask:0xf bound_ctrl:0
    v_cvt_pk_bf16_f32 v189, v178, v179 clamp
    v_mfma_f32_16x16x32_bf16 v[168:171], a[72:75], v[136:139], v[168:171]
    v_mul_f32_dpp v76, v44, v44 row_shl:8 row_mask:0xf bank_mask:0xf bound_ctrl:0
    v_mul_f32_dpp v166, v78, v46 row_newbcast:13 row_mask:0xf bank_mask:0xf
    v_mfma_f32_16x16x32_bf16 v[168:171], a[76:79], v[140:143], v[168:171]
    v_mul_f32_dpp v77, v45, v45 row_shl:8 row_mask:0xf bank_mask:0xf bound_ctrl:0
    v_mul_f32_dpp v167, v79, v47 row_newbcast:13 row_mask:0xf bank_mask:0xf
    s_waitcnt vmcnt(0)
    v_mfma_f32_4x4x4_16b_bf16 v[32:35], a[200:201], v[112:113], 0
    v_mul_f32_dpp v78, v46, v46 row_shl:8 row_mask:0xf bank_mask:0xf bound_ctrl:0
    v_mfma_f32_4x4x4_16b_bf16 v[36:39], a[200:201], v[114:115], 0
    v_cvt_pk_bf16_f32 v151, v166, v167
    v_mfma_f32_4x4x4_16b_bf16 v[40:43], a[200:201], v[116:117], 0
    v_mul_f32_dpp v79, v47, v47 row_shl:8 row_mask:0xf bank_mask:0xf bound_ctrl:0
    v_mfma_f32_4x4x4_16b_bf16 v[44:47], a[200:201], v[118:119], 0
    v_mul_f32_dpp v160, v80, v48 row_newbcast:13 row_mask:0xf bank_mask:0xf
    v_cvt_pk_bf16_f32 v190, v180, v181 clamp
    v_mul_f32_dpp v161, v81, v49 row_newbcast:13 row_mask:0xf bank_mask:0xf
    v_mfma_f32_16x16x32_bf16 v[172:175], a[92:95], v[140:143], v[20:23]
    v_cvt_pk_bf16_f32 v191, v182, v183 clamp
    v_cvt_pk_bf16_f32 v152, v160, v161
    v_mfma_f32_16x16x32_bf16 v[172:175], a[88:91], v[136:139], v[172:175]
    v_mul_f32_dpp v162, v82, v50 row_newbcast:13 row_mask:0xf bank_mask:0xf
    v_mul_f32_dpp v163, v83, v51 row_newbcast:13 row_mask:0xf bank_mask:0xf
    v_mfma_f32_16x16x32_bf16 v[172:175], a[84:87], v[132:135], v[172:175]
    v_cvt_pk_bf16_f32 v153, v162, v163
    v_mul_f32_dpp v164, v84, v52 row_newbcast:13 row_mask:0xf bank_mask:0xf
    v_mfma_f32_16x16x32_bf16 v[172:175], a[80:83], v[128:131], v[172:175]
    v_mul_f32_dpp v165, v85, v53 row_newbcast:13 row_mask:0xf bank_mask:0xf
    v_cvt_pk_bf16_f32 v154, v164, v165
    v_smfmac_f32_16x16x64_bf16 v[208:211], a[140:143], v[192:199], v233
    v_cvt_pk_bf16_f32 v192, v168, v169 clamp
    v_smfmac_f32_16x16x64_bf16 v[208:211], a[144:147], v[184:191], v233
    v_cvt_pk_bf16_f32 v193, v170, v171 clamp
    v_mfma_f32_16x16x32_bf16 v[176:179], a[96:99], v[128:131], v[24:27]
    v_mul_f32_dpp v166, v86, v54 row_newbcast:13 row_mask:0xf bank_mask:0xf
    v_mul_f32_dpp v167, v87, v55 row_newbcast:13 row_mask:0xf bank_mask:0xf
    v_mfma_f32_16x16x32_bf16 v[176:179], a[100:103], v[132:135], v[176:179]
    v_cvt_pk_bf16_f32 v155, v166, v167
    v_mul_f32_dpp v160, v88, v56 row_newbcast:13 row_mask:0xf bank_mask:0xf
    v_mfma_f32_16x16x32_bf16 v[176:179], a[104:107], v[136:139], v[176:179]
    v_mul_f32_dpp v161, v89, v57 row_newbcast:13 row_mask:0xf bank_mask:0xf
    v_cvt_pk_bf16_f32 v156, v160, v161
    v_mfma_f32_16x16x32_bf16 v[176:179], a[108:111], v[140:143], v[176:179]
    v_mul_f32_dpp v162, v90, v58 row_newbcast:13 row_mask:0xf bank_mask:0xf
    v_mul_f32_dpp v163, v91, v59 row_newbcast:13 row_mask:0xf bank_mask:0xf
    v_mfma_f32_16x16x32_bf16 v[180:183], a[124:127], v[140:143], v[28:31]
    v_cvt_pk_bf16_f32 v194, v172, v173 clamp
    v_cvt_pk_bf16_f32 v157, v162, v163
    v_mfma_f32_16x16x32_bf16 v[180:183], a[120:123], v[136:139], v[180:183]
    v_cvt_pk_bf16_f32 v195, v174, v175 clamp
    v_mul_f32_dpp v164, v92, v60 row_newbcast:13 row_mask:0xf bank_mask:0xf
    v_mfma_f32_16x16x32_bf16 v[180:183], a[116:119], v[132:135], v[180:183]
    v_mul_f32_dpp v165, v93, v61 row_newbcast:13 row_mask:0xf bank_mask:0xf
    v_cvt_pk_bf16_f32 v158, v164, v165
    v_mfma_f32_16x16x32_bf16 v[180:183], a[112:115], v[128:131], v[180:183]
    v_mul_f32_dpp v166, v94, v62 row_newbcast:13 row_mask:0xf bank_mask:0xf
    v_mul_f32_dpp v167, v95, v63 row_newbcast:13 row_mask:0xf bank_mask:0xf
    v_mfma_f32_16x16x32_bf16 v[168:171], a[0:3], v[144:147], v[0:3]
    v_cvt_pk_bf16_f32 v159, v166, v167
    v_cvt_pk_bf16_f32 v196, v176, v177 clamp
    v_mfma_f32_16x16x32_bf16 v[168:171], a[4:7], v[148:151], v[168:171]
    v_cvt_pk_bf16_f32 v197, v178, v179 clamp
L_pad4:
    s_cbranch_vccnz L_pad8
    v_mul_f32_dpp v64, v32, v32 row_shr:8 row_mask:0xf bank_mask:0xc
    v_mfma_f32_16x16x32_bf16 v[168:171], a[8:11], v[152:155], v[168:171]
    v_cvt_pk_bf16_f32 v198, v180, v181 clamp
    v_cvt_pk_bf16_f32 v199, v182, v183 clamp
    v_mfma_f32_16x16x32_bf16 v[168:171], a[12:15], v[156:159], v[168:171]
    global_load_dwordx4 v[80:83], v246, s[6:7] offset:0
    v_mul_f32_dpp v65, v33, v33 row_shr:8 row_mask:0xf bank_mask:0xc
    v_cvt_pk_bf16_f32 v96, v64, v65
    v_mul_f32_dpp v64, v48, v48 row_shl:8 row_mask:0xf bank_mask:0xf bound_ctrl:0
    v_mul_f32_dpp v65, v49, v49 row_shl:8 row_mask:0xf bank_mask:0xf bound_ctrl:0
    v_mul_f32_dpp v66, v34, v34 row_shr:8 row_mask:0xf bank_mask:0xc
    v_mul_f32_dpp v67, v35, v35 row_shr:8 row_mask:0xf bank_mask:0xc
    v_cvt_pk_bf16_f32 v97, v66, v67
    v_mul_f32_dpp v66, v50, v50 row_shl:8 row_mask:0xf bank_mask:0xf bound_ctrl:0
    v_mul_f32_dpp v67, v51, v51 row_shl:8 row_mask:0xf bank_mask:0xf bound_ctrl:0
    v_mfma_f32_4x4x4_16b_bf16 v[48:51], a[200:201], v[120:121], 0
    v_cvt_pk_bf16_f32 v184, v168, v169 clamp
    v_mul_f32_dpp v68, v36, v36 row_shr:8 row_mask:0xf bank_mask:0xc
    v_mul_f32_dpp v69, v37, v37 row_shr:8 row_mask:0xf bank_mask:0xc
    v_cvt_pk_bf16_f32 v98, v68, v69
    v_mul_f32_dpp v68, v52, v52 row_shl:8 row_mask:0xf bank_mask:0xf bound_ctrl:0
    v_mul_f32_dpp v69, v53, v53 row_shl:8 row_mask:0xf bank_mask:0xf bound_ctrl:0
    v_mul_f32_dpp v70, v38, v38 row_shr:8 row_mask:0xf bank_mask:0xc
    v_mul_f32_dpp v71, v39, v39 row_shr:8 row_mask:0xf bank_mask:0xc
    v_cvt_pk_bf16_f32 v99, v70, v71
    v_mul_f32_dpp v70, v54, v54 row_shl:8 row_mask:0xf bank_mask:0xf bound_ctrl:0
    v_mul_f32_dpp v71, v55, v55 row_shl:8 row_mask:0xf bank_mask:0xf bound_ctrl:0
    v_mfma_f32_4x4x4_16b_bf16 v[52:55], a[200:201], v[122:123], 0
    v_cvt_pk_bf16_f32 v185, v170, v171 clamp
    v_mul_f32_dpp v72, v40, v40 row_shr:8 row_mask:0xf bank_mask:0xc
    v_mul_f32_dpp v73, v41, v41 row_shr:8 row_mask:0xf bank_mask:0xc
    v_cvt_pk_bf16_f32 v100, v72, v73
    v_mul_f32_dpp v72, v56, v56 row_shl:8 row_mask:0xf bank_mask:0xf bound_ctrl:0
    v_mul_f32_dpp v73, v57, v57 row_shl:8 row_mask:0xf bank_mask:0xf bound_ctrl:0
    v_mul_f32_dpp v74, v42, v42 row_shr:8 row_mask:0xf bank_mask:0xc
    v_mul_f32_dpp v75, v43, v43 row_shr:8 row_mask:0xf bank_mask:0xc
    v_cvt_pk_bf16_f32 v101, v74, v75
    v_mul_f32_dpp v74, v58, v58 row_shl:8 row_mask:0xf bank_mask:0xf bound_ctrl:0
    v_mul_f32_dpp v75, v59, v59 row_shl:8 row_mask:0xf bank_mask:0xf bound_ctrl:0
    v_mfma_f32_4x4x4_16b_bf16 v[56:59], a[200:201], v[124:125], 0
    v_mul_f32_dpp v76, v44, v44 row_shr:8 row_mask:0xf bank_mask:0xc
    v_mul_f32_dpp v77, v45, v45 row_shr:8 row_mask:0xf bank_mask:0xc
    v_cvt_pk_bf16_f32 v102, v76, v77
    v_mul_f32_dpp v76, v60, v60 row_shl:8 row_mask:0xf bank_mask:0xf bound_ctrl:0
    v_mul_f32_dpp v77, v61, v61 row_shl:8 row_mask:0xf bank_mask:0xf bound_ctrl:0
    v_mul_f32_dpp v78, v46, v46 row_shr:8 row_mask:0xf bank_mask:0xc
    v_mul_f32_dpp v79, v47, v47 row_shr:8 row_mask:0xf bank_mask:0xc
    v_cvt_pk_bf16_f32 v103, v78, v79
    v_mul_f32_dpp v78, v62, v62 row_shl:8 row_mask:0xf bank_mask:0xf bound_ctrl:0
    v_mul_f32_dpp v79, v63, v63 row_shl:8 row_mask:0xf bank_mask:0xf bound_ctrl:0
    v_mfma_f32_4x4x4_16b_bf16 v[60:63], a[200:201], v[126:127], 0
    v_mul_f32_dpp v64, v48, v48 row_shr:8 row_mask:0xf bank_mask:0xc
    v_mul_f32_dpp v65, v49, v49 row_shr:8 row_mask:0xf bank_mask:0xc
    v_cvt_pk_bf16_f32 v104, v64, v65
    v_mfma_f32_16x16x32_bf16 v[172:175], a[28:31], v[156:159], v[4:7]
    v_mul_f32_dpp v66, v50, v50 row_shr:8 row_mask:0xf bank_mask:0xc
    v_mul_f32_dpp v67, v51, v51 row_shr:8 row_mask:0xf bank_mask:0xc
    v_mfma_f32_16x16x32_bf16 v[172:175], a[24:27], v[152:155], v[172:175]
    v_cvt_pk_bf16_f32 v105, v66, v67
    v_mul_f32_dpp v68, v52, v52 row_shr:8 row_mask:0xf bank_mask:0xc
    v_mfma_f32_16x16x32_bf16 v[172:175], a[20:23], v[148:151], v[172:175]
    v_mul_f32_dpp v69, v53, v53 row_shr:8 row_mask:0xf bank_mask:0xc
    v_cvt_pk_bf16_f32 v106, v68, v69
    v_mfma_f32_16x16x32_bf16 v[172:175], a[16:19], v[144:147], v[172:175]
    global_load_dwordx4 v[84:87], v246, s[6:7] offset:64
    v_mfma_f32_16x16x32_bf16 v[176:179], a[32:35], v[144:147], v[8:11]
    v_mul_f32_dpp v70, v54, v54 row_shr:8 row_mask:0xf bank_mask:0xc
    v_mul_f32_dpp v71, v55, v55 row_shr:8 row_mask:0xf bank_mask:0xc
    v_mfma_f32_16x16x32_bf16 v[176:179], a[36:39], v[148:151], v[176:179]
    v_cvt_pk_bf16_f32 v107, v70, v71
    v_mul_f32_dpp v72, v56, v56 row_shr:8 row_mask:0xf bank_mask:0xc
    v_mfma_f32_16x16x32_bf16 v[176:179], a[40:43], v[152:155], v[176:179]
    v_cvt_pk_bf16_f32 v186, v172, v173 clamp
    v_cvt_pk_bf16_f32 v187, v174, v175 clamp
    v_mfma_f32_16x16x32_bf16 v[176:179], a[44:47], v[156:159], v[176:179]
    v_mul_f32_dpp v73, v57, v57 row_shr:8 row_mask:0xf bank_mask:0xc
    v_cvt_pk_bf16_f32 v108, v72, v73
    v_mfma_f32_16x16x32_bf16 v[180:183], a[60:63], v[156:159], v[12:15]
    v_mul_f32_dpp v74, v58, v58 row_shr:8 row_mask:0xf bank_mask:0xc
    v_mul_f32_dpp v75, v59, v59 row_shr:8 row_mask:0xf bank_mask:0xc
    v_mfma_f32_16x16x32_bf16 v[180:183], a[56:59], v[152:155], v[180:183]
    v_cvt_pk_bf16_f32 v109, v74, v75
    v_mul_f32_dpp v76, v60, v60 row_shr:8 row_mask:0xf bank_mask:0xc
    v_mfma_f32_16x16x32_bf16 v[180:183], a[52:55], v[148:151], v[180:183]
    v_cvt_pk_bf16_f32 v188, v176, v177 clamp
    v_cvt_pk_bf16_f32 v189, v178, v179 clamp
    v_mfma_f32_16x16x32_bf16 v[180:183], a[48:51], v[144:147], v[180:183]
    v_mul_f32_dpp v77, v61, v61 row_shr:8 row_mask:0xf bank_mask:0xc
    v_cvt_pk_bf16_f32 v110, v76, v77
    v_mfma_f32_16x16x32_bf16 v[168:171], a[64:67], v[144:147], v[16:19]
    global_load_dwordx4 v[88:91], v246, s[6:7] offset:128
    v_mfma_f32_16x16x32_bf16 v[168:171], a[68:71], v[148:151], v[168:171]
    v_mul_f32_dpp v78, v62, v62 row_shr:8 row_mask:0xf bank_mask:0xc
    v_mul_f32_dpp v79, v63, v63 row_shr:8 row_mask:0xf bank_mask:0xc
    v_mfma_f32_16x16x32_bf16 v[168:171], a[72:75], v[152:155], v[168:171]
    v_cvt_pk_bf16_f32 v190, v180, v181 clamp
    v_cvt_pk_bf16_f32 v191, v182, v183 clamp
    v_mfma_f32_16x16x32_bf16 v[168:171], a[76:79], v[156:159], v[168:171]
    v_cvt_pk_bf16_f32 v111, v78, v79
    v_mul_f32_dpp v160, v32, v32 row_ror:1 row_mask:0xf bank_mask:0xf
    v_mfma_f32_16x16x32_bf16 v[172:175], a[92:95], v[156:159], v[20:23]
    v_mul_f32_dpp v161, v33, v33 row_ror:1 row_mask:0xf bank_mask:0xf
    v_cvt_pk_bf16_f32 v128, v160, v161
    v_mfma_f32_16x16x32_bf16 v[172:175], a[88:91], v[152:155], v[172:175]
    v_mul_f32_dpp v162, v34, v34 row_ror:1 row_mask:0xf bank_mask:0xf
    v_mul_f32_dpp v163, v35, v35 row_ror:1 row_mask:0xf bank_mask:0xf
    v_mfma_f32_16x16x32_bf16 v[172:175], a[84:87], v[148:151], v[172:175]
    v_cvt_pk_bf16_f32 v129, v162, v163
    v_mul_f32_dpp v164, v36, v36 row_ror:1 row_mask:0xf bank_mask:0xf
    v_mfma_f32_16x16x32_bf16 v[172:175], a[80:83], v[144:147], v[172:175]
    v_mul_f32_dpp v165, v37, v37 row_ror:1 row_mask:0xf bank_mask:0xf
    v_cvt_pk_bf16_f32 v130, v164, v165
    v_smfmac_f32_16x16x64_bf16 v[208:211], a[148:151], v[192:199], v233
    v_cvt_pk_bf16_f32 v192, v168, v169 clamp
    v_smfmac_f32_16x16x64_bf16 v[208:211], a[152:155], v[184:191], v233
    v_cvt_pk_bf16_f32 v193, v170, v171 clamp
    v_mfma_f32_16x16x32_bf16 v[176:179], a[96:99], v[144:147], v[24:27]
    global_load_dwordx4 v[92:95], v246, s[6:7] offset:192
    v_mfma_f32_16x16x32_bf16 v[176:179], a[100:103], v[148:151], v[176:179]
    v_cvt_pk_bf16_f32 v194, v172, v173 clamp
    v_cvt_pk_bf16_f32 v195, v174, v175 clamp
    v_mfma_f32_16x16x32_bf16 v[176:179], a[104:107], v[152:155], v[176:179]
    v_mul_f32_dpp v166, v38, v38 row_ror:1 row_mask:0xf bank_mask:0xf
    v_mul_f32_dpp v167, v39, v39 row_ror:1 row_mask:0xf bank_mask:0xf
    v_mfma_f32_16x16x32_bf16 v[176:179], a[108:111], v[156:159], v[176:179]
    v_cvt_pk_bf16_f32 v131, v166, v167
    v_mul_f32_dpp v160, v40, v40 row_ror:1 row_mask:0xf bank_mask:0xf
    v_mfma_f32_16x16x32_bf16 v[180:183], a[124:127], v[156:159], v[28:31]
    v_mul_f32_dpp v161, v41, v41 row_ror:1 row_mask:0xf bank_mask:0xf
    v_cvt_pk_bf16_f32 v132, v160, v161
    v_mfma_f32_16x16x32_bf16 v[180:183], a[120:123], v[152:155], v[180:183]
    v_mul_f32_dpp v162, v42, v42 row_ror:1 row_mask:0xf bank_mask:0xf
    v_mul_f32_dpp v163, v43, v43 row_ror:1 row_mask:0xf bank_mask:0xf
    v_mfma_f32_16x16x32_bf16 v[180:183], a[116:119], v[148:151], v[180:183]
    v_cvt_pk_bf16_f32 v196, v176, v177 clamp
    v_cvt_pk_bf16_f32 v197, v178, v179 clamp
    v_mfma_f32_16x16x32_bf16 v[180:183], a[112:115], v[144:147], v[180:183]
    v_cvt_pk_bf16_f32 v133, v162, v163
    v_mov_b32 v200, 0
    v_mfma_f32_16x16x32_bf16 v[168:171], a[0:3], v[96:99], v[0:3]
    v_mul_f32_dpp v164, v44, v44 row_ror:1 row_mask:0xf bank_mask:0xf
    v_mul_f32_dpp v165, v45, v45 row_ror:1 row_mask:0xf bank_mask:0xf
    v_mfma_f32_16x16x32_bf16 v[168:171], a[4:7], v[100:103], v[168:171]
    v_cvt_pk_bf16_f32 v134, v164, v165
    v_mov_b32 v201, 0
    v_mfma_f32_16x16x32_bf16 v[168:171], a[8:11], v[104:107], v[168:171]
    v_cvt_pk_bf16_f32 v198, v180, v181 clamp
    v_cvt_pk_bf16_f32 v199, v182, v183 clamp
    v_mfma_f32_16x16x32_bf16 v[168:171], a[12:15], v[108:111], v[168:171]
    v_mul_f32_dpp v166, v46, v46 row_ror:1 row_mask:0xf bank_mask:0xf
    v_mul_f32_dpp v167, v47, v47 row_ror:1 row_mask:0xf bank_mask:0xf
    v_mfma_f32_16x16x32_bf16 v[172:175], a[28:31], v[108:111], v[4:7]
    v_cvt_pk_bf16_f32 v135, v166, v167
    v_mul_f32_dpp v160, v48, v48 row_ror:1 row_mask:0xf bank_mask:0xf
    v_mfma_f32_16x16x32_bf16 v[172:175], a[24:27], v[104:107], v[172:175]
    v_mul_f32_dpp v161, v49, v49 row_ror:1 row_mask:0xf bank_mask:0xf
    v_cvt_pk_bf16_f32 v136, v160, v161
    v_mfma_f32_16x16x32_bf16 v[172:175], a[20:23], v[100:103], v[172:175]
    v_cvt_pk_bf16_f32 v184, v168, v169 clamp
    v_cvt_pk_bf16_f32 v185, v170, v171 clamp
    v_mfma_f32_16x16x32_bf16 v[172:175], a[16:19], v[96:99], v[172:175]
    v_mul_f32_dpp v162, v50, v50 row_ror:1 row_mask:0xf bank_mask:0xf
    v_mul_f32_dpp v163, v51, v51 row_ror:1 row_mask:0xf bank_mask:0xf
    v_mfma_f32_16x16x32_bf16 v[176:179], a[32:35], v[96:99], v[8:11]
    v_cvt_pk_bf16_f32 v137, v162, v163
    v_mul_f32_dpp v164, v52, v52 row_ror:1 row_mask:0xf bank_mask:0xf
    v_mfma_f32_16x16x32_bf16 v[176:179], a[36:39], v[100:103], v[176:179]
    v_mul_f32_dpp v165, v53, v53 row_ror:1 row_mask:0xf bank_mask:0xf
    v_cvt_pk_bf16_f32 v138, v164, v165
    v_mfma_f32_16x16x32_bf16 v[176:179], a[40:43], v[104:107], v[176:179]
    v_cvt_pk_bf16_f32 v186, v172, v173 clamp
    v_cvt_pk_bf16_f32 v187, v174, v175 clamp
    v_mfma_f32_16x16x32_bf16 v[176:179], a[44:47], v[108:111], v[176:179]
    v_mul_f32_dpp v166, v54, v54 row_ror:1 row_mask:0xf bank_mask:0xf
    v_mul_f32_dpp v167, v55, v55 row_ror:1 row_mask:0xf bank_mask:0xf
    v_mfma_f32_4x4x4_16b_bf16 v[64:67], a[184:185], v[112:113], 0
    v_cvt_pk_bf16_f32 v139, v166, v167
    v_mfma_f32_4x4x4_16b_bf16 v[68:71], a[186:187], v[114:115], 0
    v_mul_f32_dpp v160, v56, v56 row_ror:1 row_mask:0xf bank_mask:0xf
    v_mfma_f32_4x4x4_16b_bf16 v[72:75], a[188:189], v[116:117], 0
    v_mul_f32_dpp v161, v57, v57 row_ror:1 row_mask:0xf bank_mask:0xf
    v_mfma_f32_4x4x4_16b_bf16 v[76:79], a[190:191], v[118:119], 0
    v_cvt_pk_bf16_f32 v188, v176, v177 clamp
    v_cvt_pk_bf16_f32 v189, v178, v179 clamp
    v_cvt_pk_bf16_f32 v64, v64, v65
    v_mfma_f32_16x16x32_bf16 v[180:183], a[60:63], v[108:111], v[12:15]
    v_cvt_pk_bf16_f32 v65, v66, v67
    v_cvt_pk_bf16_f32 v66, v68, v69
    v_mfma_f32_16x16x32_bf16 v[180:183], a[56:59], v[104:107], v[180:183]
    v_cvt_pk_bf16_f32 v67, v70, v71
    v_cvt_pk_bf16_f32 v68, v72, v73
    v_mfma_f32_16x16x32_bf16 v[180:183], a[52:55], v[100:103], v[180:183]
    v_cvt_pk_bf16_f32 v69, v74, v75
    v_cvt_pk_bf16_f32 v70, v76, v77
    v_mfma_f32_16x16x32_bf16 v[180:183], a[48:51], v[96:99], v[180:183]
    v_cvt_pk_bf16_f32 v71, v78, v79
    v_cvt_pk_bf16_f32 v140, v160, v161
    v_mfma_f32_16x16x32_bf16 v[168:171], a[64:67], v[96:99], v[16:19]
    v_mul_f32_dpp v162, v58, v58 row_ror:1 row_mask:0xf bank_mask:0xf
    v_mul_f32_dpp v163, v59, v59 row_ror:1 row_mask:0xf bank_mask:0xf
    v_mfma_f32_16x16x32_bf16 v[168:171], a[68:71], v[100:103], v[168:171]
    v_cvt_pk_bf16_f32 v141, v162, v163
    v_mul_f32_dpp v164, v60, v60 row_ror:1 row_mask:0xf bank_mask:0xf
    v_mfma_f32_16x16x32_bf16 v[168:171], a[72:75], v[104:107], v[168:171]
    v_cvt_pk_bf16_f32 v190, v180, v181 clamp
    v_cvt_pk_bf16_f32 v191, v182, v183 clamp
    v_mfma_f32_16x16x32_bf16 v[168:171], a[76:79], v[108:111], v[168:171]
    v_mul_f32_dpp v165, v61, v61 row_ror:1 row_mask:0xf bank_mask:0xf
    v_cvt_pk_bf16_f32 v142, v164, v165
    v_mfma_f32_16x16x32_bf16 v[172:175], a[92:95], v[108:111], v[20:23]
    v_mul_f32_dpp v166, v62, v62 row_ror:1 row_mask:0xf bank_mask:0xf
    v_mul_f32_dpp v167, v63, v63 row_ror:1 row_mask:0xf bank_mask:0xf
    v_mfma_f32_16x16x32_bf16 v[172:175], a[88:91], v[104:107], v[172:175]
    v_cvt_pk_bf16_f32 v143, v166, v167
    v_mul_f32_dpp v160, v32, v32 row_ror:2 row_mask:0xf bank_mask:0xf
    v_mfma_f32_16x16x32_bf16 v[172:175], a[84:87], v[100:103], v[172:175]
    v_mul_f32_dpp v161, v33, v33 row_ror:2 row_mask:0xf bank_mask:0xf
    v_cvt_pk_bf16_f32 v144, v160, v161
    v_mfma_f32_16x16x32_bf16 v[172:175], a[80:83], v[96:99], v[172:175]
    v_mul_f32_dpp v162, v34, v34 row_ror:2 row_mask:0xf bank_mask:0xf
    v_mul_f32_dpp v163, v35, v35 row_ror:2 row_mask:0xf bank_mask:0xf
    v_smfmac_f32_16x16x64_bf16 v[208:211], a[156:159], v[192:199], v233
    v_cvt_pk_bf16_f32 v192, v168, v169 clamp
    v_smfmac_f32_16x16x64_bf16 v[200:203], a[152:155], v[184:191], v233
    v_cvt_pk_bf16_f32 v193, v170, v171 clamp
    v_mfma_f32_16x16x32_bf16 v[176:179], a[96:99], v[96:99], v[24:27]
    v_cvt_pk_bf16_f32 v145, v162, v163
    v_cvt_pk_bf16_f32 v194, v172, v173 clamp
    v_mfma_f32_16x16x32_bf16 v[176:179], a[100:103], v[100:103], v[176:179]
    v_cvt_pk_bf16_f32 v195, v174, v175 clamp
    v_add_f32 v230, v208, v209
    v_mfma_f32_16x16x32_bf16 v[176:179], a[104:107], v[104:107], v[176:179]
    v_mul_f32_dpp v164, v36, v36 row_ror:2 row_mask:0xf bank_mask:0xf
    v_mul_f32_dpp v165, v37, v37 row_ror:2 row_mask:0xf bank_mask:0xf
    v_mfma_f32_16x16x32_bf16 v[176:179], a[108:111], v[108:111], v[176:179]
    v_cvt_pk_bf16_f32 v146, v164, v165
    v_mul_f32_dpp v166, v38, v38 row_ror:2 row_mask:0xf bank_mask:0xf
    v_mfma_f32_4x4x4_16b_bf16 v[72:75], a[192:193], v[120:121], 0
    v_mul_f32_dpp v167, v39, v39 row_ror:2 row_mask:0xf bank_mask:0xf
    v_mfma_f32_4x4x4_16b_bf16 v[76:79], a[194:195], v[122:123], 0
    v_cvt_pk_bf16_f32 v147, v166, v167
    v_mfma_f32_4x4x4_16b_bf16 v[220:223], a[196:197], v[124:125], 0
    v_mul_f32_dpp v160, v40, v40 row_ror:2 row_mask:0xf bank_mask:0xf
    v_mfma_f32_4x4x4_16b_bf16 v[204:207], a[198:199], v[126:127], 0
    v_cvt_pk_bf16_f32 v196, v176, v177 clamp
    v_cvt_pk_bf16_f32 v197, v178, v179 clamp
    v_cvt_pk_bf16_f32 v72, v72, v73
    v_mfma_f32_16x16x32_bf16 v[180:183], a[124:127], v[108:111], v[28:31]
    v_cvt_pk_bf16_f32 v73, v74, v75
    v_cvt_pk_bf16_f32 v74, v76, v77
    v_mfma_f32_16x16x32_bf16 v[180:183], a[120:123], v[104:107], v[180:183]
    v_cvt_pk_bf16_f32 v75, v78, v79
    v_cvt_pk_bf16_f32 v76, v220, v221
    v_mfma_f32_16x16x32_bf16 v[180:183], a[116:119], v[100:103], v[180:183]
    v_cvt_pk_bf16_f32 v77, v222, v223
    v_cvt_pk_bf16_f32 v78, v204, v205
    v_mfma_f32_16x16x32_bf16 v[180:183], a[112:115], v[96:99], v[180:183]
    v_cvt_pk_bf16_f32 v79, v206, v207
    v_mul_f32_dpp v161, v41, v41 row_ror:2 row_mask:0xf bank_mask:0xf
    v_mfma_f32_16x16x32_bf16 v[168:171], a[0:3], v[128:131], v[0:3]
    v_cvt_pk_bf16_f32 v148, v160, v161
    v_mul_f32_dpp v162, v42, v42 row_ror:2 row_mask:0xf bank_mask:0xf
    v_mfma_f32_16x16x32_bf16 v[168:171], a[4:7], v[132:135], v[168:171]
    v_mul_f32_dpp v163, v43, v43 row_ror:2 row_mask:0xf bank_mask:0xf
    v_cvt_pk_bf16_f32 v149, v162, v163
    v_mfma_f32_16x16x32_bf16 v[168:171], a[8:11], v[136:139], v[168:171]
    v_cvt_pk_bf16_f32 v198, v180, v181 clamp
    v_cvt_pk_bf16_f32 v199, v182, v183 clamp
    v_mfma_f32_16x16x32_bf16 v[168:171], a[12:15], v[140:143], v[168:171]
    v_mul_f32_dpp v164, v44, v44 row_ror:2 row_mask:0xf bank_mask:0xf
    v_mul_f32_dpp v165, v45, v45 row_ror:2 row_mask:0xf bank_mask:0xf
    v_mfma_f32_16x16x32_bf16 v[172:175], a[28:31], v[140:143], v[4:7]
    v_cvt_pk_bf16_f32 v150, v164, v165
    v_mov_b32 v208, 0
    v_mfma_f32_16x16x32_bf16 v[172:175], a[24:27], v[136:139], v[172:175]
    v_mul_f32_dpp v166, v46, v46 row_ror:2 row_mask:0xf bank_mask:0xf
    v_mul_f32_dpp v167, v47, v47 row_ror:2 row_mask:0xf bank_mask:0xf
    v_mfma_f32_16x16x32_bf16 v[172:175], a[20:23], v[132:135], v[172:175]
    v_cvt_pk_bf16_f32 v184, v168, v169 clamp
    v_cvt_pk_bf16_f32 v185, v170, v171 clamp
    v_mfma_f32_16x16x32_bf16 v[172:175], a[16:19], v[128:131], v[172:175]
    v_mov_b32 v209, 0
    v_cvt_pk_bf16_f32 v151, v166, v167
    v_mfma_f32_16x16x32_bf16 v[176:179], a[32:35], v[128:131], v[8:11]
    v_mul_f32_dpp v160, v48, v48 row_ror:2 row_mask:0xf bank_mask:0xf
    v_mul_f32_dpp v161, v49, v49 row_ror:2 row_mask:0xf bank_mask:0xf
    v_mfma_f32_16x16x32_bf16 v[176:179], a[36:39], v[132:135], v[176:179]
    v_cvt_pk_bf16_f32 v152, v160, v161
    v_mul_f32_dpp v162, v50, v50 row_ror:2 row_mask:0xf bank_mask:0xf
    v_mfma_f32_16x16x32_bf16 v[176:179], a[40:43], v[136:139], v[176:179]
    v_cvt_pk_bf16_f32 v186, v172, v173 clamp
    v_cvt_pk_bf16_f32 v187, v174, v175 clamp
    v_mfma_f32_16x16x32_bf16 v[176:179], a[44:47], v[140:143], v[176:179]
    v_mul_f32_dpp v163, v51, v51 row_ror:2 row_mask:0xf bank_mask:0xf
    v_cvt_pk_bf16_f32 v153, v162, v163
    v_mfma_f32_16x16x32_bf16 v[180:183], a[60:63], v[140:143], v[12:15]
    v_mul_f32_dpp v164, v52, v52 row_ror:2 row_mask:0xf bank_mask:0xf
    v_mul_f32_dpp v165, v53, v53 row_ror:2 row_mask:0xf bank_mask:0xf
    v_mfma_f32_16x16x32_bf16 v[180:183], a[56:59], v[136:139], v[180:183]
    v_cvt_pk_bf16_f32 v154, v164, v165
    v_mul_f32_dpp v166, v54, v54 row_ror:2 row_mask:0xf bank_mask:0xf
    v_mfma_f32_16x16x32_bf16 v[180:183], a[52:55], v[132:135], v[180:183]
    v_cvt_pk_bf16_f32 v188, v176, v177 clamp
    v_cvt_pk_bf16_f32 v189, v178, v179 clamp
    v_mfma_f32_16x16x32_bf16 v[180:183], a[48:51], v[128:131], v[180:183]
    v_mul_f32_dpp v167, v55, v55 row_ror:2 row_mask:0xf bank_mask:0xf
    v_cvt_pk_bf16_f32 v155, v166, v167
    v_mfma_f32_16x16x32_bf16 v[204:207], v[112:115], v[64:67], 0
    v_mul_f32_dpp v160, v56, v56 row_ror:2 row_mask:0xf bank_mask:0xf
    v_mul_f32_dpp v161, v57, v57 row_ror:2 row_mask:0xf bank_mask:0xf
    v_mfma_f32_16x16x32_bf16 v[204:207], v[116:119], v[68:71], v[204:207]
    v_cvt_pk_bf16_f32 v156, v160, v161
    v_mul_f32_dpp v162, v58, v58 row_ror:2 row_mask:0xf bank_mask:0xf
    v_mfma_f32_16x16x32_bf16 v[204:207], v[120:123], v[72:75], v[204:207]
    v_cvt_pk_bf16_f32 v190, v180, v181 clamp
    v_cvt_pk_bf16_f32 v191, v182, v183 clamp
    v_mfma_f32_16x16x32_bf16 v[204:207], v[124:127], v[76:79], v[204:207]
    v_mul_f32_dpp v163, v59, v59 row_ror:2 row_mask:0xf bank_mask:0xf
    v_cvt_pk_bf16_f32 v157, v162, v163
    v_mfma_f32_16x16x32_bf16 v[168:171], a[64:67], v[128:131], v[16:19]
    global_load_dwordx4 v[112:115], v247, s[6:7] offset:0
    v_mfma_f32_16x16x32_bf16 v[168:171], a[68:71], v[132:135], v[168:171]
    v_mul_f32_dpp v164, v60, v60 row_ror:2 row_mask:0xf bank_mask:0xf
    v_mul_f32_dpp v165, v61, v61 row_ror:2 row_mask:0xf bank_mask:0xf
    v_mfma_f32_16x16x32_bf16 v[168:171], a[72:75], v[136:139], v[168:171]
    ds_write_b128 v242, v[204:207] offset:1280
    v_mfma_f32_16x16x32_bf16 v[168:171], a[76:79], v[140:143], v[168:171]
    v_cvt_pk_bf16_f32 v158, v164, v165
    v_mul_f32_dpp v166, v62, v62 row_ror:2 row_mask:0xf bank_mask:0xf
    v_mfma_f32_16x16x32_bf16 v[172:175], a[92:95], v[140:143], v[20:23]
    v_mul_f32_dpp v167, v63, v63 row_ror:2 row_mask:0xf bank_mask:0xf
    v_cvt_pk_bf16_f32 v159, v166, v167
    v_mfma_f32_16x16x32_bf16 v[172:175], a[88:91], v[136:139], v[172:175]
    v_mul_f32_dpp v160, v32, v32 row_ror:3 row_mask:0xf bank_mask:0xf
    v_mul_f32_dpp v161, v33, v33 row_ror:3 row_mask:0xf bank_mask:0xf
    v_mfma_f32_16x16x32_bf16 v[172:175], a[84:87], v[132:135], v[172:175]
    v_mul_f32_dpp v162, v34, v34 row_ror:3 row_mask:0xf bank_mask:0xf
    v_mul_f32_dpp v163, v35, v35 row_ror:3 row_mask:0xf bank_mask:0xf
    v_mfma_f32_16x16x32_bf16 v[172:175], a[80:83], v[128:131], v[172:175]
    v_mul_f32_dpp v164, v36, v36 row_ror:3 row_mask:0xf bank_mask:0xf
    v_mul_f32_dpp v165, v37, v37 row_ror:3 row_mask:0xf bank_mask:0xf
    v_smfmac_f32_16x16x64_bf16 v[200:203], a[156:159], v[192:199], v233
    v_cvt_pk_bf16_f32 v192, v168, v169 clamp
    v_smfmac_f32_16x16x64_bf16 v[208:211], a[128:131], v[184:191], v233
    v_cvt_pk_bf16_f32 v193, v170, v171 clamp
    v_mfma_f32_16x16x32_bf16 v[176:179], a[96:99], v[128:131], v[24:27]
    global_load_dwordx4 v[116:119], v247, s[6:7] offset:64
    v_mfma_f32_16x16x32_bf16 v[176:179], a[100:103], v[132:135], v[176:179]
    v_cvt_pk_bf16_f32 v194, v172, v173 clamp
    v_cvt_pk_bf16_f32 v195, v174, v175 clamp
    v_mfma_f32_16x16x32_bf16 v[176:179], a[104:107], v[136:139], v[176:179]
    v_add_f32 v200, v200, v201
    v_cndmask_b32 v231, v234, v200, s[20:21]
    v_mfma_f32_16x16x32_bf16 v[176:179], a[108:111], v[140:143], v[176:179]
    v_cndmask_b32 v232, v234, v200, s[28:29]
    v_mul_f32_dpp v166, v38, v38 row_ror:3 row_mask:0xf bank_mask:0xf
    v_mfma_f32_16x16x32_bf16 v[180:183], a[124:127], v[140:143], v[28:31]
    v_mul_f32_dpp v167, v39, v39 row_ror:3 row_mask:0xf bank_mask:0xf
    v_max3_f32 v235, v226, v231, v227
    v_mfma_f32_16x16x32_bf16 v[180:183], a[120:123], v[136:139], v[180:183]
    v_max3_f32 v235, v235, v228, v229
    v_max_f32 v235, v235, v230
    v_mfma_f32_16x16x32_bf16 v[180:183], a[116:119], v[132:135], v[180:183]
    v_cvt_pk_bf16_f32 v196, v176, v177 clamp
    v_cvt_pk_bf16_f32 v197, v178, v179 clamp
    v_mfma_f32_16x16x32_bf16 v[180:183], a[112:115], v[128:131], v[180:183]
    v_cvt_pk_bf16_f32 v128, v160, v161
    v_cvt_pk_bf16_f32 v129, v162, v163
    v_mfma_f32_16x16x32_bf16 v[168:171], a[0:3], v[144:147], v[0:3]
    global_load_dwordx4 v[120:123], v247, s[6:7] offset:128
    v_mfma_f32_16x16x32_bf16 v[168:171], a[4:7], v[148:151], v[168:171]
    v_cvt_pk_bf16_f32 v130, v164, v165
    v_cvt_pk_bf16_f32 v131, v166, v167
    v_mfma_f32_16x16x32_bf16 v[168:171], a[8:11], v[152:155], v[168:171]
    v_cvt_pk_bf16_f32 v198, v180, v181 clamp
    v_cvt_pk_bf16_f32 v199, v182, v183 clamp
    v_mfma_f32_16x16x32_bf16 v[168:171], a[12:15], v[156:159], v[168:171]
    v_mul_f32_dpp v160, v40, v40 row_ror:3 row_mask:0xf bank_mask:0xf
    v_mul_f32_dpp v161, v41, v41 row_ror:3 row_mask:0xf bank_mask:0xf
    v_mfma_f32_16x16x32_bf16 v[172:175], a[28:31], v[156:159], v[4:7]
    v_cvt_pk_bf16_f32 v132, v160, v161
    v_mul_f32_dpp v162, v42, v42 row_ror:3 row_mask:0xf bank_mask:0xf
    v_mfma_f32_16x16x32_bf16 v[172:175], a[24:27], v[152:155], v[172:175]
    v_mul_f32_dpp v163, v43, v43 row_ror:3 row_mask:0xf bank_mask:0xf
    v_cvt_pk_bf16_f32 v133, v162, v163
    v_mfma_f32_16x16x32_bf16 v[172:175], a[20:23], v[148:151], v[172:175]
    v_cvt_pk_bf16_f32 v184, v168, v169 clamp
    v_cvt_pk_bf16_f32 v185, v170, v171 clamp
    v_mfma_f32_16x16x32_bf16 v[172:175], a[16:19], v[144:147], v[172:175]
    v_mul_f32_dpp v164, v44, v44 row_ror:3 row_mask:0xf bank_mask:0xf
    v_mul_f32_dpp v165, v45, v45 row_ror:3 row_mask:0xf bank_mask:0xf
    v_mfma_f32_16x16x32_bf16 v[176:179], a[32:35], v[144:147], v[8:11]
    v_cvt_pk_bf16_f32 v134, v164, v165
    v_mul_f32_dpp v166, v46, v46 row_ror:3 row_mask:0xf bank_mask:0xf
    v_mfma_f32_16x16x32_bf16 v[176:179], a[36:39], v[148:151], v[176:179]
    global_load_dwordx4 v[124:127], v247, s[6:7] offset:192
    v_mfma_f32_16x16x32_bf16 v[176:179], a[40:43], v[152:155], v[176:179]
    v_cvt_pk_bf16_f32 v186, v172, v173 clamp
    v_cvt_pk_bf16_f32 v187, v174, v175 clamp
    v_mfma_f32_16x16x32_bf16 v[176:179], a[44:47], v[156:159], v[176:179]
    v_mul_f32_dpp v167, v47, v47 row_ror:3 row_mask:0xf bank_mask:0xf
    v_cvt_pk_bf16_f32 v135, v166, v167
    v_mfma_f32_16x16x32_bf16 v[180:183], a[60:63], v[156:159], v[12:15]
    v_mul_f32_dpp v160, v48, v48 row_ror:3 row_mask:0xf bank_mask:0xf
    v_mul_f32_dpp v161, v49, v49 row_ror:3 row_mask:0xf bank_mask:0xf
    v_mfma_f32_16x16x32_bf16 v[180:183], a[56:59], v[152:155], v[180:183]
    v_cvt_pk_bf16_f32 v136, v160, v161
    v_mul_f32_dpp v162, v50, v50 row_ror:3 row_mask:0xf bank_mask:0xf
    v_mfma_f32_16x16x32_bf16 v[180:183], a[52:55], v[148:151], v[180:183]
    v_cvt_pk_bf16_f32 v188, v176, v177 clamp
    v_cvt_pk_bf16_f32 v189, v178, v179 clamp
    v_mfma_f32_16x16x32_bf16 v[180:183], a[48:51], v[144:147], v[180:183]
    v_mul_f32_dpp v163, v51, v51 row_ror:3 row_mask:0xf bank_mask:0xf
    v_cvt_pk_bf16_f32 v137, v162, v163
    v_mfma_f32_16x16x32_bf16 v[168:171], a[64:67], v[144:147], v[16:19]
    v_mul_f32_dpp v164, v52, v52 row_ror:3 row_mask:0xf bank_mask:0xf
    v_mul_f32_dpp v165, v53, v53 row_ror:3 row_mask:0xf bank_mask:0xf
    v_mfma_f32_16x16x32_bf16 v[168:171], a[68:71], v[148:151], v[168:171]
    v_cvt_pk_bf16_f32 v138, v164, v165
    v_mul_f32_dpp v166, v54, v54 row_ror:3 row_mask:0xf bank_mask:0xf
    v_mfma_f32_16x16x32_bf16 v[168:171], a[72:75], v[152:155], v[168:171]
    v_cvt_pk_bf16_f32 v190, v180, v181 clamp
    v_cvt_pk_bf16_f32 v191, v182, v183 clamp
    v_mfma_f32_16x16x32_bf16 v[168:171], a[76:79], v[156:159], v[168:171]
    v_mul_f32_dpp v167, v55, v55 row_ror:3 row_mask:0xf bank_mask:0xf
    v_cvt_pk_bf16_f32 v139, v166, v167
    v_mfma_f32_16x16x32_bf16 v[172:175], a[92:95], v[156:159], v[20:23]
    v_mul_f32_dpp v160, v56, v56 row_ror:3 row_mask:0xf bank_mask:0xf
    v_mul_f32_dpp v161, v57, v57 row_ror:3 row_mask:0xf bank_mask:0xf
    v_mfma_f32_16x16x32_bf16 v[172:175], a[88:91], v[152:155], v[172:175]
    v_cvt_pk_bf16_f32 v140, v160, v161
    v_mul_f32_dpp v162, v58, v58 row_ror:3 row_mask:0xf bank_mask:0xf
    v_mfma_f32_16x16x32_bf16 v[172:175], a[84:87], v[148:151], v[172:175]
    v_mul_f32_dpp v163, v59, v59 row_ror:3 row_mask:0xf bank_mask:0xf
    v_cvt_pk_bf16_f32 v141, v162, v163
    v_mfma_f32_16x16x32_bf16 v[172:175], a[80:83], v[144:147], v[172:175]
    v_mul_f32_dpp v164, v60, v60 row_ror:3 row_mask:0xf bank_mask:0xf
    v_mul_f32_dpp v165, v61, v61 row_ror:3 row_mask:0xf bank_mask:0xf
    v_smfmac_f32_16x16x64_bf16 v[208:211], a[132:135], v[192:199], v233
    v_cvt_pk_bf16_f32 v192, v168, v169 clamp
    v_smfmac_f32_16x16x64_bf16 v[208:211], a[136:139], v[184:191], v233
    v_cvt_pk_bf16_f32 v193, v170, v171 clamp
    v_mfma_f32_16x16x32_bf16 v[176:179], a[96:99], v[144:147], v[24:27]
    v_cvt_pk_bf16_f32 v142, v164, v165
    v_cvt_pk_bf16_f32 v194, v172, v173 clamp
    v_mfma_f32_16x16x32_bf16 v[176:179], a[100:103], v[148:151], v[176:179]
    v_cvt_pk_bf16_f32 v195, v174, v175 clamp
    v_mul_f32_dpp v166, v62, v62 row_ror:3 row_mask:0xf bank_mask:0xf
    v_mfma_f32_16x16x32_bf16 v[176:179], a[104:107], v[152:155], v[176:179]
    v_mul_f32_dpp v167, v63, v63 row_ror:3 row_mask:0xf bank_mask:0xf
    v_max_f32_dpp v235, v235, v235 row_ror:8 row_mask:0xf bank_mask:0xf
    v_mfma_f32_16x16x32_bf16 v[176:179], a[108:111], v[156:159], v[176:179]
    v_cvt_pk_bf16_f32 v143, v166, v167
    v_mul_f32_dpp v160, v32, v32 row_ror:4 row_mask:0xf bank_mask:0xf
    v_mfma_f32_16x16x32_bf16 v[180:183], a[124:127], v[156:159], v[28:31]
    v_mul_f32_dpp v161, v33, v33 row_ror:4 row_mask:0xf bank_mask:0xf
    v_mul_f32_dpp v162, v34, v34 row_ror:4 row_mask:0xf bank_mask:0xf
    v_mfma_f32_16x16x32_bf16 v[180:183], a[120:123], v[152:155], v[180:183]
    v_max_f32_dpp v235, v235, v235 row_ror:4 row_mask:0xf bank_mask:0xf
    v_mul_f32_dpp v163, v35, v35 row_ror:4 row_mask:0xf bank_mask:0xf
    v_mfma_f32_16x16x32_bf16 v[180:183], a[116:119], v[148:151], v[180:183]
    v_cvt_pk_bf16_f32 v196, v176, v177 clamp
    v_cvt_pk_bf16_f32 v197, v178, v179 clamp
    v_mfma_f32_16x16x32_bf16 v[180:183], a[112:115], v[144:147], v[180:183]
    v_cvt_pk_bf16_f32 v144, v160, v161
    v_cvt_pk_bf16_f32 v145, v162, v163
    v_mfma_f32_16x16x32_bf16 v[168:171], a[0:3], v[128:131], v[0:3]
    v_mul_f32_dpp v164, v36, v36 row_ror:4 row_mask:0xf bank_mask:0xf
    v_mul_f32_dpp v165, v37, v37 row_ror:4 row_mask:0xf bank_mask:0xf
    v_mfma_f32_16x16x32_bf16 v[168:171], a[4:7], v[132:135], v[168:171]
    v_cvt_pk_bf16_f32 v146, v164, v165
    v_mul_f32_dpp v166, v38, v38 row_ror:4 row_mask:0xf bank_mask:0xf
    v_mfma_f32_16x16x32_bf16 v[168:171], a[8:11], v[136:139], v[168:171]
    v_cvt_pk_bf16_f32 v198, v180, v181 clamp
    v_cvt_pk_bf16_f32 v199, v182, v183 clamp
    v_mfma_f32_16x16x32_bf16 v[168:171], a[12:15], v[140:143], v[168:171]
    v_mul_f32_dpp v167, v39, v39 row_ror:4 row_mask:0xf bank_mask:0xf
    v_cvt_pk_bf16_f32 v147, v166, v167
    v_mfma_f32_16x16x32_bf16 v[172:175], a[28:31], v[140:143], v[4:7]
    v_mul_f32_dpp v160, v40, v40 row_ror:4 row_mask:0xf bank_mask:0xf
    v_max_f32_dpp v235, v235, v235 row_ror:2 row_mask:0xf bank_mask:0xf
    v_mfma_f32_16x16x32_bf16 v[172:175], a[24:27], v[136:139], v[172:175]
    v_mul_f32_dpp v161, v41, v41 row_ror:4 row_mask:0xf bank_mask:0xf
    v_cvt_pk_bf16_f32 v148, v160, v161
    v_mfma_f32_16x16x32_bf16 v[172:175], a[20:23], v[132:135], v[172:175]
    v_cvt_pk_bf16_f32 v184, v168, v169 clamp
    v_cvt_pk_bf16_f32 v185, v170, v171 clamp
    v_mfma_f32_16x16x32_bf16 v[172:175], a[16:19], v[128:131], v[172:175]
    v_mul_f32_dpp v162, v42, v42 row_ror:4 row_mask:0xf bank_mask:0xf
    v_mul_f32_dpp v163, v43, v43 row_ror:4 row_mask:0xf bank_mask:0xf
    v_mfma_f32_16x16x32_bf16 v[176:179], a[32:35], v[128:131], v[8:11]
    v_cvt_pk_bf16_f32 v149, v162, v163
    v_mul_f32_dpp v164, v44, v44 row_ror:4 row_mask:0xf bank_mask:0xf
    v_mfma_f32_16x16x32_bf16 v[176:179], a[36:39], v[132:135], v[176:179]
    v_mul_f32_dpp v165, v45, v45 row_ror:4 row_mask:0xf bank_mask:0xf
    v_cvt_pk_bf16_f32 v150, v164, v165
    v_mfma_f32_16x16x32_bf16 v[176:179], a[40:43], v[136:139], v[176:179]
    v_cvt_pk_bf16_f32 v186, v172, v173 clamp
    v_cvt_pk_bf16_f32 v187, v174, v175 clamp
    v_mfma_f32_16x16x32_bf16 v[176:179], a[44:47], v[140:143], v[176:179]
    v_mul_f32_dpp v166, v46, v46 row_ror:4 row_mask:0xf bank_mask:0xf
    v_max_f32_dpp v235, v235, v235 row_ror:1 row_mask:0xf bank_mask:0xf
    v_mfma_f32_16x16x32_bf16 v[180:183], a[60:63], v[140:143], v[12:15]
    v_mul_f32_dpp v167, v47, v47 row_ror:4 row_mask:0xf bank_mask:0xf
    v_cvt_pk_bf16_f32 v151, v166, v167
    v_mfma_f32_16x16x32_bf16 v[180:183], a[56:59], v[136:139], v[180:183]
    v_mul_f32_dpp v160, v48, v48 row_ror:4 row_mask:0xf bank_mask:0xf
    v_mul_f32_dpp v161, v49, v49 row_ror:4 row_mask:0xf bank_mask:0xf
    v_mfma_f32_16x16x32_bf16 v[180:183], a[52:55], v[132:135], v[180:183]
    v_cvt_pk_bf16_f32 v188, v176, v177 clamp
    v_cvt_pk_bf16_f32 v189, v178, v179 clamp
    v_mfma_f32_16x16x32_bf16 v[180:183], a[48:51], v[128:131], v[180:183]
    v_cvt_pk_bf16_f32 v152, v160, v161
    v_mul_f32_dpp v162, v50, v50 row_ror:4 row_mask:0xf bank_mask:0xf
    v_mfma_f32_16x16x32_bf16 v[168:171], a[64:67], v[128:131], v[16:19]
L_pad5:
    s_cbranch_vccnz L_pad9
    v_mul_f32_dpp v163, v51, v51 row_ror:4 row_mask:0xf bank_mask:0xf
    v_cvt_pk_bf16_f32 v153, v162, v163
    v_mfma_f32_16x16x32_bf16 v[168:171], a[68:71], v[132:135], v[168:171]
    ds_read_b32 v224, v243 offset:0
    v_mfma_f32_16x16x32_bf16 v[168:171], a[72:75], v[136:139], v[168:171]
    v_cvt_pk_bf16_f32 v190, v180, v181 clamp
    v_cvt_pk_bf16_f32 v191, v182, v183 clamp
    v_mfma_f32_16x16x32_bf16 v[168:171], a[76:79], v[140:143], v[168:171]
    v_mul_f32_dpp v164, v52, v52 row_ror:4 row_mask:0xf bank_mask:0xf
    v_max_f32_dpp v235, v235, v235 row_bcast:15 row_mask:0xa bank_mask:0xf
    v_mfma_f32_16x16x32_bf16 v[172:175], a[92:95], v[140:143], v[20:23]
    v_mul_f32_dpp v165, v53, v53 row_ror:4 row_mask:0xf bank_mask:0xf
    v_cvt_pk_bf16_f32 v154, v164, v165
    v_mfma_f32_16x16x32_bf16 v[172:175], a[88:91], v[136:139], v[172:175]
    v_mul_f32_dpp v166, v54, v54 row_ror:4 row_mask:0xf bank_mask:0xf
    v_mul_f32_dpp v167, v55, v55 row_ror:4 row_mask:0xf bank_mask:0xf
    v_mfma_f32_16x16x32_bf16 v[172:175], a[84:87], v[132:135], v[172:175]
    v_cvt_pk_bf16_f32 v155, v166, v167
    v_mul_f32_dpp v160, v56, v56 row_ror:4 row_mask:0xf bank_mask:0xf
    v_mfma_f32_16x16x32_bf16 v[172:175], a[80:83], v[128:131], v[172:175]
    ds_read_b32 v225, v244 offset:0
    v_smfmac_f32_16x16x64_bf16 v[208:211], a[140:143], v[192:199], v233
    v_cvt_pk_bf16_f32 v192, v168, v169 clamp
    v_smfmac_f32_16x16x64_bf16 v[208:211], a[144:147], v[184:191], v233
    v_cvt_pk_bf16_f32 v193, v170, v171 clamp
    v_mfma_f32_16x16x32_bf16 v[176:179], a[96:99], v[128:131], v[24:27]
    v_mul_f32_dpp v161, v57, v57 row_ror:4 row_mask:0xf bank_mask:0xf
    v_cvt_pk_bf16_f32 v156, v160, v161
    v_mfma_f32_16x16x32_bf16 v[176:179], a[100:103], v[132:135], v[176:179]
    v_mul_f32_dpp v162, v58, v58 row_ror:4 row_mask:0xf bank_mask:0xf
    v_max_f32_dpp v235, v235, v235 row_bcast:31 row_mask:0xc bank_mask:0xf
    v_mfma_f32_16x16x32_bf16 v[176:179], a[104:107], v[136:139], v[176:179]
    v_cvt_pk_bf16_f32 v194, v172, v173 clamp
    v_mul_f32_dpp v163, v59, v59 row_ror:4 row_mask:0xf bank_mask:0xf
    v_mfma_f32_16x16x32_bf16 v[176:179], a[108:111], v[140:143], v[176:179]
    v_cvt_pk_bf16_f32 v195, v174, v175 clamp
    v_cvt_pk_bf16_f32 v157, v162, v163
    v_mfma_f32_16x16x32_bf16 v[180:183], a[124:127], v[140:143], v[28:31]
    v_mul_f32_dpp v164, v60, v60 row_ror:4 row_mask:0xf bank_mask:0xf
    v_mul_f32_dpp v165, v61, v61 row_ror:4 row_mask:0xf bank_mask:0xf
    v_mfma_f32_16x16x32_bf16 v[180:183], a[120:123], v[136:139], v[180:183]
    v_cvt_pk_bf16_f32 v158, v164, v165
    v_mul_f32_dpp v166, v62, v62 row_ror:4 row_mask:0xf bank_mask:0xf
    v_mfma_f32_16x16x32_bf16 v[180:183], a[116:119], v[132:135], v[180:183]
    v_mul_f32_dpp v167, v63, v63 row_ror:4 row_mask:0xf bank_mask:0xf
    v_cvt_pk_bf16_f32 v159, v166, v167
    v_mfma_f32_16x16x32_bf16 v[180:183], a[112:115], v[128:131], v[180:183]
    v_mul_f32 v235, v253, v235
    v_cvt_pk_bf16_f32 v196, v176, v177 clamp
    v_mfma_f32_16x16x32_bf16 v[168:171], a[0:3], v[144:147], v[0:3]
    v_cvt_pk_bf16_f32 v197, v178, v179 clamp
    v_mul_f32_dpp v160, v32, v32 row_ror:5 row_mask:0xf bank_mask:0xf
    v_mfma_f32_16x16x32_bf16 v[168:171], a[4:7], v[148:151], v[168:171]
    buffer_load_dword v245, v248, s[36:39], s22 offen offset:104
    v_mfma_f32_16x16x32_bf16 v[168:171], a[8:11], v[152:155], v[168:171]
    v_mul_f32_dpp v161, v33, v33 row_ror:5 row_mask:0xf bank_mask:0xf
    v_cvt_pk_bf16_f32 v128, v160, v161
    v_mfma_f32_16x16x32_bf16 v[168:171], a[12:15], v[156:159], v[168:171]
    v_cvt_pk_bf16_f32 v198, v180, v181 clamp
    v_mul_f32_dpp v162, v34, v34 row_ror:5 row_mask:0xf bank_mask:0xf
    v_mfma_f32_16x16x32_bf16 v[172:175], a[28:31], v[156:159], v[4:7]
    v_cvt_pk_bf16_f32 v199, v182, v183 clamp
    v_mul_f32_dpp v163, v35, v35 row_ror:5 row_mask:0xf bank_mask:0xf
    v_mfma_f32_16x16x32_bf16 v[172:175], a[24:27], v[152:155], v[172:175]
    s_waitcnt lgkmcnt(0)
    v_mov_b32_dpp v218, v225 quad_perm:[0,1,2,3] row_mask:0x7 bank_mask:0xf
    v_mfma_f32_16x16x32_bf16 v[172:175], a[20:23], v[148:151], v[172:175]
    v_fma_f32 v235, |v235|, s23, v235
    v_cvt_pk_bf16_f32 v129, v162, v163
    v_mfma_f32_16x16x32_bf16 v[172:175], a[16:19], v[144:147], v[172:175]
    v_mul_f32_dpp v164, v36, v36 row_ror:5 row_mask:0xf bank_mask:0xf
    v_mul_f32_dpp v165, v37, v37 row_ror:5 row_mask:0xf bank_mask:0xf
    v_mfma_f32_16x16x32_bf16 v[176:179], a[32:35], v[144:147], v[8:11]
    v_cvt_pk_bf16_f32 v184, v168, v169 clamp
    v_cvt_pk_bf16_f32 v130, v164, v165
    v_mfma_f32_16x16x32_bf16 v[176:179], a[36:39], v[148:151], v[176:179]
    v_mul_f32_dpp v166, v38, v38 row_ror:5 row_mask:0xf bank_mask:0xf
    v_cvt_pk_bf16_f32 v185, v170, v171 clamp
    v_mfma_f32_16x16x32_bf16 v[176:179], a[40:43], v[152:155], v[176:179]
    v_mul_f32_dpp v167, v39, v39 row_ror:5 row_mask:0xf bank_mask:0xf
    v_cvt_pk_bf16_f32 v131, v166, v167
    v_mfma_f32_16x16x32_bf16 v[176:179], a[44:47], v[156:159], v[176:179]
    buffer_load_dword v246, v249, s[36:39], s22 offen offset:168
    v_mfma_f32_16x16x32_bf16 v[180:183], a[60:63], v[156:159], v[12:15]
    v_mul_f32_dpp v160, v40, v40 row_ror:5 row_mask:0xf bank_mask:0xf
    v_readlane_b32 s24, v235, 63
    v_mfma_f32_16x16x32_bf16 v[180:183], a[56:59], v[152:155], v[180:183]
    v_mul_f32_dpp v161, v41, v41 row_ror:5 row_mask:0xf bank_mask:0xf
    v_cvt_pk_bf16_f32 v186, v172, v173 clamp
    v_mfma_f32_16x16x32_bf16 v[180:183], a[52:55], v[148:151], v[180:183]
    v_cvt_pk_bf16_f32 v132, v160, v161
    v_cvt_pk_bf16_f32 v187, v174, v175 clamp
    v_mfma_f32_16x16x32_bf16 v[180:183], a[48:51], v[144:147], v[180:183]
    v_mul_f32_dpp v162, v42, v42 row_ror:5 row_mask:0xf bank_mask:0xf
    v_mul_f32_dpp v163, v43, v43 row_ror:5 row_mask:0xf bank_mask:0xf
    v_mfma_f32_16x16x32_bf16 v[168:171], a[64:67], v[144:147], v[16:19]
    v_cvt_pk_bf16_f32 v133, v162, v163
    v_mul_f32_dpp v164, v44, v44 row_ror:5 row_mask:0xf bank_mask:0xf
    v_mfma_f32_16x16x32_bf16 v[168:171], a[68:71], v[148:151], v[168:171]
    v_cvt_pk_bf16_f32 v188, v176, v177 clamp
    v_mul_f32_dpp v165, v45, v45 row_ror:5 row_mask:0xf bank_mask:0xf
    v_mfma_f32_16x16x32_bf16 v[168:171], a[72:75], v[152:155], v[168:171]
    v_cvt_pk_bf16_f32 v134, v164, v165
    v_cvt_pk_bf16_f32 v189, v178, v179 clamp
    v_mfma_f32_16x16x32_bf16 v[168:171], a[76:79], v[156:159], v[168:171]
    v_fma_f32 v226, v226, v253, -s24
    v_mul_f32_dpp v166, v46, v46 row_ror:5 row_mask:0xf bank_mask:0xf
    v_mfma_f32_16x16x32_bf16 v[172:175], a[92:95], v[156:159], v[20:23]
    v_mul_f32_dpp v167, v47, v47 row_ror:5 row_mask:0xf bank_mask:0xf
    v_cvt_pk_bf16_f32 v135, v166, v167
    v_mfma_f32_16x16x32_bf16 v[172:175], a[88:91], v[152:155], v[172:175]
    v_mul_f32_dpp v160, v48, v48 row_ror:5 row_mask:0xf bank_mask:0xf
    v_cvt_pk_bf16_f32 v190, v180, v181 clamp
    v_mfma_f32_16x16x32_bf16 v[172:175], a[84:87], v[148:151], v[172:175]
    buffer_load_dword v247, v250, s[36:39], s22 offen offset:168
    v_mfma_f32_16x16x32_bf16 v[172:175], a[80:83], v[144:147], v[172:175]
    v_mul_f32_dpp v161, v49, v49 row_ror:5 row_mask:0xf bank_mask:0xf
    v_cvt_pk_bf16_f32 v191, v182, v183 clamp
    v_smfmac_f32_16x16x64_bf16 v[208:211], a[148:151], v[192:199], v233
    v_cvt_pk_bf16_f32 v136, v160, v161
    v_smfmac_f32_16x16x64_bf16 v[208:211], a[152:155], v[184:191], v233
    v_mul_f32_dpp v162, v50, v50 row_ror:5 row_mask:0xf bank_mask:0xf
    v_mfma_f32_16x16x32_bf16 v[176:179], a[96:99], v[144:147], v[24:27]
    v_mul_f32_dpp v163, v51, v51 row_ror:5 row_mask:0xf bank_mask:0xf
    v_cvt_pk_bf16_f32 v137, v162, v163
    v_mfma_f32_16x16x32_bf16 v[176:179], a[100:103], v[148:151], v[176:179]
    v_exp_f32_e64 v226, v226 clamp
    v_mfma_f32_16x16x32_bf16 v[176:179], a[104:107], v[152:155], v[176:179]
    v_cvt_pk_bf16_f32 v192, v168, v169 clamp
    v_mul_f32_dpp v164, v52, v52 row_ror:5 row_mask:0xf bank_mask:0xf
    v_mfma_f32_16x16x32_bf16 v[176:179], a[108:111], v[156:159], v[176:179]
    v_cvt_pk_bf16_f32 v193, v170, v171 clamp
    v_mul_f32_dpp v165, v53, v53 row_ror:5 row_mask:0xf bank_mask:0xf
    s_waitcnt vmcnt(7)
    v_mfma_f32_16x16x32_bf16 v[220:223], v[80:83], v[64:67], 0
    v_cvt_pk_bf16_f32 v138, v164, v165
    v_mul_f32_dpp v166, v54, v54 row_ror:5 row_mask:0xf bank_mask:0xf
    v_mfma_f32_16x16x32_bf16 v[220:223], v[84:87], v[68:71], v[220:223]
    v_mul_f32_dpp v167, v55, v55 row_ror:5 row_mask:0xf bank_mask:0xf
    v_cvt_pk_bf16_f32 v139, v166, v167
    v_mfma_f32_16x16x32_bf16 v[220:223], v[88:91], v[72:75], v[220:223]
    v_cvt_pk_bf16_f32 v194, v172, v173 clamp
    v_mul_f32_dpp v160, v56, v56 row_ror:5 row_mask:0xf bank_mask:0xf
    v_mfma_f32_16x16x32_bf16 v[220:223], v[92:95], v[76:79], v[220:223]
    s_addk_i32 s22, 208
    v_cvt_pk_bf16_f32 v195, v174, v175 clamp
    v_mfma_f32_16x16x32_bf16 v[180:183], a[124:127], v[156:159], v[28:31]
    v_mul_f32_dpp v161, v57, v57 row_ror:5 row_mask:0xf bank_mask:0xf
    v_cvt_pk_bf16_f32 v140, v160, v161
    v_mfma_f32_16x16x32_bf16 v[180:183], a[120:123], v[152:155], v[180:183]
    v_mul_f32 v236, v226, v224
    v_mul_f32_dpp v162, v58, v58 row_ror:5 row_mask:0xf bank_mask:0xf
    v_mfma_f32_16x16x32_bf16 v[180:183], a[116:119], v[148:151], v[180:183]
    v_mul_f32_dpp v163, v59, v59 row_ror:5 row_mask:0xf bank_mask:0xf
    v_cvt_pk_bf16_f32 v141, v162, v163
    v_mfma_f32_16x16x32_bf16 v[180:183], a[112:115], v[144:147], v[180:183]
    v_mul_f32_dpp v164, v60, v60 row_ror:5 row_mask:0xf bank_mask:0xf
    v_mul_f32_dpp v165, v61, v61 row_ror:5 row_mask:0xf bank_mask:0xf
    v_mfma_f32_16x16x32_bf16 v[168:171], a[0:3], v[128:131], v[0:3]
    v_cvt_pk_bf16_f32 v196, v176, v177 clamp
    v_cvt_pk_bf16_f32 v142, v164, v165
    v_mfma_f32_16x16x32_bf16 v[168:171], a[4:7], v[132:135], v[168:171]
    v_cvt_pk_bf16_f32 v197, v178, v179 clamp
    v_mul_f32_dpp v166, v62, v62 row_ror:5 row_mask:0xf bank_mask:0xf
    v_mfma_f32_16x16x32_bf16 v[168:171], a[8:11], v[136:139], v[168:171]
    v_mul_f32_dpp v167, v63, v63 row_ror:5 row_mask:0xf bank_mask:0xf
    v_cvt_pk_bf16_f32 v143, v166, v167
    v_fma_f32 v231, v231, v253, -s24
    s_cmp_lt_u32 s22, 520
    v_mfma_f32_16x16x32_bf16 v[168:171], a[12:15], v[140:143], v[168:171]
    v_mul_f32_dpp v160, v32, v32 row_ror:6 row_mask:0xf bank_mask:0xf
    v_mul_f32_dpp v161, v33, v33 row_ror:6 row_mask:0xf bank_mask:0xf
    v_mfma_f32_16x16x32_bf16 v[172:175], a[28:31], v[140:143], v[4:7]
    v_cvt_pk_bf16_f32 v144, v160, v161
    v_cvt_pk_bf16_f32 v198, v180, v181 clamp
    v_mfma_f32_16x16x32_bf16 v[172:175], a[24:27], v[136:139], v[172:175]
    v_mul_f32_dpp v162, v34, v34 row_ror:6 row_mask:0xf bank_mask:0xf
    v_cvt_pk_bf16_f32 v199, v182, v183 clamp
    v_mfma_f32_16x16x32_bf16 v[172:175], a[20:23], v[132:135], v[172:175]
    v_mul_f32_dpp v163, v35, v35 row_ror:6 row_mask:0xf bank_mask:0xf
    v_cvt_pk_bf16_f32 v145, v162, v163
    v_mfma_f32_16x16x32_bf16 v[172:175], a[16:19], v[128:131], v[172:175]
    v_exp_f32_e64 v231, v231 clamp
    v_mfma_f32_16x16x32_bf16 v[176:179], a[32:35], v[128:131], v[8:11]
    v_mul_f32_dpp v164, v36, v36 row_ror:6 row_mask:0xf bank_mask:0xf
    v_mul_f32_dpp v165, v37, v37 row_ror:6 row_mask:0xf bank_mask:0xf
    v_mfma_f32_16x16x32_bf16 v[176:179], a[36:39], v[132:135], v[176:179]
    v_cvt_pk_bf16_f32 v184, v168, v169 clamp
    v_cvt_pk_bf16_f32 v146, v164, v165
    v_mfma_f32_16x16x32_bf16 v[176:179], a[40:43], v[136:139], v[176:179]
    v_cvt_pk_bf16_f32 v185, v170, v171 clamp
    v_mul_f32_dpp v166, v38, v38 row_ror:6 row_mask:0xf bank_mask:0xf
    v_mfma_f32_16x16x32_bf16 v[176:179], a[44:47], v[140:143], v[176:179]
    v_mul_f32_dpp v167, v39, v39 row_ror:6 row_mask:0xf bank_mask:0xf
    v_cvt_pk_bf16_f32 v147, v166, v167
    v_mfma_f32_16x16x32_bf16 v[180:183], a[60:63], v[140:143], v[12:15]
    v_mul_f32_dpp v160, v40, v40 row_ror:6 row_mask:0xf bank_mask:0xf
    v_cvt_pk_bf16_f32 v186, v172, v173 clamp
    v_mfma_f32_16x16x32_bf16 v[180:183], a[56:59], v[136:139], v[180:183]
    v_mul_f32_dpp v161, v41, v41 row_ror:6 row_mask:0xf bank_mask:0xf
    v_mov_b32 v200, 0
    v_mfma_f32_16x16x32_bf16 v[180:183], a[52:55], v[132:135], v[180:183]
    v_fmac_f32 v236, v231, v225
    v_cvt_pk_bf16_f32 v187, v174, v175 clamp
    v_mfma_f32_16x16x32_bf16 v[180:183], a[48:51], v[128:131], v[180:183]
    v_cvt_pk_bf16_f32 v148, v160, v161
    v_mul_f32_dpp v162, v42, v42 row_ror:6 row_mask:0xf bank_mask:0xf
    v_mfma_f32_16x16x32_bf16 v[168:171], a[64:67], v[128:131], v[16:19]
    v_mov_b32 v201, 0
    v_mul_f32_dpp v163, v43, v43 row_ror:6 row_mask:0xf bank_mask:0xf
    v_mfma_f32_16x16x32_bf16 v[168:171], a[68:71], v[132:135], v[168:171]
    v_cvt_pk_bf16_f32 v188, v176, v177 clamp
    v_cvt_pk_bf16_f32 v149, v162, v163
    v_mfma_f32_16x16x32_bf16 v[168:171], a[72:75], v[136:139], v[168:171]
    v_mul_f32_dpp v164, v44, v44 row_ror:6 row_mask:0xf bank_mask:0xf
    v_cvt_pk_bf16_f32 v189, v178, v179 clamp
    v_mfma_f32_16x16x32_bf16 v[168:171], a[76:79], v[140:143], v[168:171]
    v_mul_f32_dpp v165, v45, v45 row_ror:6 row_mask:0xf bank_mask:0xf
    v_cvt_pk_bf16_f32 v150, v164, v165
    v_mfma_f32_16x16x32_bf16 v[172:175], a[92:95], v[140:143], v[20:23]
    v_mul_f32_dpp v166, v46, v46 row_ror:6 row_mask:0xf bank_mask:0xf
    v_add_f32 v237, v226, v231
    v_mfma_f32_16x16x32_bf16 v[172:175], a[88:91], v[136:139], v[172:175]
    v_cvt_pk_bf16_f32 v190, v180, v181 clamp
    v_mul_f32_dpp v167, v47, v47 row_ror:6 row_mask:0xf bank_mask:0xf
    v_mfma_f32_16x16x32_bf16 v[172:175], a[84:87], v[132:135], v[172:175]
    v_cvt_pk_bf16_f32 v191, v182, v183 clamp
    v_cvt_pk_bf16_f32 v151, v166, v167
    v_mfma_f32_16x16x32_bf16 v[172:175], a[80:83], v[128:131], v[172:175]
    v_mul_f32_dpp v160, v48, v48 row_ror:6 row_mask:0xf bank_mask:0xf
    v_mul_f32_dpp v161, v49, v49 row_ror:6 row_mask:0xf bank_mask:0xf
    v_smfmac_f32_16x16x64_bf16 v[208:211], a[156:159], v[192:199], v233
    v_cvt_pk_bf16_f32 v152, v160, v161
    v_smfmac_f32_16x16x64_bf16 v[200:203], a[128:131], v[184:191], v233
    v_cvt_pk_bf16_f32 v192, v168, v169 clamp
    v_mfma_f32_16x16x32_bf16 v[176:179], a[96:99], v[128:131], v[24:27]
    v_mul_f32_dpp v162, v50, v50 row_ror:6 row_mask:0xf bank_mask:0xf
    v_cvt_pk_bf16_f32 v193, v170, v171 clamp
    v_mfma_f32_16x16x32_bf16 v[176:179], a[100:103], v[132:135], v[176:179]
    v_mul_f32_dpp v163, v51, v51 row_ror:6 row_mask:0xf bank_mask:0xf
    v_cvt_pk_bf16_f32 v153, v162, v163
    v_mfma_f32_16x16x32_bf16 v[176:179], a[104:107], v[136:139], v[176:179]
    v_fma_f32 v227, v227, v253, -s24
    v_mul_f32_dpp v164, v52, v52 row_ror:6 row_mask:0xf bank_mask:0xf
    v_mfma_f32_16x16x32_bf16 v[176:179], a[108:111], v[140:143], v[176:179]
    v_mul_f32_dpp v165, v53, v53 row_ror:6 row_mask:0xf bank_mask:0xf
    v_cvt_pk_bf16_f32 v194, v172, v173 clamp
    v_mfma_f32_4x4x4_16b_bf16 v[64:67], a[200:201], v[80:81], 0
    v_cvt_pk_bf16_f32 v154, v164, v165
    v_mfma_f32_4x4x4_16b_bf16 v[68:71], a[200:201], v[82:83], 0
    v_cvt_pk_bf16_f32 v195, v174, v175 clamp
    v_mfma_f32_4x4x4_16b_bf16 v[72:75], a[200:201], v[84:85], 0
    v_mul_f32_dpp v166, v54, v54 row_ror:6 row_mask:0xf bank_mask:0xf
    v_mfma_f32_4x4x4_16b_bf16 v[76:79], a[200:201], v[86:87], 0
    v_mul_f32_dpp v167, v55, v55 row_ror:6 row_mask:0xf bank_mask:0xf
    v_mfma_f32_4x4x4_16b_bf16 v[80:83], a[200:201], v[88:89], 0
    v_add_f32 v226, v208, v209
    v_mfma_f32_4x4x4_16b_bf16 v[84:87], a[200:201], v[90:91], 0
    v_cvt_pk_bf16_f32 v155, v166, v167
    v_mfma_f32_4x4x4_16b_bf16 v[88:91], a[200:201], v[92:93], 0
    v_mul_f32_dpp v160, v56, v56 row_ror:6 row_mask:0xf bank_mask:0xf
    v_mfma_f32_4x4x4_16b_bf16 v[92:95], a[200:201], v[94:95], 0
    v_mul_f32_dpp v161, v57, v57 row_ror:6 row_mask:0xf bank_mask:0xf
    v_exp_f32_e64 v227, v227 clamp
    v_mfma_f32_16x16x32_bf16 v[180:183], a[124:127], v[140:143], v[28:31]
    v_cvt_pk_bf16_f32 v156, v160, v161
    v_cvt_pk_bf16_f32 v196, v176, v177 clamp
    v_mfma_f32_16x16x32_bf16 v[180:183], a[120:123], v[136:139], v[180:183]
    v_mul_f32_dpp v162, v58, v58 row_ror:6 row_mask:0xf bank_mask:0xf
    v_cvt_pk_bf16_f32 v197, v178, v179 clamp
    v_mfma_f32_16x16x32_bf16 v[180:183], a[116:119], v[132:135], v[180:183]
    v_mul_f32_dpp v163, v59, v59 row_ror:6 row_mask:0xf bank_mask:0xf
    v_cvt_pk_bf16_f32 v157, v162, v163
    v_mfma_f32_16x16x32_bf16 v[180:183], a[112:115], v[128:131], v[180:183]
    v_mul_f32_dpp v164, v60, v60 row_ror:6 row_mask:0xf bank_mask:0xf
    v_mul_f32_dpp v165, v61, v61 row_ror:6 row_mask:0xf bank_mask:0xf
    v_mfma_f32_16x16x32_bf16 v[168:171], a[0:3], v[144:147], v[0:3]
    v_cvt_pk_bf16_f32 v158, v164, v165
    v_mul_f32_dpp v166, v62, v62 row_ror:6 row_mask:0xf bank_mask:0xf
    v_mfma_f32_16x16x32_bf16 v[168:171], a[4:7], v[148:151], v[168:171]
    v_mul_f32_dpp v167, v63, v63 row_ror:6 row_mask:0xf bank_mask:0xf
    v_fmac_f32 v236, v227, v218
    v_mfma_f32_16x16x32_bf16 v[168:171], a[8:11], v[152:155], v[168:171]
    v_cvt_pk_bf16_f32 v159, v166, v167
    v_mul_f32_dpp v160, v32, v32 row_ror:7 row_mask:0xf bank_mask:0xf
    v_mul_f32_dpp v161, v33, v33 row_ror:7 row_mask:0xf bank_mask:0xf
    v_mfma_f32_16x16x32_bf16 v[168:171], a[12:15], v[156:159], v[168:171]
    v_cvt_pk_bf16_f32 v128, v160, v161
    v_cvt_pk_bf16_f32 v198, v180, v181 clamp
    v_mfma_f32_16x16x32_bf16 v[172:175], a[28:31], v[156:159], v[4:7]
    v_mul_f32_dpp v162, v34, v34 row_ror:7 row_mask:0xf bank_mask:0xf
    v_mul_f32_dpp v163, v35, v35 row_ror:7 row_mask:0xf bank_mask:0xf
    v_mfma_f32_16x16x32_bf16 v[172:175], a[24:27], v[152:155], v[172:175]
    v_add_f32 v237, v237, v227
    v_cvt_pk_bf16_f32 v199, v182, v183 clamp
    v_mfma_f32_16x16x32_bf16 v[172:175], a[20:23], v[148:151], v[172:175]
    v_cvt_pk_bf16_f32 v129, v162, v163
    v_mul_f32_dpp v164, v36, v36 row_ror:7 row_mask:0xf bank_mask:0xf
    v_mfma_f32_16x16x32_bf16 v[172:175], a[16:19], v[144:147], v[172:175]
    v_mul_f32_dpp v165, v37, v37 row_ror:7 row_mask:0xf bank_mask:0xf
    v_cvt_pk_bf16_f32 v130, v164, v165
    v_mfma_f32_16x16x32_bf16 v[176:179], a[32:35], v[144:147], v[8:11]
    v_cvt_pk_bf16_f32 v184, v168, v169 clamp
    v_mul_f32_dpp v166, v38, v38 row_ror:7 row_mask:0xf bank_mask:0xf
    v_mfma_f32_16x16x32_bf16 v[176:179], a[36:39], v[148:151], v[176:179]
    v_mul_f32_dpp v167, v39, v39 row_ror:7 row_mask:0xf bank_mask:0xf
    v_cvt_pk_bf16_f32 v185, v170, v171 clamp
    v_mfma_f32_16x16x32_bf16 v[176:179], a[40:43], v[152:155], v[176:179]
    v_cvt_pk_bf16_f32 v131, v166, v167
    v_mul_f32_dpp v160, v40, v40 row_ror:7 row_mask:0xf bank_mask:0xf
    v_mfma_f32_16x16x32_bf16 v[176:179], a[44:47], v[156:159], v[176:179]
    v_mul_f32_dpp v161, v41, v41 row_ror:7 row_mask:0xf bank_mask:0xf
    v_cvt_pk_bf16_f32 v132, v160, v161
    v_mfma_f32_16x16x32_bf16 v[180:183], a[60:63], v[156:159], v[12:15]
    v_fma_f32 v228, v228, v253, -s24
    v_mul_f32_dpp v162, v42, v42 row_ror:7 row_mask:0xf bank_mask:0xf
    v_mfma_f32_16x16x32_bf16 v[180:183], a[56:59], v[152:155], v[180:183]
    v_cvt_pk_bf16_f32 v186, v172, v173 clamp
    v_mul_f32_dpp v163, v43, v43 row_ror:7 row_mask:0xf bank_mask:0xf
    v_mfma_f32_16x16x32_bf16 v[180:183], a[52:55], v[148:151], v[180:183]
    v_cvt_pk_bf16_f32 v187, v174, v175 clamp
    v_cvt_pk_bf16_f32 v133, v162, v163
    v_mfma_f32_16x16x32_bf16 v[180:183], a[48:51], v[144:147], v[180:183]
    v_mul_f32_dpp v164, v44, v44 row_ror:7 row_mask:0xf bank_mask:0xf
    v_mul_f32_dpp v165, v45, v45 row_ror:7 row_mask:0xf bank_mask:0xf
    v_mfma_f32_16x16x32_bf16 v[168:171], a[64:67], v[144:147], v[16:19]
    v_cvt_pk_bf16_f32 v134, v164, v165
    v_mul_f32_dpp v166, v46, v46 row_ror:7 row_mask:0xf bank_mask:0xf
    v_mfma_f32_16x16x32_bf16 v[168:171], a[68:71], v[148:151], v[168:171]
    v_cvt_pk_bf16_f32 v188, v176, v177 clamp
    v_mul_f32_dpp v167, v47, v47 row_ror:7 row_mask:0xf bank_mask:0xf
    v_mfma_f32_16x16x32_bf16 v[168:171], a[72:75], v[152:155], v[168:171]
    v_cvt_pk_bf16_f32 v189, v178, v179 clamp
    v_cvt_pk_bf16_f32 v135, v166, v167
    v_mfma_f32_16x16x32_bf16 v[168:171], a[76:79], v[156:159], v[168:171]
    v_mul_f32_dpp v160, v48, v48 row_ror:7 row_mask:0xf bank_mask:0xf
    v_mul_f32_dpp v161, v49, v49 row_ror:7 row_mask:0xf bank_mask:0xf
    v_mfma_f32_16x16x32_bf16 v[172:175], a[92:95], v[156:159], v[20:23]
    v_exp_f32_e64 v228, v228 clamp
    v_mfma_f32_16x16x32_bf16 v[172:175], a[88:91], v[152:155], v[172:175]
    v_cvt_pk_bf16_f32 v136, v160, v161
    v_mul_f32_dpp v162, v50, v50 row_ror:7 row_mask:0xf bank_mask:0xf
    v_mfma_f32_16x16x32_bf16 v[172:175], a[84:87], v[148:151], v[172:175]
    v_cvt_pk_bf16_f32 v190, v180, v181 clamp
    v_mul_f32_dpp v163, v51, v51 row_ror:7 row_mask:0xf bank_mask:0xf
    v_mfma_f32_16x16x32_bf16 v[172:175], a[80:83], v[144:147], v[172:175]
    v_cvt_pk_bf16_f32 v191, v182, v183 clamp
    v_cvt_pk_bf16_f32 v137, v162, v163
    v_smfmac_f32_16x16x64_bf16 v[200:203], a[132:135], v[192:199], v233
    v_mul_f32_dpp v164, v52, v52 row_ror:7 row_mask:0xf bank_mask:0xf
    v_smfmac_f32_16x16x64_bf16 v[200:203], a[136:139], v[184:191], v233
    v_mul_f32_dpp v165, v53, v53 row_ror:7 row_mask:0xf bank_mask:0xf
    v_mfma_f32_16x16x32_bf16 v[176:179], a[96:99], v[144:147], v[24:27]
    v_cvt_pk_bf16_f32 v138, v164, v165
    v_mul_f32_dpp v166, v54, v54 row_ror:7 row_mask:0xf bank_mask:0xf
    v_mfma_f32_16x16x32_bf16 v[176:179], a[100:103], v[148:151], v[176:179]
    v_cvt_pk_bf16_f32 v192, v168, v169 clamp
    v_mul_f32_dpp v167, v55, v55 row_ror:7 row_mask:0xf bank_mask:0xf
    v_mfma_f32_16x16x32_bf16 v[176:179], a[104:107], v[152:155], v[176:179]
    v_cvt_pk_bf16_f32 v193, v170, v171 clamp
    v_cvt_pk_bf16_f32 v139, v166, v167
    v_mfma_f32_16x16x32_bf16 v[176:179], a[108:111], v[156:159], v[176:179]
    v_fmac_f32 v236, v228, v219
    v_mul_f32_dpp v160, v56, v56 row_ror:7 row_mask:0xf bank_mask:0xf
    v_mfma_f32_16x16x32_bf16 v[180:183], a[124:127], v[156:159], v[28:31]
    v_mul_f32_dpp v161, v57, v57 row_ror:7 row_mask:0xf bank_mask:0xf
    v_cvt_pk_bf16_f32 v140, v160, v161
    v_mfma_f32_16x16x32_bf16 v[180:183], a[120:123], v[152:155], v[180:183]
    v_mul_f32_dpp v162, v58, v58 row_ror:7 row_mask:0xf bank_mask:0xf
    v_cvt_pk_bf16_f32 v194, v172, v173 clamp
    v_mfma_f32_16x16x32_bf16 v[180:183], a[116:119], v[148:151], v[180:183]
    v_mul_f32_dpp v163, v59, v59 row_ror:7 row_mask:0xf bank_mask:0xf
    v_cvt_pk_bf16_f32 v195, v174, v175 clamp
    v_mfma_f32_16x16x32_bf16 v[180:183], a[112:115], v[144:147], v[180:183]
    v_cvt_pk_bf16_f32 v141, v162, v163
    v_mul_f32_dpp v164, v60, v60 row_ror:7 row_mask:0xf bank_mask:0xf
    v_mfma_f32_16x16x32_bf16 v[168:171], a[0:3], v[128:131], v[0:3]
    v_mul_f32_dpp v165, v61, v61 row_ror:7 row_mask:0xf bank_mask:0xf
    v_cvt_pk_bf16_f32 v142, v164, v165
    v_mfma_f32_16x16x32_bf16 v[168:171], a[4:7], v[132:135], v[168:171]
    v_mul_f32_dpp v166, v62, v62 row_ror:7 row_mask:0xf bank_mask:0xf
    v_add_f32 v237, v237, v228
    v_mfma_f32_16x16x32_bf16 v[168:171], a[8:11], v[136:139], v[168:171]
    v_mul_f32_dpp v167, v63, v63 row_ror:7 row_mask:0xf bank_mask:0xf
    v_cvt_pk_bf16_f32 v143, v166, v167
    v_cvt_pk_bf16_f32 v196, v176, v177 clamp
    v_cvt_pk_bf16_f32 v197, v178, v179 clamp
    v_mfma_f32_16x16x32_bf16 v[168:171], a[12:15], v[140:143], v[168:171]
    v_mul_f32_dpp v160, v64, v32 row_newbcast:14 row_mask:0xf bank_mask:0xf
    v_mul_f32_dpp v161, v65, v33 row_newbcast:14 row_mask:0xf bank_mask:0xf
    v_mfma_f32_16x16x32_bf16 v[172:175], a[28:31], v[140:143], v[4:7]
    v_cvt_pk_bf16_f32 v144, v160, v161
    v_cvt_pk_bf16_f32 v198, v180, v181 clamp
    v_mfma_f32_16x16x32_bf16 v[172:175], a[24:27], v[136:139], v[172:175]
    v_mul_f32_dpp v162, v66, v34 row_newbcast:14 row_mask:0xf bank_mask:0xf
    v_fma_f32 v229, v229, v253, -s24
    v_mfma_f32_16x16x32_bf16 v[172:175], a[20:23], v[132:135], v[172:175]
    v_cvt_pk_bf16_f32 v199, v182, v183 clamp
    v_mul_f32_dpp v163, v67, v35 row_newbcast:14 row_mask:0xf bank_mask:0xf
    v_mfma_f32_16x16x32_bf16 v[172:175], a[16:19], v[128:131], v[172:175]
    v_cvt_pk_bf16_f32 v145, v162, v163
    s_waitcnt vmcnt(3)
    v_mfma_f32_4x4x4_16b_bf16 v[96:99], a[200:201], v[112:113], 0
    v_mul_f32_dpp v164, v68, v36 row_newbcast:14 row_mask:0xf bank_mask:0xf
    v_mfma_f32_4x4x4_16b_bf16 v[100:103], a[200:201], v[114:115], 0
    v_mul_f32_dpp v165, v69, v37 row_newbcast:14 row_mask:0xf bank_mask:0xf
    v_mfma_f32_4x4x4_16b_bf16 v[104:107], a[200:201], v[116:117], 0
    v_cvt_pk_bf16_f32 v184, v168, v169 clamp
    v_mfma_f32_4x4x4_16b_bf16 v[108:111], a[200:201], v[118:119], 0
    v_cvt_pk_bf16_f32 v146, v164, v165
    v_mfma_f32_4x4x4_16b_bf16 v[112:115], a[200:201], v[120:121], 0
    v_cvt_pk_bf16_f32 v185, v170, v171 clamp
    v_mfma_f32_4x4x4_16b_bf16 v[116:119], a[200:201], v[122:123], 0
    v_mul_f32_dpp v166, v70, v38 row_newbcast:14 row_mask:0xf bank_mask:0xf
    v_mfma_f32_4x4x4_16b_bf16 v[120:123], a[200:201], v[124:125], 0
    v_mul_f32_dpp v167, v71, v39 row_newbcast:14 row_mask:0xf bank_mask:0xf
    v_mfma_f32_4x4x4_16b_bf16 v[124:127], a[200:201], v[126:127], 0
    v_cvt_pk_bf16_f32 v147, v166, v167
    v_exp_f32_e64 v229, v229 clamp
    v_mfma_f32_16x16x32_bf16 v[176:179], a[32:35], v[128:131], v[8:11]
    v_mul_f32_dpp v160, v72, v40 row_newbcast:14 row_mask:0xf bank_mask:0xf
    v_cvt_pk_bf16_f32 v186, v172, v173 clamp
    v_mfma_f32_16x16x32_bf16 v[176:179], a[36:39], v[132:135], v[176:179]
    v_mul_f32_dpp v161, v73, v41 row_newbcast:14 row_mask:0xf bank_mask:0xf
    v_cvt_pk_bf16_f32 v187, v174, v175 clamp
    v_mfma_f32_16x16x32_bf16 v[176:179], a[40:43], v[136:139], v[176:179]
    v_cvt_pk_bf16_f32 v148, v160, v161
    v_mul_f32_dpp v162, v74, v42 row_newbcast:14 row_mask:0xf bank_mask:0xf
    v_mfma_f32_16x16x32_bf16 v[176:179], a[44:47], v[140:143], v[176:179]
    v_mul_f32_dpp v163, v75, v43 row_newbcast:14 row_mask:0xf bank_mask:0xf
    v_cvt_pk_bf16_f32 v149, v162, v163
    v_mfma_f32_16x16x32_bf16 v[180:183], a[60:63], v[140:143], v[12:15]
    v_mul_f32_dpp v164, v76, v44 row_newbcast:14 row_mask:0xf bank_mask:0xf
    v_mul_f32_dpp v165, v77, v45 row_newbcast:14 row_mask:0xf bank_mask:0xf
    v_mfma_f32_16x16x32_bf16 v[180:183], a[56:59], v[136:139], v[180:183]
    v_fmac_f32 v236, v229, v216
    v_cvt_pk_bf16_f32 v150, v164, v165
    v_mfma_f32_16x16x32_bf16 v[180:183], a[52:55], v[132:135], v[180:183]
    v_mul_f32_dpp v166, v78, v46 row_newbcast:14 row_mask:0xf bank_mask:0xf
    v_mul_f32_dpp v167, v79, v47 row_newbcast:14 row_mask:0xf bank_mask:0xf
    v_mfma_f32_16x16x32_bf16 v[180:183], a[48:51], v[128:131], v[180:183]
    v_cvt_pk_bf16_f32 v151, v166, v167
    v_mul_f32_dpp v160, v80, v48 row_newbcast:14 row_mask:0xf bank_mask:0xf
    v_mfma_f32_16x16x32_bf16 v[168:171], a[64:67], v[128:131], v[16:19]
    v_mul_f32_dpp v161, v81, v49 row_newbcast:14 row_mask:0xf bank_mask:0xf
    v_cvt_pk_bf16_f32 v152, v160, v161
    v_mfma_f32_16x16x32_bf16 v[168:171], a[68:71], v[132:135], v[168:171]
    v_cvt_pk_bf16_f32 v188, v176, v177 clamp
    v_mul_f32_dpp v162, v82, v50 row_newbcast:14 row_mask:0xf bank_mask:0xf
    v_mfma_f32_16x16x32_bf16 v[168:171], a[72:75], v[136:139], v[168:171]
    v_add_f32 v237, v237, v229
    v_cvt_pk_bf16_f32 v189, v178, v179 clamp
    v_mfma_f32_16x16x32_bf16 v[168:171], a[76:79], v[140:143], v[168:171]
    v_mul_f32_dpp v163, v83, v51 row_newbcast:14 row_mask:0xf bank_mask:0xf
    v_cvt_pk_bf16_f32 v153, v162, v163
    v_mfma_f32_16x16x32_bf16 v[172:175], a[92:95], v[140:143], v[20:23]
    v_mul_f32_dpp v164, v84, v52 row_newbcast:14 row_mask:0xf bank_mask:0xf
    v_mul_f32_dpp v165, v85, v53 row_newbcast:14 row_mask:0xf bank_mask:0xf
    v_mfma_f32_16x16x32_bf16 v[172:175], a[88:91], v[136:139], v[172:175]
    v_cvt_pk_bf16_f32 v190, v180, v181 clamp
    v_cvt_pk_bf16_f32 v154, v164, v165
    v_mfma_f32_16x16x32_bf16 v[172:175], a[84:87], v[132:135], v[172:175]
    v_cvt_pk_bf16_f32 v191, v182, v183 clamp
    v_mul_f32_dpp v166, v86, v54 row_newbcast:14 row_mask:0xf bank_mask:0xf
    v_mfma_f32_16x16x32_bf16 v[172:175], a[80:83], v[128:131], v[172:175]
    v_mul_f32_dpp v167, v87, v55 row_newbcast:14 row_mask:0xf bank_mask:0xf
    v_cvt_pk_bf16_f32 v155, v166, v167
    v_smfmac_f32_16x16x64_bf16 v[200:203], a[140:143], v[192:199], v233
    v_mul_f32_dpp v160, v88, v56 row_newbcast:14 row_mask:0xf bank_mask:0xf
    v_smfmac_f32_16x16x64_bf16 v[200:203], a[144:147], v[184:191], v233
    v_fma_f32 v230, v230, v253, -s24
    v_mfma_f32_16x16x32_bf16 v[176:179], a[96:99], v[128:131], v[24:27]
    v_cvt_pk_bf16_f32 v192, v168, v169 clamp
    v_mul_f32_dpp v161, v89, v57 row_newbcast:14 row_mask:0xf bank_mask:0xf
    v_mfma_f32_16x16x32_bf16 v[176:179], a[100:103], v[132:135], v[176:179]
    v_cvt_pk_bf16_f32 v193, v170, v171 clamp
    v_cvt_pk_bf16_f32 v156, v160, v161
    v_mfma_f32_16x16x32_bf16 v[176:179], a[104:107], v[136:139], v[176:179]
    v_mul_f32_dpp v162, v90, v58 row_newbcast:14 row_mask:0xf bank_mask:0xf
    v_mul_f32_dpp v163, v91, v59 row_newbcast:14 row_mask:0xf bank_mask:0xf
    v_mfma_f32_16x16x32_bf16 v[176:179], a[108:111], v[140:143], v[176:179]
    v_cvt_pk_bf16_f32 v157, v162, v163
    v_cvt_pk_bf16_f32 v194, v172, v173 clamp
    v_mfma_f32_16x16x32_bf16 v[180:183], a[124:127], v[140:143], v[28:31]
    v_mul_f32_dpp v164, v92, v60 row_newbcast:14 row_mask:0xf bank_mask:0xf
    v_cvt_pk_bf16_f32 v195, v174, v175 clamp
    v_mfma_f32_16x16x32_bf16 v[180:183], a[120:123], v[136:139], v[180:183]
    v_mul_f32_dpp v165, v93, v61 row_newbcast:14 row_mask:0xf bank_mask:0xf
    v_cvt_pk_bf16_f32 v158, v164, v165
    v_mfma_f32_16x16x32_bf16 v[180:183], a[116:119], v[132:135], v[180:183]
    v_exp_f32_e64 v230, v230 clamp
    v_mfma_f32_16x16x32_bf16 v[180:183], a[112:115], v[128:131], v[180:183]
    v_mul_f32_dpp v166, v94, v62 row_newbcast:14 row_mask:0xf bank_mask:0xf
    v_mul_f32_dpp v167, v95, v63 row_newbcast:14 row_mask:0xf bank_mask:0xf
    v_mfma_f32_16x16x32_bf16 v[168:171], a[0:3], v[144:147], v[0:3]
    v_cvt_pk_bf16_f32 v159, v166, v167
    v_cvt_pk_bf16_f32 v196, v176, v177 clamp
    v_mfma_f32_16x16x32_bf16 v[168:171], a[4:7], v[148:151], v[168:171]
    v_cvt_pk_bf16_f32 v197, v178, v179 clamp
    v_mul_f32 v160, v64, v96
    v_mfma_f32_16x16x32_bf16 v[168:171], a[8:11], v[152:155], v[168:171]
    v_mul_f32 v161, v65, v97
    v_fmac_f32 v236, v230, v217
    v_mfma_f32_16x16x32_bf16 v[168:171], a[12:15], v[156:159], v[168:171]
    v_cvt_pk_bf16_f32 v128, v160, v161
    v_cvt_pk_bf16_f32 v198, v180, v181 clamp
    v_mfma_f32_16x16x32_bf16 v[172:175], a[28:31], v[156:159], v[4:7]
    v_mul_f32 v162, v66, v98
    v_mul_f32 v163, v67, v99
    v_mfma_f32_16x16x32_bf16 v[172:175], a[24:27], v[152:155], v[172:175]
    v_cvt_pk_bf16_f32 v199, v182, v183 clamp
    v_cvt_pk_bf16_f32 v129, v162, v163
    v_mfma_f32_16x16x32_bf16 v[172:175], a[20:23], v[148:151], v[172:175]
    v_mul_f32 v164, v68, v100
    v_mul_f32 v165, v69, v101
    v_mfma_f32_16x16x32_bf16 v[172:175], a[16:19], v[144:147], v[172:175]
    v_cvt_pk_bf16_f32 v130, v164, v165
    v_cvt_pk_bf16_f32 v184, v168, v169 clamp
    v_mfma_f32_16x16x32_bf16 v[176:179], a[32:35], v[144:147], v[8:11]
    v_mul_f32 v166, v70, v102
    v_mul_f32 v167, v71, v103
    v_mfma_f32_16x16x32_bf16 v[176:179], a[36:39], v[148:151], v[176:179]
    v_cvt_pk_bf16_f32 v185, v170, v171 clamp
    v_cvt_pk_bf16_f32 v131, v166, v167
    v_mfma_f32_16x16x32_bf16 v[176:179], a[40:43], v[152:155], v[176:179]
L_pad6:
    s_cbranch_vccnz L_resume
    v_mul_f32 v160, v72, v104
    v_add_f32 v237, v237, v230
    v_mfma_f32_16x16x32_bf16 v[176:179], a[44:47], v[156:159], v[176:179]
    v_mul_f32 v161, v73, v105
    v_cvt_pk_bf16_f32 v132, v160, v161
    v_mfma_f32_16x16x32_bf16 v[180:183], a[60:63], v[156:159], v[12:15]
    v_mul_f32 v162, v74, v106
    v_cvt_pk_bf16_f32 v186, v172, v173 clamp
    v_mfma_f32_16x16x32_bf16 v[180:183], a[56:59], v[152:155], v[180:183]
    v_mul_f32 v163, v75, v107
    v_cvt_pk_bf16_f32 v187, v174, v175 clamp
    v_mfma_f32_16x16x32_bf16 v[180:183], a[52:55], v[148:151], v[180:183]
    v_cvt_pk_bf16_f32 v133, v162, v163
    v_mul_f32 v164, v76, v108
    v_mfma_f32_16x16x32_bf16 v[180:183], a[48:51], v[144:147], v[180:183]
    v_mul_f32 v165, v77, v109
    v_cvt_pk_bf16_f32 v134, v164, v165
    v_mfma_f32_16x16x32_bf16 v[168:171], a[64:67], v[144:147], v[16:19]
    v_mul_f32 v166, v78, v110
    v_cvt_pk_bf16_f32 v188, v176, v177 clamp
    v_mfma_f32_16x16x32_bf16 v[168:171], a[68:71], v[148:151], v[168:171]
    v_mul_f32 v167, v79, v111
    v_cvt_pk_bf16_f32 v189, v178, v179 clamp
    v_mfma_f32_16x16x32_bf16 v[168:171], a[72:75], v[152:155], v[168:171]
    v_permlane32_swap_b32 v236, v237
    v_mfma_f32_16x16x32_bf16 v[168:171], a[76:79], v[156:159], v[168:171]
    v_cvt_pk_bf16_f32 v135, v166, v167
    v_mul_f32 v160, v80, v112
    v_mfma_f32_16x16x32_bf16 v[172:175], a[92:95], v[156:159], v[20:23]
    v_mul_f32 v161, v81, v113
    v_cvt_pk_bf16_f32 v136, v160, v161
    v_mfma_f32_16x16x32_bf16 v[172:175], a[88:91], v[152:155], v[172:175]
    v_mul_f32 v162, v82, v114
    v_cvt_pk_bf16_f32 v190, v180, v181 clamp
    v_mfma_f32_16x16x32_bf16 v[172:175], a[84:87], v[148:151], v[172:175]
    v_mul_f32 v163, v83, v115
    v_cvt_pk_bf16_f32 v191, v182, v183 clamp
    v_mfma_f32_16x16x32_bf16 v[172:175], a[80:83], v[144:147], v[172:175]
    v_cvt_pk_bf16_f32 v137, v162, v163
    v_mul_f32 v164, v84, v116
    v_smfmac_f32_16x16x64_bf16 v[200:203], a[148:151], v[192:199], v233
    v_mul_f32 v165, v85, v117
    v_smfmac_f32_16x16x64_bf16 v[200:203], a[152:155], v[184:191], v233
    v_cvt_pk_bf16_f32 v138, v164, v165
    v_mfma_f32_16x16x32_bf16 v[176:179], a[96:99], v[144:147], v[24:27]
    v_mov_b32 v240, v238
    v_mul_f32 v166, v86, v118
    v_mfma_f32_16x16x32_bf16 v[176:179], a[100:103], v[148:151], v[176:179]
    v_cvt_pk_bf16_f32 v192, v168, v169 clamp
    v_mul_f32 v167, v87, v119
    v_mfma_f32_16x16x32_bf16 v[176:179], a[104:107], v[152:155], v[176:179]
    v_cvt_pk_bf16_f32 v193, v170, v171 clamp
    v_cvt_pk_bf16_f32 v139, v166, v167
    v_mfma_f32_16x16x32_bf16 v[176:179], a[108:111], v[156:159], v[176:179]
    v_mul_f32 v160, v88, v120
    v_mul_f32 v161, v89, v121
    v_mfma_f32_16x16x32_bf16 v[180:183], a[124:127], v[156:159], v[28:31]
    v_cvt_pk_bf16_f32 v140, v160, v161
    v_mul_f32 v162, v90, v122
    v_mfma_f32_16x16x32_bf16 v[180:183], a[120:123], v[152:155], v[180:183]
    v_cvt_pk_bf16_f32 v194, v172, v173 clamp
    v_mul_f32 v163, v91, v123
    v_mfma_f32_16x16x32_bf16 v[180:183], a[116:119], v[148:151], v[180:183]
    v_cvt_pk_bf16_f32 v195, v174, v175 clamp
    v_cvt_pk_bf16_f32 v141, v162, v163
    v_mfma_f32_16x16x32_bf16 v[180:183], a[112:115], v[144:147], v[180:183]
    v_mul_f32 v164, v92, v124
    v_mul_f32 v165, v93, v125
    v_mfma_f32_16x16x32_bf16 v[168:171], a[0:3], v[128:131], v[0:3]
    v_add_f32 v238, v236, v237
    v_cvt_pk_bf16_f32 v142, v164, v165
    v_mfma_f32_16x16x32_bf16 v[168:171], a[4:7], v[132:135], v[168:171]
    v_mul_f32 v166, v94, v126
    v_mul_f32 v167, v95, v127
    v_mfma_f32_16x16x32_bf16 v[168:171], a[8:11], v[136:139], v[168:171]
    v_cvt_pk_bf16_f32 v143, v166, v167
    v_cvt_pk_bf16_f32 v196, v176, v177 clamp
    v_cvt_pk_bf16_f32 v197, v178, v179 clamp
    v_mfma_f32_16x16x32_bf16 v[168:171], a[12:15], v[140:143], v[168:171]
    v_mul_f32_dpp v160, v64, v96 quad_perm:[1,0,3,2] row_mask:0xf bank_mask:0xf
    v_mul_f32_dpp v161, v65, v97 quad_perm:[1,0,3,2] row_mask:0xf bank_mask:0xf
    v_mfma_f32_16x16x32_bf16 v[172:175], a[28:31], v[140:143], v[4:7]
    v_cvt_pk_bf16_f32 v144, v160, v161
    v_cvt_pk_bf16_f32 v198, v180, v181 clamp
    v_mfma_f32_16x16x32_bf16 v[172:175], a[24:27], v[136:139], v[172:175]
    v_mul_f32_dpp v162, v66, v98 quad_perm:[1,0,3,2] row_mask:0xf bank_mask:0xf
    v_mul_f32_dpp v163, v67, v99 quad_perm:[1,0,3,2] row_mask:0xf bank_mask:0xf
    v_mfma_f32_16x16x32_bf16 v[172:175], a[20:23], v[132:135], v[172:175]
    v_cvt_pk_bf16_f32 v199, v182, v183 clamp
    v_cvt_pk_bf16_f32 v145, v162, v163
    v_mfma_f32_16x16x32_bf16 v[172:175], a[16:19], v[128:131], v[172:175]
    v_mul_f32_dpp v164, v68, v100 quad_perm:[1,0,3,2] row_mask:0xf bank_mask:0xf
    v_mul_f32_dpp v165, v69, v101 quad_perm:[1,0,3,2] row_mask:0xf bank_mask:0xf
    v_mfma_f32_16x16x32_bf16 v[176:179], a[32:35], v[128:131], v[8:11]
    v_cvt_pk_bf16_f32 v146, v164, v165
    v_cvt_pk_bf16_f32 v184, v168, v169 clamp
    v_mfma_f32_16x16x32_bf16 v[176:179], a[36:39], v[132:135], v[176:179]
    v_mul_f32_dpp v166, v70, v102 quad_perm:[1,0,3,2] row_mask:0xf bank_mask:0xf
    v_cvt_pk_bf16_f32 v185, v170, v171 clamp
    v_mfma_f32_16x16x32_bf16 v[176:179], a[40:43], v[136:139], v[176:179]
    v_mul_f32_dpp v167, v71, v103 quad_perm:[1,0,3,2] row_mask:0xf bank_mask:0xf
    v_cvt_pk_bf16_f32 v147, v166, v167
    v_mfma_f32_16x16x32_bf16 v[176:179], a[44:47], v[140:143], v[176:179]
    v_mul_f32_dpp v160, v72, v104 quad_perm:[1,0,3,2] row_mask:0xf bank_mask:0xf
    v_mul_f32_dpp v161, v73, v105 quad_perm:[1,0,3,2] row_mask:0xf bank_mask:0xf
    v_mfma_f32_16x16x32_bf16 v[180:183], a[60:63], v[140:143], v[12:15]
    v_cvt_pk_bf16_f32 v186, v172, v173 clamp
    v_cvt_pk_bf16_f32 v148, v160, v161
    v_mfma_f32_16x16x32_bf16 v[180:183], a[56:59], v[136:139], v[180:183]
    v_mul_f32_dpp v162, v74, v106 quad_perm:[1,0,3,2] row_mask:0xf bank_mask:0xf
    v_cvt_pk_bf16_f32 v187, v174, v175 clamp
    v_mfma_f32_16x16x32_bf16 v[180:183], a[52:55], v[132:135], v[180:183]
    v_mul_f32_dpp v163, v75, v107 quad_perm:[1,0,3,2] row_mask:0xf bank_mask:0xf
    v_cvt_pk_bf16_f32 v149, v162, v163
    v_mfma_f32_16x16x32_bf16 v[180:183], a[48:51], v[128:131], v[180:183]
    v_mul_f32_dpp v164, v76, v108 quad_perm:[1,0,3,2] row_mask:0xf bank_mask:0xf
    v_mul_f32_dpp v165, v77, v109 quad_perm:[1,0,3,2] row_mask:0xf bank_mask:0xf
    v_mfma_f32_16x16x32_bf16 v[168:171], a[64:67], v[128:131], v[16:19]
    v_cvt_pk_bf16_f32 v188, v176, v177 clamp
    v_cvt_pk_bf16_f32 v150, v164, v165
    v_mfma_f32_16x16x32_bf16 v[168:171], a[68:71], v[132:135], v[168:171]
    v_cvt_pk_bf16_f32 v189, v178, v179 clamp
    v_mul_f32_dpp v166, v78, v110 quad_perm:[1,0,3,2] row_mask:0xf bank_mask:0xf
    v_mfma_f32_16x16x32_bf16 v[168:171], a[72:75], v[136:139], v[168:171]
    v_mul_f32_dpp v167, v79, v111 quad_perm:[1,0,3,2] row_mask:0xf bank_mask:0xf
    v_cvt_pk_bf16_f32 v151, v166, v167
    v_mfma_f32_16x16x32_bf16 v[168:171], a[76:79], v[140:143], v[168:171]
    v_mul_f32_dpp v160, v80, v112 quad_perm:[1,0,3,2] row_mask:0xf bank_mask:0xf
    v_cvt_pk_bf16_f32 v190, v180, v181 clamp
    v_mfma_f32_16x16x32_bf16 v[172:175], a[92:95], v[140:143], v[20:23]
    v_mul_f32_dpp v161, v81, v113 quad_perm:[1,0,3,2] row_mask:0xf bank_mask:0xf
    v_cvt_pk_bf16_f32 v152, v160, v161
    v_mfma_f32_16x16x32_bf16 v[172:175], a[88:91], v[136:139], v[172:175]
    v_cvt_pk_bf16_f32 v191, v182, v183 clamp
    v_mul_f32_dpp v162, v82, v114 quad_perm:[1,0,3,2] row_mask:0xf bank_mask:0xf
    v_mfma_f32_16x16x32_bf16 v[172:175], a[84:87], v[132:135], v[172:175]
    v_mul_f32_dpp v163, v83, v115 quad_perm:[1,0,3,2] row_mask:0xf bank_mask:0xf
    v_cvt_pk_bf16_f32 v153, v162, v163
    v_mfma_f32_16x16x32_bf16 v[172:175], a[80:83], v[128:131], v[172:175]
    v_mul_f32_dpp v164, v84, v116 quad_perm:[1,0,3,2] row_mask:0xf bank_mask:0xf
    v_mul_f32_dpp v165, v85, v117 quad_perm:[1,0,3,2] row_mask:0xf bank_mask:0xf
    v_mfma_f32_4x4x4_16b_bf16 v[208:211], a[204:205], v[128:129], v[212:215]
    v_cvt_pk_bf16_f32 v154, v164, v165
    v_mul_f32_dpp v166, v86, v118 quad_perm:[1,0,3,2] row_mask:0xf bank_mask:0xf
    v_mul_f32_dpp v167, v87, v119 quad_perm:[1,0,3,2] row_mask:0xf bank_mask:0xf
    v_smfmac_f32_16x16x64_bf16 v[200:203], a[156:159], v[192:199], v233
    v_cvt_pk_bf16_f32 v192, v168, v169 clamp
    v_smfmac_f32_16x16x64_bf16 v[208:211], a[160:163], v[128:135], v233
    v_cvt_pk_bf16_f32 v193, v170, v171 clamp
    v_smfmac_f32_16x16x64_bf16 v[208:211], a[164:167], v[136:143], v233
    v_cvt_pk_bf16_f32 v155, v166, v167
    v_smfmac_f32_16x16x64_bf16 v[208:211], a[128:131], v[184:191], v233
    v_mul_f32_dpp v160, v88, v120 quad_perm:[1,0,3,2] row_mask:0xf bank_mask:0xf
    v_mfma_f32_16x16x32_bf16 v[176:179], a[96:99], v[128:131], v[24:27]
    v_cvt_pk_bf16_f32 v194, v172, v173 clamp
    v_mul_f32_dpp v161, v89, v121 quad_perm:[1,0,3,2] row_mask:0xf bank_mask:0xf
    v_mfma_f32_16x16x32_bf16 v[176:179], a[100:103], v[132:135], v[176:179]
    v_cvt_pk_bf16_f32 v195, v174, v175 clamp
    v_cvt_pk_bf16_f32 v156, v160, v161
    v_mfma_f32_16x16x32_bf16 v[176:179], a[104:107], v[136:139], v[176:179]
    v_mul_f32_dpp v162, v90, v122 quad_perm:[1,0,3,2] row_mask:0xf bank_mask:0xf
    v_mul_f32_dpp v163, v91, v123 quad_perm:[1,0,3,2] row_mask:0xf bank_mask:0xf
    v_mfma_f32_16x16x32_bf16 v[176:179], a[108:111], v[140:143], v[176:179]
    v_cvt_pk_bf16_f32 v157, v162, v163
    v_add_f32 v227, v200, v201
    v_mfma_f32_16x16x32_bf16 v[180:183], a[124:127], v[140:143], v[28:31]
    v_mul_f32_dpp v164, v92, v124 quad_perm:[1,0,3,2] row_mask:0xf bank_mask:0xf
    v_mul_f32_dpp v165, v93, v125 quad_perm:[1,0,3,2] row_mask:0xf bank_mask:0xf
    v_mfma_f32_16x16x32_bf16 v[180:183], a[120:123], v[136:139], v[180:183]
    v_cvt_pk_bf16_f32 v158, v164, v165
    v_mul_f32_dpp v166, v94, v126 quad_perm:[1,0,3,2] row_mask:0xf bank_mask:0xf
    v_mfma_f32_16x16x32_bf16 v[180:183], a[116:119], v[132:135], v[180:183]
    v_mul_f32_dpp v167, v95, v127 quad_perm:[1,0,3,2] row_mask:0xf bank_mask:0xf
    v_cvt_pk_bf16_f32 v159, v166, v167
    v_mfma_f32_16x16x32_bf16 v[180:183], a[112:115], v[128:131], v[180:183]
    v_cvt_pk_bf16_f32 v196, v176, v177 clamp
    v_cvt_pk_bf16_f32 v197, v178, v179 clamp
    v_mfma_f32_16x16x32_bf16 v[168:171], a[0:3], v[144:147], v[0:3]
    v_mul_f32_dpp v160, v64, v96 quad_perm:[2,3,0,1] row_mask:0xf bank_mask:0xf
    v_mul_f32_dpp v161, v65, v97 quad_perm:[2,3,0,1] row_mask:0xf bank_mask:0xf
    v_mfma_f32_16x16x32_bf16 v[168:171], a[4:7], v[148:151], v[168:171]
    v_cvt_pk_bf16_f32 v128, v160, v161
    v_mul_f32_dpp v162, v66, v98 quad_perm:[2,3,0,1] row_mask:0xf bank_mask:0xf
    v_mfma_f32_16x16x32_bf16 v[168:171], a[8:11], v[152:155], v[168:171]
    v_cvt_pk_bf16_f32 v198, v180, v181 clamp
    v_mul_f32_dpp v163, v67, v99 quad_perm:[2,3,0,1] row_mask:0xf bank_mask:0xf
    v_mfma_f32_16x16x32_bf16 v[168:171], a[12:15], v[156:159], v[168:171]
    v_cvt_pk_bf16_f32 v199, v182, v183 clamp
    v_cvt_pk_bf16_f32 v129, v162, v163
    v_mfma_f32_16x16x32_bf16 v[172:175], a[28:31], v[156:159], v[4:7]
    v_mul_f32_dpp v164, v68, v100 quad_perm:[2,3,0,1] row_mask:0xf bank_mask:0xf
    v_mul_f32_dpp v165, v69, v101 quad_perm:[2,3,0,1] row_mask:0xf bank_mask:0xf
    v_mfma_f32_16x16x32_bf16 v[172:175], a[24:27], v[152:155], v[172:175]
    v_cvt_pk_bf16_f32 v130, v164, v165
    v_mul_f32_dpp v166, v70, v102 quad_perm:[2,3,0,1] row_mask:0xf bank_mask:0xf
    v_mfma_f32_16x16x32_bf16 v[172:175], a[20:23], v[148:151], v[172:175]
    v_cvt_pk_bf16_f32 v184, v168, v169 clamp
    v_cvt_pk_bf16_f32 v185, v170, v171 clamp
    v_mfma_f32_16x16x32_bf16 v[172:175], a[16:19], v[144:147], v[172:175]
    v_mul_f32_dpp v167, v71, v103 quad_perm:[2,3,0,1] row_mask:0xf bank_mask:0xf
    v_cvt_pk_bf16_f32 v131, v166, v167
    v_mfma_f32_16x16x32_bf16 v[176:179], a[32:35], v[144:147], v[8:11]
    v_mul_f32_dpp v160, v72, v104 quad_perm:[2,3,0,1] row_mask:0xf bank_mask:0xf
    v_mul_f32_dpp v161, v73, v105 quad_perm:[2,3,0,1] row_mask:0xf bank_mask:0xf
    v_mfma_f32_16x16x32_bf16 v[176:179], a[36:39], v[148:151], v[176:179]
    v_cvt_pk_bf16_f32 v132, v160, v161
    v_mul_f32_dpp v162, v74, v106 quad_perm:[2,3,0,1] row_mask:0xf bank_mask:0xf
    v_mfma_f32_16x16x32_bf16 v[176:179], a[40:43], v[152:155], v[176:179]
    v_cvt_pk_bf16_f32 v186, v172, v173 clamp
    v_cvt_pk_bf16_f32 v187, v174, v175 clamp
    v_mfma_f32_16x16x32_bf16 v[176:179], a[44:47], v[156:159], v[176:179]
    v_mul_f32_dpp v163, v75, v107 quad_perm:[2,3,0,1] row_mask:0xf bank_mask:0xf
    v_cvt_pk_bf16_f32 v133, v162, v163
    v_mfma_f32_16x16x32_bf16 v[180:183], a[60:63], v[156:159], v[12:15]
    v_mul_f32_dpp v164, v76, v108 quad_perm:[2,3,0,1] row_mask:0xf bank_mask:0xf
    v_mul_f32_dpp v165, v77, v109 quad_perm:[2,3,0,1] row_mask:0xf bank_mask:0xf
    v_mfma_f32_16x16x32_bf16 v[180:183], a[56:59], v[152:155], v[180:183]
    v_cvt_pk_bf16_f32 v134, v164, v165
    v_mul_f32_dpp v166, v78, v110 quad_perm:[2,3,0,1] row_mask:0xf bank_mask:0xf
    v_mfma_f32_16x16x32_bf16 v[180:183], a[52:55], v[148:151], v[180:183]
    v_cvt_pk_bf16_f32 v188, v176, v177 clamp
    v_cvt_pk_bf16_f32 v189, v178, v179 clamp
    v_mfma_f32_16x16x32_bf16 v[180:183], a[48:51], v[144:147], v[180:183]
    v_mul_f32_dpp v167, v79, v111 quad_perm:[2,3,0,1] row_mask:0xf bank_mask:0xf
    v_cvt_pk_bf16_f32 v135, v166, v167
    v_mfma_f32_16x16x32_bf16 v[168:171], a[64:67], v[144:147], v[16:19]
    v_mul_f32_dpp v160, v80, v112 quad_perm:[2,3,0,1] row_mask:0xf bank_mask:0xf
    v_mul_f32_dpp v161, v81, v113 quad_perm:[2,3,0,1] row_mask:0xf bank_mask:0xf
    v_mfma_f32_16x16x32_bf16 v[168:171], a[68:71], v[148:151], v[168:171]
    v_cvt_pk_bf16_f32 v136, v160, v161
    v_mul_f32_dpp v162, v82, v114 quad_perm:[2,3,0,1] row_mask:0xf bank_mask:0xf
    v_mfma_f32_16x16x32_bf16 v[168:171], a[72:75], v[152:155], v[168:171]
    v_cvt_pk_bf16_f32 v190, v180, v181 clamp
    v_cvt_pk_bf16_f32 v191, v182, v183 clamp
    v_mfma_f32_16x16x32_bf16 v[168:171], a[76:79], v[156:159], v[168:171]
    v_mul_f32_dpp v163, v83, v115 quad_perm:[2,3,0,1] row_mask:0xf bank_mask:0xf
    v_cvt_pk_bf16_f32 v137, v162, v163
    v_mfma_f32_16x16x32_bf16 v[172:175], a[92:95], v[156:159], v[20:23]
    v_mul_f32_dpp v164, v84, v116 quad_perm:[2,3,0,1] row_mask:0xf bank_mask:0xf
    v_mul_f32_dpp v165, v85, v117 quad_perm:[2,3,0,1] row_mask:0xf bank_mask:0xf
    v_mfma_f32_16x16x32_bf16 v[172:175], a[88:91], v[152:155], v[172:175]
    v_cvt_pk_bf16_f32 v138, v164, v165
    v_mul_f32_dpp v166, v86, v118 quad_perm:[2,3,0,1] row_mask:0xf bank_mask:0xf
    v_mfma_f32_16x16x32_bf16 v[172:175], a[84:87], v[148:151], v[172:175]
    v_mul_f32_dpp v167, v87, v119 quad_perm:[2,3,0,1] row_mask:0xf bank_mask:0xf
    v_cvt_pk_bf16_f32 v139, v166, v167
    v_mfma_f32_16x16x32_bf16 v[172:175], a[80:83], v[144:147], v[172:175]
    v_mul_f32_dpp v160, v88, v120 quad_perm:[2,3,0,1] row_mask:0xf bank_mask:0xf
    v_mul_f32_dpp v161, v89, v121 quad_perm:[2,3,0,1] row_mask:0xf bank_mask:0xf
    v_smfmac_f32_16x16x64_bf16 v[208:211], a[132:135], v[192:199], v233
    v_cvt_pk_bf16_f32 v192, v168, v169 clamp
    v_smfmac_f32_16x16x64_bf16 v[208:211], a[168:171], v[144:151], v233
    v_cvt_pk_bf16_f32 v193, v170, v171 clamp
    v_smfmac_f32_16x16x64_bf16 v[208:211], a[172:175], v[152:159], v233
    v_cvt_pk_bf16_f32 v140, v160, v161
    v_smfmac_f32_16x16x64_bf16 v[208:211], a[136:139], v[184:191], v233
    v_cvt_pk_bf16_f32 v194, v172, v173 clamp
    v_mfma_f32_16x16x32_bf16 v[176:179], a[96:99], v[144:147], v[24:27]
    v_cvt_pk_bf16_f32 v195, v174, v175 clamp
    v_mul_f32_dpp v162, v90, v122 quad_perm:[2,3,0,1] row_mask:0xf bank_mask:0xf
    v_mfma_f32_16x16x32_bf16 v[176:179], a[100:103], v[148:151], v[176:179]
    v_mul_f32_dpp v163, v91, v123 quad_perm:[2,3,0,1] row_mask:0xf bank_mask:0xf
    v_cvt_pk_bf16_f32 v141, v162, v163
    v_mfma_f32_16x16x32_bf16 v[176:179], a[104:107], v[152:155], v[176:179]
    v_mul_f32_dpp v164, v92, v124 quad_perm:[2,3,0,1] row_mask:0xf bank_mask:0xf
    v_mul_f32_dpp v165, v93, v125 quad_perm:[2,3,0,1] row_mask:0xf bank_mask:0xf
    v_mfma_f32_16x16x32_bf16 v[176:179], a[108:111], v[156:159], v[176:179]
    v_cvt_pk_bf16_f32 v142, v164, v165
    v_mul_f32_dpp v166, v94, v126 quad_perm:[2,3,0,1] row_mask:0xf bank_mask:0xf
    v_mfma_f32_16x16x32_bf16 v[180:183], a[124:127], v[156:159], v[28:31]
    v_mul_f32_dpp v167, v95, v127 quad_perm:[2,3,0,1] row_mask:0xf bank_mask:0xf
    v_cvt_pk_bf16_f32 v143, v166, v167
    v_mfma_f32_16x16x32_bf16 v[180:183], a[120:123], v[152:155], v[180:183]
    v_mul_f32_dpp v160, v64, v32 row_newbcast:15 row_mask:0xf bank_mask:0xf
    v_mul_f32_dpp v161, v65, v33 row_newbcast:15 row_mask:0xf bank_mask:0xf
    v_mfma_f32_16x16x32_bf16 v[180:183], a[116:119], v[148:151], v[180:183]
    v_cvt_pk_bf16_f32 v196, v176, v177 clamp
    v_cvt_pk_bf16_f32 v197, v178, v179 clamp
    v_mfma_f32_16x16x32_bf16 v[180:183], a[112:115], v[144:147], v[180:183]
    v_cvt_pk_bf16_f32 v144, v160, v161
    v_mul_f32_dpp v162, v66, v34 row_newbcast:15 row_mask:0xf bank_mask:0xf
    v_mfma_f32_16x16x32_bf16 v[168:171], a[0:3], v[128:131], v[0:3]
    v_mul_f32_dpp v163, v67, v35 row_newbcast:15 row_mask:0xf bank_mask:0xf
    v_cvt_pk_bf16_f32 v145, v162, v163
    v_mfma_f32_16x16x32_bf16 v[168:171], a[4:7], v[132:135], v[168:171]
    v_mul_f32_dpp v164, v68, v36 row_newbcast:15 row_mask:0xf bank_mask:0xf
    v_mul_f32_dpp v165, v69, v37 row_newbcast:15 row_mask:0xf bank_mask:0xf
    v_mfma_f32_16x16x32_bf16 v[168:171], a[8:11], v[136:139], v[168:171]
    v_cvt_pk_bf16_f32 v198, v180, v181 clamp
    v_cvt_pk_bf16_f32 v199, v182, v183 clamp
    v_mfma_f32_16x16x32_bf16 v[168:171], a[12:15], v[140:143], v[168:171]
    v_cvt_pk_bf16_f32 v146, v164, v165
    v_mul_f32_dpp v166, v70, v38 row_newbcast:15 row_mask:0xf bank_mask:0xf
    v_mfma_f32_16x16x32_bf16 v[172:175], a[28:31], v[140:143], v[4:7]
    v_mul_f32_dpp v167, v71, v39 row_newbcast:15 row_mask:0xf bank_mask:0xf
    s_waitcnt vmcnt(0)
    v_mfma_f32_16x16x32_bf16 v[172:175], a[24:27], v[136:139], v[172:175]
    v_lshl_add_u32 v245, v245, 8, v251
    v_cvt_pk_bf16_f32 v147, v166, v167
    v_mfma_f32_16x16x32_bf16 v[172:175], a[20:23], v[132:135], v[172:175]
    v_cvt_pk_bf16_f32 v184, v168, v169 clamp
    v_cvt_pk_bf16_f32 v185, v170, v171 clamp
    v_mfma_f32_16x16x32_bf16 v[172:175], a[16:19], v[128:131], v[172:175]
    v_mul_f32_dpp v160, v72, v40 row_newbcast:15 row_mask:0xf bank_mask:0xf
    v_lshl_add_u32 v246, v246, 8, v251
    v_mfma_f32_16x16x32_bf16 v[176:179], a[32:35], v[128:131], v[8:11]
    v_mul_f32_dpp v161, v73, v41 row_newbcast:15 row_mask:0xf bank_mask:0xf
    v_cvt_pk_bf16_f32 v148, v160, v161
    v_mfma_f32_16x16x32_bf16 v[176:179], a[36:39], v[132:135], v[176:179]
    v_mul_f32_dpp v162, v74, v42 row_newbcast:15 row_mask:0xf bank_mask:0xf
    v_lshl_add_u32 v247, v247, 8, v251
    v_mfma_f32_16x16x32_bf16 v[176:179], a[40:43], v[136:139], v[176:179]
    v_cvt_pk_bf16_f32 v186, v172, v173 clamp
    v_cvt_pk_bf16_f32 v187, v174, v175 clamp
    v_mfma_f32_16x16x32_bf16 v[176:179], a[44:47], v[140:143], v[176:179]
    v_mul_f32_dpp v163, v75, v43 row_newbcast:15 row_mask:0xf bank_mask:0xf
    v_cvt_pk_bf16_f32 v149, v162, v163
    v_mfma_f32_16x16x32_bf16 v[180:183], a[60:63], v[140:143], v[12:15]
    v_mul_f32_dpp v164, v76, v44 row_newbcast:15 row_mask:0xf bank_mask:0xf
    v_mul_f32_dpp v165, v77, v45 row_newbcast:15 row_mask:0xf bank_mask:0xf
    v_mfma_f32_16x16x32_bf16 v[180:183], a[56:59], v[136:139], v[180:183]
    global_load_dwordx4 v[112:115], v245, s[6:7] offset:0
    v_mfma_f32_16x16x32_bf16 v[180:183], a[52:55], v[132:135], v[180:183]
    v_cvt_pk_bf16_f32 v188, v176, v177 clamp
    v_cvt_pk_bf16_f32 v150, v164, v165
    v_mfma_f32_16x16x32_bf16 v[180:183], a[48:51], v[128:131], v[180:183]
    v_mul_f32_dpp v166, v78, v46 row_newbcast:15 row_mask:0xf bank_mask:0xf
    v_cvt_pk_bf16_f32 v189, v178, v179 clamp
    v_mfma_f32_16x16x32_bf16 v[168:171], a[64:67], v[128:131], v[16:19]
    v_mul_f32_dpp v167, v79, v47 row_newbcast:15 row_mask:0xf bank_mask:0xf
    v_cvt_pk_bf16_f32 v151, v166, v167
    v_mfma_f32_16x16x32_bf16 v[168:171], a[68:71], v[132:135], v[168:171]
    v_mul_f32_dpp v160, v80, v48 row_newbcast:15 row_mask:0xf bank_mask:0xf
    v_mul_f32_dpp v161, v81, v49 row_newbcast:15 row_mask:0xf bank_mask:0xf
    v_mfma_f32_16x16x32_bf16 v[168:171], a[72:75], v[136:139], v[168:171]
    v_cvt_pk_bf16_f32 v190, v180, v181 clamp
    v_cvt_pk_bf16_f32 v152, v160, v161
    v_mfma_f32_16x16x32_bf16 v[168:171], a[76:79], v[140:143], v[168:171]
    v_mul_f32_dpp v162, v82, v50 row_newbcast:15 row_mask:0xf bank_mask:0xf
    v_cvt_pk_bf16_f32 v191, v182, v183 clamp
    v_mfma_f32_16x16x32_bf16 v[172:175], a[92:95], v[140:143], v[20:23]
    v_mul_f32_dpp v163, v83, v51 row_newbcast:15 row_mask:0xf bank_mask:0xf
    v_cvt_pk_bf16_f32 v153, v162, v163
    v_mfma_f32_16x16x32_bf16 v[172:175], a[88:91], v[136:139], v[172:175]
    v_mul_f32_dpp v164, v84, v52 row_newbcast:15 row_mask:0xf bank_mask:0xf
    v_mul_f32_dpp v165, v85, v53 row_newbcast:15 row_mask:0xf bank_mask:0xf
    v_mfma_f32_16x16x32_bf16 v[172:175], a[84:87], v[132:135], v[172:175]
    global_load_dwordx4 v[116:119], v245, s[6:7] offset:64
    v_mfma_f32_16x16x32_bf16 v[172:175], a[80:83], v[128:131], v[172:175]
    v_cvt_pk_bf16_f32 v154, v164, v165
    v_mul_f32_dpp v166, v86, v54 row_newbcast:15 row_mask:0xf bank_mask:0xf
    v_smfmac_f32_16x16x64_bf16 v[208:211], a[140:143], v[192:199], v233
    v_cvt_pk_bf16_f32 v192, v168, v169 clamp
    v_smfmac_f32_16x16x64_bf16 v[208:211], a[176:179], v[128:135], v233
    v_cvt_pk_bf16_f32 v193, v170, v171 clamp
    v_smfmac_f32_16x16x64_bf16 v[208:211], a[180:183], v[136:143], v233
    v_mul_f32_dpp v167, v87, v55 row_newbcast:15 row_mask:0xf bank_mask:0xf
    v_smfmac_f32_16x16x64_bf16 v[208:211], a[144:147], v[184:191], v233
    v_cvt_pk_bf16_f32 v155, v166, v167
    v_mfma_f32_16x16x32_bf16 v[176:179], a[96:99], v[128:131], v[24:27]
    v_mul_f32_dpp v160, v88, v56 row_newbcast:15 row_mask:0xf bank_mask:0xf
    v_mul_f32_dpp v161, v89, v57 row_newbcast:15 row_mask:0xf bank_mask:0xf
    v_mfma_f32_16x16x32_bf16 v[176:179], a[100:103], v[132:135], v[176:179]
    v_cvt_pk_bf16_f32 v194, v172, v173 clamp
    v_cvt_pk_bf16_f32 v156, v160, v161
    v_mfma_f32_16x16x32_bf16 v[176:179], a[104:107], v[136:139], v[176:179]
    v_cvt_pk_bf16_f32 v195, v174, v175 clamp
    v_mul_f32_dpp v162, v90, v58 row_newbcast:15 row_mask:0xf bank_mask:0xf
    v_mfma_f32_16x16x32_bf16 v[176:179], a[108:111], v[140:143], v[176:179]
    v_mul_f32_dpp v163, v91, v59 row_newbcast:15 row_mask:0xf bank_mask:0xf
    v_cvt_pk_bf16_f32 v157, v162, v163
    v_mfma_f32_16x16x32_bf16 v[180:183], a[124:127], v[140:143], v[28:31]
    v_mul_f32_dpp v164, v92, v60 row_newbcast:15 row_mask:0xf bank_mask:0xf
    v_mul_f32_dpp v165, v93, v61 row_newbcast:15 row_mask:0xf bank_mask:0xf
    v_mfma_f32_16x16x32_bf16 v[180:183], a[120:123], v[136:139], v[180:183]
    v_cvt_pk_bf16_f32 v158, v164, v165
    v_mul_f32_dpp v166, v94, v62 row_newbcast:15 row_mask:0xf bank_mask:0xf
    v_mfma_f32_16x16x32_bf16 v[180:183], a[116:119], v[132:135], v[180:183]
    global_load_dwordx4 v[120:123], v245, s[6:7] offset:128
    v_mfma_f32_16x16x32_bf16 v[180:183], a[112:115], v[128:131], v[180:183]
    v_mul_f32_dpp v167, v95, v63 row_newbcast:15 row_mask:0xf bank_mask:0xf
    v_cvt_pk_bf16_f32 v159, v166, v167
    v_mfma_f32_16x16x32_bf16 v[168:171], a[0:3], v[144:147], v[0:3]
    v_cvt_pk_bf16_f32 v196, v176, v177 clamp
    v_cvt_pk_bf16_f32 v197, v178, v179 clamp
    v_mfma_f32_16x16x32_bf16 v[168:171], a[4:7], v[148:151], v[168:171]
    v_mul_f32_dpp v160, v64, v32 row_newbcast:0 row_mask:0xf bank_mask:0xf
    v_mul_f32_dpp v161, v65, v33 row_newbcast:0 row_mask:0xf bank_mask:0xf
    v_mfma_f32_16x16x32_bf16 v[168:171], a[8:11], v[152:155], v[168:171]
    v_cvt_pk_bf16_f32 v128, v160, v161
    v_cvt_pk_bf16_f32 v198, v180, v181 clamp
    v_mfma_f32_16x16x32_bf16 v[168:171], a[12:15], v[156:159], v[168:171]
    v_mul_f32_dpp v162, v66, v34 row_newbcast:0 row_mask:0xf bank_mask:0xf
    v_mul_f32_dpp v163, v67, v35 row_newbcast:0 row_mask:0xf bank_mask:0xf
    v_mfma_f32_16x16x32_bf16 v[172:175], a[28:31], v[156:159], v[4:7]
    v_cvt_pk_bf16_f32 v199, v182, v183 clamp
    v_cvt_pk_bf16_f32 v129, v162, v163
    v_mfma_f32_16x16x32_bf16 v[172:175], a[24:27], v[152:155], v[172:175]
    v_mul_f32_dpp v164, v68, v36 row_newbcast:0 row_mask:0xf bank_mask:0xf
    v_mul_f32_dpp v165, v69, v37 row_newbcast:0 row_mask:0xf bank_mask:0xf
    v_mfma_f32_16x16x32_bf16 v[172:175], a[20:23], v[148:151], v[172:175]
    global_load_dwordx4 v[124:127], v245, s[6:7] offset:192
    v_mfma_f32_16x16x32_bf16 v[172:175], a[16:19], v[144:147], v[172:175]
    v_cvt_pk_bf16_f32 v130, v164, v165
    v_cvt_pk_bf16_f32 v184, v168, v169 clamp
    v_mfma_f32_16x16x32_bf16 v[176:179], a[32:35], v[144:147], v[8:11]
    v_mul_f32_dpp v166, v70, v38 row_newbcast:0 row_mask:0xf bank_mask:0xf
    v_mul_f32_dpp v167, v71, v39 row_newbcast:0 row_mask:0xf bank_mask:0xf
    v_mfma_f32_16x16x32_bf16 v[176:179], a[36:39], v[148:151], v[176:179]
    v_cvt_pk_bf16_f32 v185, v170, v171 clamp
    v_cvt_pk_bf16_f32 v131, v166, v167
    v_mfma_f32_16x16x32_bf16 v[176:179], a[40:43], v[152:155], v[176:179]
    v_mul_f32_dpp v160, v72, v40 row_newbcast:0 row_mask:0xf bank_mask:0xf
    v_mul_f32_dpp v161, v73, v41 row_newbcast:0 row_mask:0xf bank_mask:0xf
    v_mfma_f32_16x16x32_bf16 v[176:179], a[44:47], v[156:159], v[176:179]
    v_cvt_pk_bf16_f32 v132, v160, v161
    v_mul_f32_dpp v162, v74, v42 row_newbcast:0 row_mask:0xf bank_mask:0xf
    v_mfma_f32_16x16x32_bf16 v[180:183], a[60:63], v[156:159], v[12:15]
    v_cvt_pk_bf16_f32 v186, v172, v173 clamp
    v_mul_f32_dpp v163, v75, v43 row_newbcast:0 row_mask:0xf bank_mask:0xf
    v_mfma_f32_16x16x32_bf16 v[180:183], a[56:59], v[152:155], v[180:183]
    v_cvt_pk_bf16_f32 v187, v174, v175 clamp
    v_cvt_pk_bf16_f32 v133, v162, v163
    v_mfma_f32_16x16x32_bf16 v[180:183], a[52:55], v[148:151], v[180:183]
    v_mul_f32_dpp v164, v76, v44 row_newbcast:0 row_mask:0xf bank_mask:0xf
    v_mul_f32_dpp v165, v77, v45 row_newbcast:0 row_mask:0xf bank_mask:0xf
    v_mfma_f32_16x16x32_bf16 v[180:183], a[48:51], v[144:147], v[180:183]
    v_cvt_pk_bf16_f32 v134, v164, v165
    v_mul_f32_dpp v166, v78, v46 row_newbcast:0 row_mask:0xf bank_mask:0xf
    v_mfma_f32_16x16x32_bf16 v[168:171], a[64:67], v[144:147], v[16:19]
    v_cvt_pk_bf16_f32 v188, v176, v177 clamp
    v_mul_f32_dpp v167, v79, v47 row_newbcast:0 row_mask:0xf bank_mask:0xf
    v_mfma_f32_16x16x32_bf16 v[168:171], a[68:71], v[148:151], v[168:171]
    v_cvt_pk_bf16_f32 v189, v178, v179 clamp
    v_cvt_pk_bf16_f32 v135, v166, v167
    v_mfma_f32_16x16x32_bf16 v[168:171], a[72:75], v[152:155], v[168:171]
    v_mul_f32_dpp v160, v80, v48 row_newbcast:0 row_mask:0xf bank_mask:0xf
    v_mul_f32_dpp v161, v81, v49 row_newbcast:0 row_mask:0xf bank_mask:0xf
    v_mfma_f32_16x16x32_bf16 v[168:171], a[76:79], v[156:159], v[168:171]
    v_cvt_pk_bf16_f32 v136, v160, v161
    v_mul_f32_dpp v162, v82, v50 row_newbcast:0 row_mask:0xf bank_mask:0xf
    v_mfma_f32_16x16x32_bf16 v[172:175], a[92:95], v[156:159], v[20:23]
    v_cvt_pk_bf16_f32 v190, v180, v181 clamp
    v_mul_f32_dpp v163, v83, v51 row_newbcast:0 row_mask:0xf bank_mask:0xf
    v_mfma_f32_16x16x32_bf16 v[172:175], a[88:91], v[152:155], v[172:175]
    v_cvt_pk_bf16_f32 v191, v182, v183 clamp
    v_cvt_pk_bf16_f32 v137, v162, v163
    v_mfma_f32_16x16x32_bf16 v[172:175], a[84:87], v[148:151], v[172:175]
    v_mul_f32_dpp v164, v84, v52 row_newbcast:0 row_mask:0xf bank_mask:0xf
    v_mul_f32_dpp v165, v85, v53 row_newbcast:0 row_mask:0xf bank_mask:0xf
    v_mfma_f32_16x16x32_bf16 v[172:175], a[80:83], v[144:147], v[172:175]
    v_cvt_pk_bf16_f32 v138, v164, v165
    v_mul_f32_dpp v166, v86, v54 row_newbcast:0 row_mask:0xf bank_mask:0xf
    v_smfmac_f32_16x16x64_bf16 v[208:211], a[148:151], v[192:199], v233
    v_cvt_pk_bf16_f32 v192, v168, v169 clamp
    v_smfmac_f32_16x16x64_bf16 v[208:211], a[152:155], v[184:191], v233
    v_mul_f32_dpp v167, v87, v55 row_newbcast:0 row_mask:0xf bank_mask:0xf
    v_mfma_f32_16x16x32_bf16 v[176:179], a[96:99], v[144:147], v[24:27]
    v_cvt_pk_bf16_f32 v193, v170, v171 clamp
    v_cvt_pk_bf16_f32 v139, v166, v167
    v_mfma_f32_16x16x32_bf16 v[176:179], a[100:103], v[148:151], v[176:179]
    v_mul_f32_dpp v160, v88, v56 row_newbcast:0 row_mask:0xf bank_mask:0xf
    v_mul_f32_dpp v161, v89, v57 row_newbcast:0 row_mask:0xf bank_mask:0xf
    v_mfma_f32_16x16x32_bf16 v[176:179], a[104:107], v[152:155], v[176:179]
    v_cvt_pk_bf16_f32 v140, v160, v161
    v_mul_f32_dpp v162, v90, v58 row_newbcast:0 row_mask:0xf bank_mask:0xf
    v_mfma_f32_16x16x32_bf16 v[176:179], a[108:111], v[156:159], v[176:179]
    v_cvt_pk_bf16_f32 v194, v172, v173 clamp
    v_mul_f32_dpp v163, v91, v59 row_newbcast:0 row_mask:0xf bank_mask:0xf
    v_mfma_f32_16x16x32_bf16 v[180:183], a[124:127], v[156:159], v[28:31]
    v_cvt_pk_bf16_f32 v195, v174, v175 clamp
    v_cvt_pk_bf16_f32 v141, v162, v163
    v_mfma_f32_16x16x32_bf16 v[180:183], a[120:123], v[152:155], v[180:183]
    v_mul_f32_dpp v164, v92, v60 row_newbcast:0 row_mask:0xf bank_mask:0xf
    v_mul_f32_dpp v165, v93, v61 row_newbcast:0 row_mask:0xf bank_mask:0xf
    v_mfma_f32_16x16x32_bf16 v[180:183], a[116:119], v[148:151], v[180:183]
    v_cvt_pk_bf16_f32 v142, v164, v165
    v_mul_f32_dpp v166, v94, v62 row_newbcast:0 row_mask:0xf bank_mask:0xf
    v_mfma_f32_16x16x32_bf16 v[180:183], a[112:115], v[144:147], v[180:183]
    v_mul_f32_dpp v167, v95, v63 row_newbcast:0 row_mask:0xf bank_mask:0xf
    v_cvt_pk_bf16_f32 v143, v166, v167
    v_mfma_f32_16x16x32_bf16 v[168:171], a[0:3], v[128:131], v[0:3]
    v_cvt_pk_bf16_f32 v196, v176, v177 clamp
    v_cvt_pk_bf16_f32 v197, v178, v179 clamp
    v_mfma_f32_16x16x32_bf16 v[168:171], a[4:7], v[132:135], v[168:171]
    v_mul_f32_dpp v160, v64, v32 row_newbcast:4 row_mask:0xf bank_mask:0xf
    v_mul_f32_dpp v161, v65, v33 row_newbcast:4 row_mask:0xf bank_mask:0xf
    v_mfma_f32_16x16x32_bf16 v[168:171], a[8:11], v[136:139], v[168:171]
    v_cvt_pk_bf16_f32 v144, v160, v161
    v_cvt_pk_bf16_f32 v198, v180, v181 clamp
    v_mfma_f32_16x16x32_bf16 v[168:171], a[12:15], v[140:143], v[168:171]
    v_mul_f32_dpp v162, v66, v34 row_newbcast:4 row_mask:0xf bank_mask:0xf
    v_mul_f32_dpp v163, v67, v35 row_newbcast:4 row_mask:0xf bank_mask:0xf
    v_mfma_f32_16x16x32_bf16 v[172:175], a[28:31], v[140:143], v[4:7]
    v_cvt_pk_bf16_f32 v199, v182, v183 clamp
    v_cvt_pk_bf16_f32 v145, v162, v163
    v_mfma_f32_16x16x32_bf16 v[172:175], a[24:27], v[136:139], v[172:175]
    v_mul_f32_dpp v164, v68, v36 row_newbcast:4 row_mask:0xf bank_mask:0xf
    v_mul_f32_dpp v165, v69, v37 row_newbcast:4 row_mask:0xf bank_mask:0xf
    v_mfma_f32_16x16x32_bf16 v[172:175], a[20:23], v[132:135], v[172:175]
    v_cvt_pk_bf16_f32 v146, v164, v165
    v_cvt_pk_bf16_f32 v184, v168, v169 clamp
    v_mfma_f32_16x16x32_bf16 v[172:175], a[16:19], v[128:131], v[172:175]
    v_mul_f32_dpp v166, v70, v38 row_newbcast:4 row_mask:0xf bank_mask:0xf
    v_mul_f32_dpp v167, v71, v39 row_newbcast:4 row_mask:0xf bank_mask:0xf
    v_mfma_f32_16x16x32_bf16 v[176:179], a[32:35], v[128:131], v[8:11]
    v_cvt_pk_bf16_f32 v185, v170, v171 clamp
    v_cvt_pk_bf16_f32 v147, v166, v167
    v_mfma_f32_16x16x32_bf16 v[176:179], a[36:39], v[132:135], v[176:179]
    v_mul_f32_dpp v160, v72, v40 row_newbcast:4 row_mask:0xf bank_mask:0xf
    v_mul_f32_dpp v161, v73, v41 row_newbcast:4 row_mask:0xf bank_mask:0xf
    v_mfma_f32_16x16x32_bf16 v[176:179], a[40:43], v[136:139], v[176:179]
    v_cvt_pk_bf16_f32 v148, v160, v161
    v_mul_f32_dpp v162, v74, v42 row_newbcast:4 row_mask:0xf bank_mask:0xf
    v_mfma_f32_16x16x32_bf16 v[176:179], a[44:47], v[140:143], v[176:179]
    v_cvt_pk_bf16_f32 v186, v172, v173 clamp
    v_mul_f32_dpp v163, v75, v43 row_newbcast:4 row_mask:0xf bank_mask:0xf
    v_mfma_f32_16x16x32_bf16 v[180:183], a[60:63], v[140:143], v[12:15]
    v_mov_b32 v200, 0
    v_cvt_pk_bf16_f32 v187, v174, v175 clamp
    v_mfma_f32_16x16x32_bf16 v[180:183], a[56:59], v[136:139], v[180:183]
    v_cvt_pk_bf16_f32 v149, v162, v163
    v_mul_f32_dpp v164, v76, v44 row_newbcast:4 row_mask:0xf bank_mask:0xf
    v_mfma_f32_16x16x32_bf16 v[180:183], a[52:55], v[132:135], v[180:183]
    v_mul_f32_dpp v165, v77, v45 row_newbcast:4 row_mask:0xf bank_mask:0xf
    v_mov_b32 v201, 0
    v_mfma_f32_16x16x32_bf16 v[180:183], a[48:51], v[128:131], v[180:183]
L_pad7:
    s_cbranch_vccnz L_resume
    v_cvt_pk_bf16_f32 v150, v164, v165
    v_mul_f32_dpp v166, v78, v46 row_newbcast:4 row_mask:0xf bank_mask:0xf
    v_mfma_f32_16x16x32_bf16 v[168:171], a[64:67], v[128:131], v[16:19]
    v_cvt_pk_bf16_f32 v188, v176, v177 clamp
    v_mul_f32_dpp v167, v79, v47 row_newbcast:4 row_mask:0xf bank_mask:0xf
    v_mfma_f32_16x16x32_bf16 v[168:171], a[68:71], v[132:135], v[168:171]
    v_cvt_pk_bf16_f32 v189, v178, v179 clamp
    v_cvt_pk_bf16_f32 v151, v166, v167
    v_mfma_f32_16x16x32_bf16 v[168:171], a[72:75], v[136:139], v[168:171]
    v_mul_f32_dpp v160, v80, v48 row_newbcast:4 row_mask:0xf bank_mask:0xf
    v_mul_f32_dpp v161, v81, v49 row_newbcast:4 row_mask:0xf bank_mask:0xf
    v_mfma_f32_16x16x32_bf16 v[168:171], a[76:79], v[140:143], v[168:171]
    v_cvt_pk_bf16_f32 v152, v160, v161
    v_mul_f32_dpp v162, v82, v50 row_newbcast:4 row_mask:0xf bank_mask:0xf
    v_mfma_f32_16x16x32_bf16 v[172:175], a[92:95], v[140:143], v[20:23]
    v_cvt_pk_bf16_f32 v190, v180, v181 clamp
    v_mul_f32_dpp v163, v83, v51 row_newbcast:4 row_mask:0xf bank_mask:0xf
    v_mfma_f32_16x16x32_bf16 v[172:175], a[88:91], v[136:139], v[172:175]
    v_cvt_pk_bf16_f32 v191, v182, v183 clamp
    v_cvt_pk_bf16_f32 v153, v162, v163
    v_mfma_f32_16x16x32_bf16 v[172:175], a[84:87], v[132:135], v[172:175]
    v_mul_f32_dpp v164, v84, v52 row_newbcast:4 row_mask:0xf bank_mask:0xf
    v_mul_f32_dpp v165, v85, v53 row_newbcast:4 row_mask:0xf bank_mask:0xf
    v_mfma_f32_16x16x32_bf16 v[172:175], a[80:83], v[128:131], v[172:175]
    v_cvt_pk_bf16_f32 v154, v164, v165
    v_mul_f32_dpp v166, v86, v54 row_newbcast:4 row_mask:0xf bank_mask:0xf
    v_smfmac_f32_16x16x64_bf16 v[208:211], a[156:159], v[192:199], v233
    v_cvt_pk_bf16_f32 v192, v168, v169 clamp
    v_smfmac_f32_16x16x64_bf16 v[200:203], a[128:131], v[184:191], v233
    v_mul_f32_dpp v167, v87, v55 row_newbcast:4 row_mask:0xf bank_mask:0xf
    v_mfma_f32_16x16x32_bf16 v[176:179], a[96:99], v[128:131], v[24:27]
    v_cvt_pk_bf16_f32 v193, v170, v171 clamp
    v_cvt_pk_bf16_f32 v155, v166, v167
    v_mfma_f32_16x16x32_bf16 v[176:179], a[100:103], v[132:135], v[176:179]
    v_mul_f32_dpp v160, v88, v56 row_newbcast:4 row_mask:0xf bank_mask:0xf
    v_mul_f32_dpp v161, v89, v57 row_newbcast:4 row_mask:0xf bank_mask:0xf
    v_mfma_f32_16x16x32_bf16 v[176:179], a[104:107], v[136:139], v[176:179]
    v_cvt_pk_bf16_f32 v156, v160, v161
    v_mul_f32_dpp v162, v90, v58 row_newbcast:4 row_mask:0xf bank_mask:0xf
    v_mfma_f32_16x16x32_bf16 v[176:179], a[108:111], v[140:143], v[176:179]
    v_cvt_pk_bf16_f32 v194, v172, v173 clamp
    v_mul_f32_dpp v163, v91, v59 row_newbcast:4 row_mask:0xf bank_mask:0xf
    v_mfma_f32_16x16x32_bf16 v[180:183], a[124:127], v[140:143], v[28:31]
    v_cvt_pk_bf16_f32 v195, v174, v175 clamp
    v_cvt_pk_bf16_f32 v157, v162, v163
    v_mfma_f32_16x16x32_bf16 v[180:183], a[120:123], v[136:139], v[180:183]
    v_mul_f32_dpp v164, v92, v60 row_newbcast:4 row_mask:0xf bank_mask:0xf
    v_mul_f32_dpp v165, v93, v61 row_newbcast:4 row_mask:0xf bank_mask:0xf
    v_mfma_f32_16x16x32_bf16 v[180:183], a[116:119], v[132:135], v[180:183]
    v_add_f32 v228, v208, v209
    v_cvt_pk_bf16_f32 v158, v164, v165
    v_mfma_f32_16x16x32_bf16 v[180:183], a[112:115], v[128:131], v[180:183]
    v_mul_f32_dpp v166, v94, v62 row_newbcast:4 row_mask:0xf bank_mask:0xf
    v_mul_f32_dpp v167, v95, v63 row_newbcast:4 row_mask:0xf bank_mask:0xf
    v_mfma_f32_16x16x32_bf16 v[168:171], a[0:3], v[144:147], v[0:3]
    v_cvt_pk_bf16_f32 v159, v166, v167
    v_add_f32 v210, v210, v211
    v_mfma_f32_16x16x32_bf16 v[168:171], a[4:7], v[148:151], v[168:171]
    v_cvt_pk_bf16_f32 v196, v176, v177 clamp
    v_cvt_pk_bf16_f32 v197, v178, v179 clamp
    v_mfma_f32_16x16x32_bf16 v[168:171], a[8:11], v[152:155], v[168:171]
    v_mul_f32_dpp v160, v64, v32 row_newbcast:8 row_mask:0xf bank_mask:0xf
    v_mul_f32_dpp v161, v65, v33 row_newbcast:8 row_mask:0xf bank_mask:0xf
    v_mfma_f32_16x16x32_bf16 v[168:171], a[12:15], v[156:159], v[168:171]
    v_mul_f32_dpp v223, v210, v241 quad_perm:[0,1,2,3] row_mask:0x7 bank_mask:0xf
    v_cvt_pk_bf16_f32 v128, v160, v161
    v_mfma_f32_16x16x32_bf16 v[172:175], a[28:31], v[156:159], v[4:7]
    v_cvt_pk_bf16_f32 v198, v180, v181 clamp
    v_mul_f32_dpp v162, v66, v34 row_newbcast:8 row_mask:0xf bank_mask:0xf
    v_mfma_f32_16x16x32_bf16 v[172:175], a[24:27], v[152:155], v[172:175]
    v_mul_f32_dpp v163, v67, v35 row_newbcast:8 row_mask:0xf bank_mask:0xf
    v_cvt_pk_bf16_f32 v199, v182, v183 clamp
    v_mfma_f32_16x16x32_bf16 v[172:175], a[20:23], v[148:151], v[172:175]
    v_cvt_pk_bf16_f32 v129, v162, v163
    v_mul_f32_dpp v164, v68, v36 row_newbcast:8 row_mask:0xf bank_mask:0xf
    v_mfma_f32_16x16x32_bf16 v[172:175], a[16:19], v[144:147], v[172:175]
    v_mul_f32_dpp v165, v69, v37 row_newbcast:8 row_mask:0xf bank_mask:0xf
    v_cvt_pk_bf16_f32 v130, v164, v165
    v_mfma_f32_16x16x32_bf16 v[176:179], a[32:35], v[144:147], v[8:11]
    v_cvt_pk_bf16_f32 v184, v168, v169 clamp
    v_mul_f32_dpp v166, v70, v38 row_newbcast:8 row_mask:0xf bank_mask:0xf
    v_mfma_f32_16x16x32_bf16 v[176:179], a[36:39], v[148:151], v[176:179]
    v_mul_f32_dpp v167, v71, v39 row_newbcast:8 row_mask:0xf bank_mask:0xf
    v_cvt_pk_bf16_f32 v185, v170, v171 clamp
    v_mfma_f32_16x16x32_bf16 v[176:179], a[40:43], v[152:155], v[176:179]
    v_cvt_pk_bf16_f32 v131, v166, v167
    v_mul_f32_dpp v160, v72, v40 row_newbcast:8 row_mask:0xf bank_mask:0xf
    v_mfma_f32_16x16x32_bf16 v[176:179], a[44:47], v[156:159], v[176:179]
    v_mul_f32_dpp v161, v73, v41 row_newbcast:8 row_mask:0xf bank_mask:0xf
    v_cvt_pk_bf16_f32 v132, v160, v161
    v_mfma_f32_16x16x32_bf16 v[180:183], a[60:63], v[156:159], v[12:15]
    v_mul_f32_dpp v162, v74, v42 row_newbcast:8 row_mask:0xf bank_mask:0xf
    v_cvt_pk_bf16_f32 v186, v172, v173 clamp
    v_mfma_f32_16x16x32_bf16 v[180:183], a[56:59], v[152:155], v[180:183]
    v_mul_f32_dpp v163, v75, v43 row_newbcast:8 row_mask:0xf bank_mask:0xf
    v_cvt_pk_bf16_f32 v187, v174, v175 clamp
    v_mfma_f32_16x16x32_bf16 v[180:183], a[52:55], v[148:151], v[180:183]
    v_cvt_pk_bf16_f32 v133, v162, v163
    v_mul_f32_dpp v164, v76, v44 row_newbcast:8 row_mask:0xf bank_mask:0xf
    v_mfma_f32_16x16x32_bf16 v[180:183], a[48:51], v[144:147], v[180:183]
    v_mul_f32_dpp v165, v77, v45 row_newbcast:8 row_mask:0xf bank_mask:0xf
    v_cvt_pk_bf16_f32 v134, v164, v165
    v_mfma_f32_16x16x32_bf16 v[168:171], a[64:67], v[144:147], v[16:19]
    v_mul_f32_dpp v166, v78, v46 row_newbcast:8 row_mask:0xf bank_mask:0xf
    v_cvt_pk_bf16_f32 v188, v176, v177 clamp
    v_mfma_f32_16x16x32_bf16 v[168:171], a[68:71], v[148:151], v[168:171]
    v_mul_f32_dpp v167, v79, v47 row_newbcast:8 row_mask:0xf bank_mask:0xf
    v_cvt_pk_bf16_f32 v189, v178, v179 clamp
    v_mfma_f32_16x16x32_bf16 v[168:171], a[72:75], v[152:155], v[168:171]
    v_cvt_pk_bf16_f32 v135, v166, v167
    v_mul_f32_dpp v160, v80, v48 row_newbcast:8 row_mask:0xf bank_mask:0xf
    v_mfma_f32_16x16x32_bf16 v[168:171], a[76:79], v[156:159], v[168:171]
    v_mul_f32_dpp v161, v81, v49 row_newbcast:8 row_mask:0xf bank_mask:0xf
    v_cvt_pk_bf16_f32 v136, v160, v161
    v_mfma_f32_16x16x32_bf16 v[172:175], a[92:95], v[156:159], v[20:23]
    v_mul_f32_dpp v162, v82, v50 row_newbcast:8 row_mask:0xf bank_mask:0xf
    v_cvt_pk_bf16_f32 v190, v180, v181 clamp
    v_mfma_f32_16x16x32_bf16 v[172:175], a[88:91], v[152:155], v[172:175]
    v_mul_f32_dpp v163, v83, v51 row_newbcast:8 row_mask:0xf bank_mask:0xf
    v_cvt_pk_bf16_f32 v191, v182, v183 clamp
    v_mfma_f32_16x16x32_bf16 v[172:175], a[84:87], v[148:151], v[172:175]
    v_cvt_pk_bf16_f32 v137, v162, v163
    v_mul_f32_dpp v164, v84, v52 row_newbcast:8 row_mask:0xf bank_mask:0xf
    v_mfma_f32_16x16x32_bf16 v[172:175], a[80:83], v[144:147], v[172:175]
    v_mul_f32_dpp v165, v85, v53 row_newbcast:8 row_mask:0xf bank_mask:0xf
    v_cvt_pk_bf16_f32 v138, v164, v165
    v_smfmac_f32_16x16x64_bf16 v[200:203], a[132:135], v[192:199], v233
    v_mul_f32_dpp v166, v86, v54 row_newbcast:8 row_mask:0xf bank_mask:0xf
    v_smfmac_f32_16x16x64_bf16 v[200:203], a[136:139], v[184:191], v233
    v_cvt_pk_bf16_f32 v192, v168, v169 clamp
    v_mfma_f32_16x16x32_bf16 v[176:179], a[96:99], v[144:147], v[24:27]
    v_mul_f32_dpp v167, v87, v55 row_newbcast:8 row_mask:0xf bank_mask:0xf
    v_cvt_pk_bf16_f32 v193, v170, v171 clamp
    v_mfma_f32_16x16x32_bf16 v[176:179], a[100:103], v[148:151], v[176:179]
    v_cvt_pk_bf16_f32 v139, v166, v167
    v_mul_f32_dpp v160, v88, v56 row_newbcast:8 row_mask:0xf bank_mask:0xf
    v_mfma_f32_16x16x32_bf16 v[176:179], a[104:107], v[152:155], v[176:179]
    v_mul_f32_dpp v161, v89, v57 row_newbcast:8 row_mask:0xf bank_mask:0xf
    v_cvt_pk_bf16_f32 v140, v160, v161
    v_mfma_f32_16x16x32_bf16 v[176:179], a[108:111], v[156:159], v[176:179]
    v_mul_f32_dpp v162, v90, v58 row_newbcast:8 row_mask:0xf bank_mask:0xf
    v_cvt_pk_bf16_f32 v194, v172, v173 clamp
    v_mfma_f32_16x16x32_bf16 v[180:183], a[124:127], v[156:159], v[28:31]
    v_mul_f32_dpp v163, v91, v59 row_newbcast:8 row_mask:0xf bank_mask:0xf
    v_cvt_pk_bf16_f32 v195, v174, v175 clamp
    v_mfma_f32_16x16x32_bf16 v[180:183], a[120:123], v[152:155], v[180:183]
    v_cvt_pk_bf16_f32 v141, v162, v163
    v_mul_f32_dpp v164, v92, v60 row_newbcast:8 row_mask:0xf bank_mask:0xf
    v_mfma_f32_16x16x32_bf16 v[180:183], a[116:119], v[148:151], v[180:183]
    v_mul_f32_dpp v165, v93, v61 row_newbcast:8 row_mask:0xf bank_mask:0xf
    v_cvt_pk_bf16_f32 v142, v164, v165
    v_mfma_f32_16x16x32_bf16 v[180:183], a[112:115], v[144:147], v[180:183]
    v_mul_f32_dpp v166, v94, v62 row_newbcast:8 row_mask:0xf bank_mask:0xf
    v_mul_f32_dpp v167, v95, v63 row_newbcast:8 row_mask:0xf bank_mask:0xf
    v_mfma_f32_16x16x32_bf16 v[168:171], a[0:3], v[128:131], v[0:3]
    v_cvt_pk_bf16_f32 v143, v166, v167
    v_cvt_pk_bf16_f32 v196, v176, v177 clamp
    v_mfma_f32_16x16x32_bf16 v[168:171], a[4:7], v[132:135], v[168:171]
    v_cvt_pk_bf16_f32 v197, v178, v179 clamp
    v_mul_f32_dpp v160, v64, v32 row_newbcast:12 row_mask:0xf bank_mask:0xf
    v_mfma_f32_16x16x32_bf16 v[168:171], a[8:11], v[136:139], v[168:171]
    v_mul_f32_dpp v161, v65, v33 row_newbcast:12 row_mask:0xf bank_mask:0xf
    v_cvt_pk_bf16_f32 v144, v160, v161
    v_mfma_f32_16x16x32_bf16 v[168:171], a[12:15], v[140:143], v[168:171]
    v_cvt_pk_bf16_f32 v198, v180, v181 clamp
    v_mul_f32_dpp v162, v66, v34 row_newbcast:12 row_mask:0xf bank_mask:0xf
    v_mfma_f32_16x16x32_bf16 v[172:175], a[28:31], v[140:143], v[4:7]
    v_mul_f32_dpp v163, v67, v35 row_newbcast:12 row_mask:0xf bank_mask:0xf
    v_cvt_pk_bf16_f32 v199, v182, v183 clamp
    v_mfma_f32_16x16x32_bf16 v[172:175], a[24:27], v[136:139], v[172:175]
    v_cvt_pk_bf16_f32 v145, v162, v163
    v_mul_f32_dpp v164, v68, v36 row_newbcast:12 row_mask:0xf bank_mask:0xf
    v_mfma_f32_16x16x32_bf16 v[172:175], a[20:23], v[132:135], v[172:175]
    v_mul_f32_dpp v165, v69, v37 row_newbcast:12 row_mask:0xf bank_mask:0xf
    v_cvt_pk_bf16_f32 v146, v164, v165
    v_mfma_f32_16x16x32_bf16 v[172:175], a[16:19], v[128:131], v[172:175]
    v_cvt_pk_bf16_f32 v184, v168, v169 clamp
    v_mul_f32_dpp v166, v70, v38 row_newbcast:12 row_mask:0xf bank_mask:0xf
    v_mfma_f32_16x16x32_bf16 v[176:179], a[32:35], v[128:131], v[8:11]
    v_mul_f32_dpp v167, v71, v39 row_newbcast:12 row_mask:0xf bank_mask:0xf
    v_cvt_pk_bf16_f32 v185, v170, v171 clamp
    v_mfma_f32_16x16x32_bf16 v[176:179], a[36:39], v[132:135], v[176:179]
    v_cvt_pk_bf16_f32 v147, v166, v167
    v_mul_f32_dpp v160, v72, v40 row_newbcast:12 row_mask:0xf bank_mask:0xf
    v_mfma_f32_16x16x32_bf16 v[176:179], a[40:43], v[136:139], v[176:179]
    v_mul_f32_dpp v161, v73, v41 row_newbcast:12 row_mask:0xf bank_mask:0xf
    v_cvt_pk_bf16_f32 v148, v160, v161
    v_mfma_f32_16x16x32_bf16 v[176:179], a[44:47], v[140:143], v[176:179]
    v_mul_f32_dpp v162, v74, v42 row_newbcast:12 row_mask:0xf bank_mask:0xf
    v_cvt_pk_bf16_f32 v186, v172, v173 clamp
    v_mfma_f32_16x16x32_bf16 v[180:183], a[60:63], v[140:143], v[12:15]
    v_mul_f32_dpp v163, v75, v43 row_newbcast:12 row_mask:0xf bank_mask:0xf
    v_cvt_pk_bf16_f32 v187, v174, v175 clamp
    v_mfma_f32_16x16x32_bf16 v[180:183], a[56:59], v[136:139], v[180:183]
    v_cvt_pk_bf16_f32 v149, v162, v163
    v_mul_f32_dpp v164, v76, v44 row_newbcast:12 row_mask:0xf bank_mask:0xf
    v_mfma_f32_16x16x32_bf16 v[180:183], a[52:55], v[132:135], v[180:183]
    v_mul_f32_dpp v165, v77, v45 row_newbcast:12 row_mask:0xf bank_mask:0xf
    v_cvt_pk_bf16_f32 v150, v164, v165
    v_mfma_f32_16x16x32_bf16 v[180:183], a[48:51], v[128:131], v[180:183]
    v_mul_f32_dpp v166, v78, v46 row_newbcast:12 row_mask:0xf bank_mask:0xf
    v_cvt_pk_bf16_f32 v188, v176, v177 clamp
    v_mfma_f32_16x16x32_bf16 v[168:171], a[64:67], v[128:131], v[16:19]
    v_mul_f32_dpp v167, v79, v47 row_newbcast:12 row_mask:0xf bank_mask:0xf
    v_cvt_pk_bf16_f32 v189, v178, v179 clamp
    v_mfma_f32_16x16x32_bf16 v[168:171], a[68:71], v[132:135], v[168:171]
    v_cvt_pk_bf16_f32 v151, v166, v167
    v_mul_f32_dpp v160, v80, v48 row_newbcast:12 row_mask:0xf bank_mask:0xf
    v_mfma_f32_16x16x32_bf16 v[168:171], a[72:75], v[136:139], v[168:171]
    v_mul_f32_dpp v161, v81, v49 row_newbcast:12 row_mask:0xf bank_mask:0xf
    v_cvt_pk_bf16_f32 v152, v160, v161
    v_mfma_f32_16x16x32_bf16 v[168:171], a[76:79], v[140:143], v[168:171]
    v_mul_f32_dpp v162, v82, v50 row_newbcast:12 row_mask:0xf bank_mask:0xf
    v_cvt_pk_bf16_f32 v190, v180, v181 clamp
    v_mfma_f32_16x16x32_bf16 v[172:175], a[92:95], v[140:143], v[20:23]
    v_mul_f32_dpp v163, v83, v51 row_newbcast:12 row_mask:0xf bank_mask:0xf
    v_cvt_pk_bf16_f32 v191, v182, v183 clamp
    v_mfma_f32_16x16x32_bf16 v[172:175], a[88:91], v[136:139], v[172:175]
    v_cvt_pk_bf16_f32 v153, v162, v163
    v_mul_f32_dpp v164, v84, v52 row_newbcast:12 row_mask:0xf bank_mask:0xf
    v_mfma_f32_16x16x32_bf16 v[172:175], a[84:87], v[132:135], v[172:175]
    v_mul_f32_dpp v165, v85, v53 row_newbcast:12 row_mask:0xf bank_mask:0xf
    v_cvt_pk_bf16_f32 v154, v164, v165
    v_mfma_f32_16x16x32_bf16 v[172:175], a[80:83], v[128:131], v[172:175]
    v_mul_f32_dpp v166, v86, v54 row_newbcast:12 row_mask:0xf bank_mask:0xf
    v_mul_f32_dpp v167, v87, v55 row_newbcast:12 row_mask:0xf bank_mask:0xf
    v_smfmac_f32_16x16x64_bf16 v[200:203], a[140:143], v[192:199], v233
    v_cvt_pk_bf16_f32 v192, v168, v169 clamp
    v_smfmac_f32_16x16x64_bf16 v[200:203], a[144:147], v[184:191], v233
    v_cvt_pk_bf16_f32 v193, v170, v171 clamp
    v_mfma_f32_16x16x32_bf16 v[176:179], a[96:99], v[128:131], v[24:27]
    v_cvt_pk_bf16_f32 v155, v166, v167
    v_mul_f32_dpp v160, v88, v56 row_newbcast:12 row_mask:0xf bank_mask:0xf
    v_mfma_f32_16x16x32_bf16 v[176:179], a[100:103], v[132:135], v[176:179]
    v_mul_f32_dpp v161, v89, v57 row_newbcast:12 row_mask:0xf bank_mask:0xf
    v_cvt_pk_bf16_f32 v156, v160, v161
    v_mfma_f32_16x16x32_bf16 v[176:179], a[104:107], v[136:139], v[176:179]
    v_mul_f32_dpp v162, v90, v58 row_newbcast:12 row_mask:0xf bank_mask:0xf
    v_cvt_pk_bf16_f32 v194, v172, v173 clamp
    v_mfma_f32_16x16x32_bf16 v[176:179], a[108:111], v[140:143], v[176:179]
    v_mul_f32_dpp v163, v91, v59 row_newbcast:12 row_mask:0xf bank_mask:0xf
    v_cvt_pk_bf16_f32 v195, v174, v175 clamp
    v_mfma_f32_16x16x32_bf16 v[180:183], a[124:127], v[140:143], v[28:31]
    v_cvt_pk_bf16_f32 v157, v162, v163
    v_mul_f32_dpp v164, v92, v60 row_newbcast:12 row_mask:0xf bank_mask:0xf
    v_mfma_f32_16x16x32_bf16 v[180:183], a[120:123], v[136:139], v[180:183]
    v_mul_f32_dpp v165, v93, v61 row_newbcast:12 row_mask:0xf bank_mask:0xf
    v_cvt_pk_bf16_f32 v158, v164, v165
    v_mfma_f32_16x16x32_bf16 v[180:183], a[116:119], v[132:135], v[180:183]
    v_mul_f32_dpp v166, v94, v62 row_newbcast:12 row_mask:0xf bank_mask:0xf
    v_mul_f32_dpp v167, v95, v63 row_newbcast:12 row_mask:0xf bank_mask:0xf
    v_mfma_f32_16x16x32_bf16 v[180:183], a[112:115], v[128:131], v[180:183]
    v_cvt_pk_bf16_f32 v159, v166, v167
    v_cvt_pk_bf16_f32 v196, v176, v177 clamp
    v_mfma_f32_16x16x32_bf16 v[168:171], a[0:3], v[144:147], v[0:3]
    v_cvt_pk_bf16_f32 v197, v178, v179 clamp
    v_mul_f32_dpp v160, v64, v32 row_newbcast:1 row_mask:0xf bank_mask:0xf
    v_mfma_f32_16x16x32_bf16 v[168:171], a[4:7], v[148:151], v[168:171]
    v_mul_f32_dpp v161, v65, v33 row_newbcast:1 row_mask:0xf bank_mask:0xf
    v_cvt_pk_bf16_f32 v128, v160, v161
    v_mfma_f32_16x16x32_bf16 v[168:171], a[8:11], v[152:155], v[168:171]
    v_cvt_pk_bf16_f32 v198, v180, v181 clamp
    v_mul_f32_dpp v162, v66, v34 row_newbcast:1 row_mask:0xf bank_mask:0xf
    v_mfma_f32_16x16x32_bf16 v[168:171], a[12:15], v[156:159], v[168:171]
    v_mul_f32_dpp v163, v67, v35 row_newbcast:1 row_mask:0xf bank_mask:0xf
    v_cvt_pk_bf16_f32 v199, v182, v183 clamp
    v_mfma_f32_16x16x32_bf16 v[172:175], a[28:31], v[156:159], v[4:7]
    v_cvt_pk_bf16_f32 v129, v162, v163
    v_mul_f32_dpp v164, v68, v36 row_newbcast:1 row_mask:0xf bank_mask:0xf
    v_mfma_f32_16x16x32_bf16 v[172:175], a[24:27], v[152:155], v[172:175]
    v_mul_f32_dpp v165, v69, v37 row_newbcast:1 row_mask:0xf bank_mask:0xf
    v_cvt_pk_bf16_f32 v130, v164, v165
    v_mfma_f32_16x16x32_bf16 v[172:175], a[20:23], v[148:151], v[172:175]
    v_cvt_pk_bf16_f32 v184, v168, v169 clamp
    v_mul_f32_dpp v166, v70, v38 row_newbcast:1 row_mask:0xf bank_mask:0xf
    v_mfma_f32_16x16x32_bf16 v[172:175], a[16:19], v[144:147], v[172:175]
    v_mul_f32_dpp v167, v71, v39 row_newbcast:1 row_mask:0xf bank_mask:0xf
    v_cvt_pk_bf16_f32 v185, v170, v171 clamp
    v_mfma_f32_16x16x32_bf16 v[176:179], a[32:35], v[144:147], v[8:11]
    v_cvt_pk_bf16_f32 v131, v166, v167
    v_mul_f32_dpp v160, v72, v40 row_newbcast:1 row_mask:0xf bank_mask:0xf
    v_mfma_f32_16x16x32_bf16 v[176:179], a[36:39], v[148:151], v[176:179]
    v_mul_f32_dpp v161, v73, v41 row_newbcast:1 row_mask:0xf bank_mask:0xf
    v_cvt_pk_bf16_f32 v132, v160, v161
    v_mfma_f32_16x16x32_bf16 v[176:179], a[40:43], v[152:155], v[176:179]
    v_mul_f32_dpp v162, v74, v42 row_newbcast:1 row_mask:0xf bank_mask:0xf
    v_cvt_pk_bf16_f32 v186, v172, v173 clamp
    v_mfma_f32_16x16x32_bf16 v[176:179], a[44:47], v[156:159], v[176:179]
    v_mul_f32_dpp v163, v75, v43 row_newbcast:1 row_mask:0xf bank_mask:0xf
    v_cvt_pk_bf16_f32 v187, v174, v175 clamp
    v_mfma_f32_16x16x32_bf16 v[180:183], a[60:63], v[156:159], v[12:15]
    v_cvt_pk_bf16_f32 v133, v162, v163
    v_mul_f32_dpp v164, v76, v44 row_newbcast:1 row_mask:0xf bank_mask:0xf
    v_mfma_f32_16x16x32_bf16 v[180:183], a[56:59], v[152:155], v[180:183]
    v_mul_f32_dpp v165, v77, v45 row_newbcast:1 row_mask:0xf bank_mask:0xf
    v_cvt_pk_bf16_f32 v134, v164, v165
    v_mfma_f32_16x16x32_bf16 v[180:183], a[52:55], v[148:151], v[180:183]
    v_mul_f32_dpp v166, v78, v46 row_newbcast:1 row_mask:0xf bank_mask:0xf
    v_cvt_pk_bf16_f32 v188, v176, v177 clamp
    v_mfma_f32_16x16x32_bf16 v[180:183], a[48:51], v[144:147], v[180:183]
    v_mul_f32_dpp v167, v79, v47 row_newbcast:1 row_mask:0xf bank_mask:0xf
    v_cvt_pk_bf16_f32 v189, v178, v179 clamp
    v_mfma_f32_16x16x32_bf16 v[168:171], a[64:67], v[144:147], v[16:19]
    v_cvt_pk_bf16_f32 v135, v166, v167
    v_mul_f32_dpp v160, v80, v48 row_newbcast:1 row_mask:0xf bank_mask:0xf
    v_mfma_f32_16x16x32_bf16 v[168:171], a[68:71], v[148:151], v[168:171]
    v_mul_f32_dpp v161, v81, v49 row_newbcast:1 row_mask:0xf bank_mask:0xf
    v_cvt_pk_bf16_f32 v136, v160, v161
    v_mfma_f32_16x16x32_bf16 v[168:171], a[72:75], v[152:155], v[168:171]
    v_mul_f32_dpp v162, v82, v50 row_newbcast:1 row_mask:0xf bank_mask:0xf
    v_cvt_pk_bf16_f32 v190, v180, v181 clamp
    v_mfma_f32_16x16x32_bf16 v[168:171], a[76:79], v[156:159], v[168:171]
    v_mul_f32_dpp v163, v83, v51 row_newbcast:1 row_mask:0xf bank_mask:0xf
    v_cvt_pk_bf16_f32 v191, v182, v183 clamp
    v_mfma_f32_16x16x32_bf16 v[172:175], a[92:95], v[156:159], v[20:23]
    v_cvt_pk_bf16_f32 v137, v162, v163
    v_mul_f32_dpp v164, v84, v52 row_newbcast:1 row_mask:0xf bank_mask:0xf
    v_mfma_f32_16x16x32_bf16 v[172:175], a[88:91], v[152:155], v[172:175]
    v_mul_f32_dpp v165, v85, v53 row_newbcast:1 row_mask:0xf bank_mask:0xf
    v_cvt_pk_bf16_f32 v138, v164, v165
    v_mfma_f32_16x16x32_bf16 v[172:175], a[84:87], v[148:151], v[172:175]
    v_mul_f32_dpp v166, v86, v54 row_newbcast:1 row_mask:0xf bank_mask:0xf
    v_mul_f32_dpp v167, v87, v55 row_newbcast:1 row_mask:0xf bank_mask:0xf
    v_mfma_f32_16x16x32_bf16 v[172:175], a[80:83], v[144:147], v[172:175]
    v_cvt_pk_bf16_f32 v139, v166, v167
    v_mul_f32_dpp v160, v88, v56 row_newbcast:1 row_mask:0xf bank_mask:0xf
    v_smfmac_f32_16x16x64_bf16 v[200:203], a[148:151], v[192:199], v233
    v_cvt_pk_bf16_f32 v192, v168, v169 clamp
    v_smfmac_f32_16x16x64_bf16 v[200:203], a[152:155], v[184:191], v233
    v_cvt_pk_bf16_f32 v193, v170, v171 clamp
    v_mfma_f32_16x16x32_bf16 v[176:179], a[96:99], v[144:147], v[24:27]
    v_mul_f32_dpp v161, v89, v57 row_newbcast:1 row_mask:0xf bank_mask:0xf
    v_cvt_pk_bf16_f32 v140, v160, v161
    v_mfma_f32_16x16x32_bf16 v[176:179], a[100:103], v[148:151], v[176:179]
    v_mul_f32_dpp v162, v90, v58 row_newbcast:1 row_mask:0xf bank_mask:0xf
    v_cvt_pk_bf16_f32 v194, v172, v173 clamp
    v_mfma_f32_16x16x32_bf16 v[176:179], a[104:107], v[152:155], v[176:179]
    v_mul_f32_dpp v163, v91, v59 row_newbcast:1 row_mask:0xf bank_mask:0xf
    v_cvt_pk_bf16_f32 v195, v174, v175 clamp
    v_mfma_f32_16x16x32_bf16 v[176:179], a[108:111], v[156:159], v[176:179]
    v_cvt_pk_bf16_f32 v141, v162, v163
    v_mul_f32_dpp v164, v92, v60 row_newbcast:1 row_mask:0xf bank_mask:0xf
    v_mfma_f32_16x16x32_bf16 v[180:183], a[124:127], v[156:159], v[28:31]
    v_mul_f32_dpp v165, v93, v61 row_newbcast:1 row_mask:0xf bank_mask:0xf
    v_cvt_pk_bf16_f32 v142, v164, v165
    v_mfma_f32_16x16x32_bf16 v[180:183], a[120:123], v[152:155], v[180:183]
    v_mul_f32_dpp v166, v94, v62 row_newbcast:1 row_mask:0xf bank_mask:0xf
    v_mul_f32_dpp v167, v95, v63 row_newbcast:1 row_mask:0xf bank_mask:0xf
    v_mfma_f32_16x16x32_bf16 v[180:183], a[116:119], v[148:151], v[180:183]
    v_cvt_pk_bf16_f32 v143, v166, v167
    v_cvt_pk_bf16_f32 v196, v176, v177 clamp
    v_mfma_f32_16x16x32_bf16 v[180:183], a[112:115], v[144:147], v[180:183]
    v_cvt_pk_bf16_f32 v197, v178, v179 clamp
    v_mul_f32_dpp v160, v64, v32 row_newbcast:5 row_mask:0xf bank_mask:0xf
    v_mfma_f32_16x16x32_bf16 v[168:171], a[0:3], v[128:131], v[0:3]
    v_mul_f32_dpp v161, v65, v33 row_newbcast:5 row_mask:0xf bank_mask:0xf
    v_cvt_pk_bf16_f32 v144, v160, v161
    v_mfma_f32_16x16x32_bf16 v[168:171], a[4:7], v[132:135], v[168:171]
    v_mul_f32_dpp v162, v66, v34 row_newbcast:5 row_mask:0xf bank_mask:0xf
    v_mul_f32_dpp v163, v67, v35 row_newbcast:5 row_mask:0xf bank_mask:0xf
    v_mfma_f32_16x16x32_bf16 v[168:171], a[8:11], v[136:139], v[168:171]
    v_cvt_pk_bf16_f32 v198, v180, v181 clamp
    v_cvt_pk_bf16_f32 v199, v182, v183 clamp
    v_mfma_f32_16x16x32_bf16 v[168:171], a[12:15], v[140:143], v[168:171]
    v_cvt_pk_bf16_f32 v145, v162, v163
    v_mul_f32_dpp v164, v68, v36 row_newbcast:5 row_mask:0xf bank_mask:0xf
    v_mfma_f32_16x16x32_bf16 v[172:175], a[28:31], v[140:143], v[4:7]
    v_mul_f32_dpp v165, v69, v37 row_newbcast:5 row_mask:0xf bank_mask:0xf
    v_cvt_pk_bf16_f32 v146, v164, v165
    v_mfma_f32_16x16x32_bf16 v[172:175], a[24:27], v[136:139], v[172:175]
    v_mul_f32_dpp v166, v70, v38 row_newbcast:5 row_mask:0xf bank_mask:0xf
    v_mul_f32_dpp v167, v71, v39 row_newbcast:5 row_mask:0xf bank_mask:0xf
    v_mfma_f32_16x16x32_bf16 v[172:175], a[20:23], v[132:135], v[172:175]
    v_cvt_pk_bf16_f32 v184, v168, v169 clamp
    v_cvt_pk_bf16_f32 v185, v170, v171 clamp
    v_mfma_f32_16x16x32_bf16 v[172:175], a[16:19], v[128:131], v[172:175]
    v_cvt_pk_bf16_f32 v147, v166, v167
    v_mul_f32_dpp v160, v72, v40 row_newbcast:5 row_mask:0xf bank_mask:0xf
    v_mfma_f32_16x16x32_bf16 v[176:179], a[32:35], v[128:131], v[8:11]
    v_mul_f32_dpp v161, v73, v41 row_newbcast:5 row_mask:0xf bank_mask:0xf
    v_cvt_pk_bf16_f32 v148, v160, v161
    v_mfma_f32_16x16x32_bf16 v[176:179], a[36:39], v[132:135], v[176:179]
    v_mul_f32_dpp v162, v74, v42 row_newbcast:5 row_mask:0xf bank_mask:0xf
    v_mul_f32_dpp v163, v75, v43 row_newbcast:5 row_mask:0xf bank_mask:0xf
    v_mfma_f32_16x16x32_bf16 v[176:179], a[40:43], v[136:139], v[176:179]
    v_cvt_pk_bf16_f32 v186, v172, v173 clamp
    v_mov_b32 v204, 0
    v_mfma_f32_16x16x32_bf16 v[176:179], a[44:47], v[140:143], v[176:179]
    v_cvt_pk_bf16_f32 v187, v174, v175 clamp
    v_cvt_pk_bf16_f32 v149, v162, v163
    v_mfma_f32_16x16x32_bf16 v[180:183], a[60:63], v[140:143], v[12:15]
    v_mul_f32_dpp v164, v76, v44 row_newbcast:5 row_mask:0xf bank_mask:0xf
    v_mul_f32_dpp v165, v77, v45 row_newbcast:5 row_mask:0xf bank_mask:0xf
    v_mfma_f32_16x16x32_bf16 v[180:183], a[56:59], v[136:139], v[180:183]
    v_mov_b32 v205, 0
    v_cvt_pk_bf16_f32 v150, v164, v165
    v_mfma_f32_16x16x32_bf16 v[180:183], a[52:55], v[132:135], v[180:183]
    v_mul_f32_dpp v166, v78, v46 row_newbcast:5 row_mask:0xf bank_mask:0xf
    v_cvt_pk_bf16_f32 v188, v176, v177 clamp
    v_mfma_f32_16x16x32_bf16 v[180:183], a[48:51], v[128:131], v[180:183]
    v_mul_f32_dpp v167, v79, v47 row_newbcast:5 row_mask:0xf bank_mask:0xf
    v_cvt_pk_bf16_f32 v189, v178, v179 clamp
    v_mfma_f32_16x16x32_bf16 v[168:171], a[64:67], v[128:131], v[16:19]
    v_cvt_pk_bf16_f32 v151, v166, v167
    v_mul_f32_dpp v160, v80, v48 row_newbcast:5 row_mask:0xf bank_mask:0xf
    v_mfma_f32_16x16x32_bf16 v[168:171], a[68:71], v[132:135], v[168:171]
    v_mul_f32_dpp v161, v81, v49 row_newbcast:5 row_mask:0xf bank_mask:0xf
    v_cvt_pk_bf16_f32 v152, v160, v161
    v_mfma_f32_16x16x32_bf16 v[168:171], a[72:75], v[136:139], v[168:171]
    v_mul_f32_dpp v162, v82, v50 row_newbcast:5 row_mask:0xf bank_mask:0xf
    v_cvt_pk_bf16_f32 v190, v180, v181 clamp
    v_mfma_f32_16x16x32_bf16 v[168:171], a[76:79], v[140:143], v[168:171]
    v_mul_f32_dpp v163, v83, v51 row_newbcast:5 row_mask:0xf bank_mask:0xf
    v_cvt_pk_bf16_f32 v191, v182, v183 clamp
    v_mfma_f32_16x16x32_bf16 v[172:175], a[92:95], v[140:143], v[20:23]
    v_cvt_pk_bf16_f32 v153, v162, v163
    v_mul_f32_dpp v164, v84, v52 row_newbcast:5 row_mask:0xf bank_mask:0xf
    v_mfma_f32_16x16x32_bf16 v[172:175], a[88:91], v[136:139], v[172:175]
    v_mul_f32_dpp v165, v85, v53 row_newbcast:5 row_mask:0xf bank_mask:0xf
    v_cvt_pk_bf16_f32 v154, v164, v165
    v_mfma_f32_16x16x32_bf16 v[172:175], a[84:87], v[132:135], v[172:175]
    v_mul_f32_dpp v166, v86, v54 row_newbcast:5 row_mask:0xf bank_mask:0xf
    v_mul_f32_dpp v167, v87, v55 row_newbcast:5 row_mask:0xf bank_mask:0xf
    v_mfma_f32_16x16x32_bf16 v[172:175], a[80:83], v[128:131], v[172:175]
    v_cvt_pk_bf16_f32 v155, v166, v167
    v_mul_f32_dpp v160, v88, v56 row_newbcast:5 row_mask:0xf bank_mask:0xf
    v_smfmac_f32_16x16x64_bf16 v[200:203], a[156:159], v[192:199], v233
    v_cvt_pk_bf16_f32 v192, v168, v169 clamp
    v_smfmac_f32_16x16x64_bf16 v[204:207], a[128:131], v[184:191], v233
    v_cvt_pk_bf16_f32 v193, v170, v171 clamp
    v_mfma_f32_16x16x32_bf16 v[176:179], a[96:99], v[128:131], v[24:27]
    v_mul_f32_dpp v161, v89, v57 row_newbcast:5 row_mask:0xf bank_mask:0xf
    v_cvt_pk_bf16_f32 v156, v160, v161
    v_mfma_f32_16x16x32_bf16 v[176:179], a[100:103], v[132:135], v[176:179]
    v_mul_f32_dpp v162, v90, v58 row_newbcast:5 row_mask:0xf bank_mask:0xf
    v_cvt_pk_bf16_f32 v194, v172, v173 clamp
    v_mfma_f32_16x16x32_bf16 v[176:179], a[104:107], v[136:139], v[176:179]
    v_mul_f32_dpp v163, v91, v59 row_newbcast:5 row_mask:0xf bank_mask:0xf
    v_cvt_pk_bf16_f32 v195, v174, v175 clamp
    v_mfma_f32_16x16x32_bf16 v[176:179], a[108:111], v[140:143], v[176:179]
    v_cvt_pk_bf16_f32 v157, v162, v163
    v_mul_f32_dpp v164, v92, v60 row_newbcast:5 row_mask:0xf bank_mask:0xf
    v_mfma_f32_16x16x32_bf16 v[180:183], a[124:127], v[140:143], v[28:31]
    v_mul_f32_dpp v165, v93, v61 row_newbcast:5 row_mask:0xf bank_mask:0xf
    v_add_f32 v229, v200, v201
    v_mfma_f32_16x16x32_bf16 v[180:183], a[120:123], v[136:139], v[180:183]
    v_cvt_pk_bf16_f32 v158, v164, v165
    v_mul_f32_dpp v166, v94, v62 row_newbcast:5 row_mask:0xf bank_mask:0xf
    v_mfma_f32_16x16x32_bf16 v[180:183], a[116:119], v[132:135], v[180:183]
    v_mul_f32_dpp v167, v95, v63 row_newbcast:5 row_mask:0xf bank_mask:0xf
    v_cvt_pk_bf16_f32 v159, v166, v167
    v_mfma_f32_16x16x32_bf16 v[180:183], a[112:115], v[128:131], v[180:183]
    v_cvt_pk_bf16_f32 v196, v176, v177 clamp
    v_cvt_pk_bf16_f32 v197, v178, v179 clamp
    v_mfma_f32_16x16x32_bf16 v[168:171], a[0:3], v[144:147], v[0:3]
    v_mul_f32_dpp v160, v64, v32 row_newbcast:9 row_mask:0xf bank_mask:0xf
    v_mul_f32_dpp v161, v65, v33 row_newbcast:9 row_mask:0xf bank_mask:0xf
    v_mfma_f32_16x16x32_bf16 v[168:171], a[4:7], v[148:151], v[168:171]
    v_cvt_pk_bf16_f32 v128, v160, v161
    v_mul_f32_dpp v162, v66, v34 row_newbcast:9 row_mask:0xf bank_mask:0xf
    v_mfma_f32_16x16x32_bf16 v[168:171], a[8:11], v[152:155], v[168:171]
    v_cvt_pk_bf16_f32 v198, v180, v181 clamp
    v_mul_f32_dpp v163, v67, v35 row_newbcast:9 row_mask:0xf bank_mask:0xf
    v_mfma_f32_16x16x32_bf16 v[168:171], a[12:15], v[156:159], v[168:171]
    v_cvt_pk_bf16_f32 v199, v182, v183 clamp
    v_cvt_pk_bf16_f32 v129, v162, v163
    v_mfma_f32_16x16x32_bf16 v[172:175], a[28:31], v[156:159], v[4:7]
    v_mul_f32_dpp v164, v68, v36 row_newbcast:9 row_mask:0xf bank_mask:0xf
    v_mul_f32_dpp v165, v69, v37 row_newbcast:9 row_mask:0xf bank_mask:0xf
    v_mfma_f32_16x16x32_bf16 v[172:175], a[24:27], v[152:155], v[172:175]
    v_cvt_pk_bf16_f32 v130, v164, v165
    v_mul_f32_dpp v166, v70, v38 row_newbcast:9 row_mask:0xf bank_mask:0xf
    v_mfma_f32_16x16x32_bf16 v[172:175], a[20:23], v[148:151], v[172:175]
    v_cvt_pk_bf16_f32 v184, v168, v169 clamp
    v_mul_f32_dpp v167, v71, v39 row_newbcast:9 row_mask:0xf bank_mask:0xf
    v_mfma_f32_16x16x32_bf16 v[172:175], a[16:19], v[144:147], v[172:175]
    v_cvt_pk_bf16_f32 v185, v170, v171 clamp
    v_cvt_pk_bf16_f32 v131, v166, v167
    v_mfma_f32_16x16x32_bf16 v[176:179], a[32:35], v[144:147], v[8:11]
    v_mul_f32_dpp v160, v72, v40 row_newbcast:9 row_mask:0xf bank_mask:0xf
    v_mul_f32_dpp v161, v73, v41 row_newbcast:9 row_mask:0xf bank_mask:0xf
    v_mfma_f32_16x16x32_bf16 v[176:179], a[36:39], v[148:151], v[176:179]
    v_cvt_pk_bf16_f32 v132, v160, v161
    v_mul_f32_dpp v162, v74, v42 row_newbcast:9 row_mask:0xf bank_mask:0xf
    v_mfma_f32_16x16x32_bf16 v[176:179], a[40:43], v[152:155], v[176:179]
    v_cvt_pk_bf16_f32 v186, v172, v173 clamp
    v_mul_f32_dpp v163, v75, v43 row_newbcast:9 row_mask:0xf bank_mask:0xf
    v_mfma_f32_16x16x32_bf16 v[176:179], a[44:47], v[156:159], v[176:179]
    v_cvt_pk_bf16_f32 v187, v174, v175 clamp
    v_cvt_pk_bf16_f32 v133, v162, v163
    v_mfma_f32_16x16x32_bf16 v[180:183], a[60:63], v[156:159], v[12:15]
    v_mul_f32_dpp v164, v76, v44 row_newbcast:9 row_mask:0xf bank_mask:0xf
    v_mul_f32_dpp v165, v77, v45 row_newbcast:9 row_mask:0xf bank_mask:0xf
    v_mfma_f32_16x16x32_bf16 v[180:183], a[56:59], v[152:155], v[180:183]
    v_cvt_pk_bf16_f32 v134, v164, v165
    v_mul_f32_dpp v166, v78, v46 row_newbcast:9 row_mask:0xf bank_mask:0xf
    v_mfma_f32_16x16x32_bf16 v[180:183], a[52:55], v[148:151], v[180:183]
    v_cvt_pk_bf16_f32 v188, v176, v177 clamp
    v_mul_f32_dpp v167, v79, v47 row_newbcast:9 row_mask:0xf bank_mask:0xf
    v_mfma_f32_16x16x32_bf16 v[180:183], a[48:51], v[144:147], v[180:183]
    v_cvt_pk_bf16_f32 v189, v178, v179 clamp
    v_cvt_pk_bf16_f32 v135, v166, v167
    v_mfma_f32_16x16x32_bf16 v[168:171], a[64:67], v[144:147], v[16:19]
    v_mul_f32_dpp v160, v80, v48 row_newbcast:9 row_mask:0xf bank_mask:0xf
    v_mul_f32_dpp v161, v81, v49 row_newbcast:9 row_mask:0xf bank_mask:0xf
    v_mfma_f32_16x16x32_bf16 v[168:171], a[68:71], v[148:151], v[168:171]
    v_cvt_pk_bf16_f32 v136, v160, v161
    v_mul_f32_dpp v162, v82, v50 row_newbcast:9 row_mask:0xf bank_mask:0xf
    v_mfma_f32_16x16x32_bf16 v[168:171], a[72:75], v[152:155], v[168:171]
    v_cvt_pk_bf16_f32 v190, v180, v181 clamp
    v_mul_f32_dpp v163, v83, v51 row_newbcast:9 row_mask:0xf bank_mask:0xf
    v_mfma_f32_16x16x32_bf16 v[168:171], a[76:79], v[156:159], v[168:171]
    v_cvt_pk_bf16_f32 v191, v182, v183 clamp
    v_cvt_pk_bf16_f32 v137, v162, v163
L_pad8:
    s_cbranch_vccnz L_resume
    v_mfma_f32_16x16x32_bf16 v[172:175], a[92:95], v[156:159], v[20:23]
    v_mul_f32_dpp v164, v84, v52 row_newbcast:9 row_mask:0xf bank_mask:0xf
    v_mul_f32_dpp v165, v85, v53 row_newbcast:9 row_mask:0xf bank_mask:0xf
    v_mfma_f32_16x16x32_bf16 v[172:175], a[88:91], v[152:155], v[172:175]
    v_cvt_pk_bf16_f32 v138, v164, v165
    v_mul_f32_dpp v166, v86, v54 row_newbcast:9 row_mask:0xf bank_mask:0xf
    v_mfma_f32_16x16x32_bf16 v[172:175], a[84:87], v[148:151], v[172:175]
    v_mul_f32_dpp v167, v87, v55 row_newbcast:9 row_mask:0xf bank_mask:0xf
    v_cvt_pk_bf16_f32 v139, v166, v167
    v_mfma_f32_16x16x32_bf16 v[172:175], a[80:83], v[144:147], v[172:175]
    v_mul_f32_dpp v160, v88, v56 row_newbcast:9 row_mask:0xf bank_mask:0xf
    v_mul_f32_dpp v161, v89, v57 row_newbcast:9 row_mask:0xf bank_mask:0xf
    v_smfmac_f32_16x16x64_bf16 v[204:207], a[132:135], v[192:199], v233
    v_cvt_pk_bf16_f32 v192, v168, v169 clamp
    v_smfmac_f32_16x16x64_bf16 v[204:207], a[136:139], v[184:191], v233
    v_cvt_pk_bf16_f32 v193, v170, v171 clamp
    v_mfma_f32_16x16x32_bf16 v[176:179], a[96:99], v[144:147], v[24:27]
    v_cvt_pk_bf16_f32 v140, v160, v161
    v_mul_f32_dpp v162, v90, v58 row_newbcast:9 row_mask:0xf bank_mask:0xf
    v_mfma_f32_16x16x32_bf16 v[176:179], a[100:103], v[148:151], v[176:179]
    v_cvt_pk_bf16_f32 v194, v172, v173 clamp
    v_mul_f32_dpp v163, v91, v59 row_newbcast:9 row_mask:0xf bank_mask:0xf
    v_mfma_f32_16x16x32_bf16 v[176:179], a[104:107], v[152:155], v[176:179]
    v_cvt_pk_bf16_f32 v195, v174, v175 clamp
    v_cvt_pk_bf16_f32 v141, v162, v163
    v_mfma_f32_16x16x32_bf16 v[176:179], a[108:111], v[156:159], v[176:179]
    v_mul_f32_dpp v164, v92, v60 row_newbcast:9 row_mask:0xf bank_mask:0xf
    v_mul_f32_dpp v165, v93, v61 row_newbcast:9 row_mask:0xf bank_mask:0xf
    v_mfma_f32_16x16x32_bf16 v[180:183], a[124:127], v[156:159], v[28:31]
    v_cvt_pk_bf16_f32 v142, v164, v165
    v_mul_f32_dpp v166, v94, v62 row_newbcast:9 row_mask:0xf bank_mask:0xf
    v_mfma_f32_16x16x32_bf16 v[180:183], a[120:123], v[152:155], v[180:183]
    v_mul_f32_dpp v167, v95, v63 row_newbcast:9 row_mask:0xf bank_mask:0xf
    v_cvt_pk_bf16_f32 v143, v166, v167
    v_mfma_f32_16x16x32_bf16 v[180:183], a[116:119], v[148:151], v[180:183]
    v_cvt_pk_bf16_f32 v196, v176, v177 clamp
    v_cvt_pk_bf16_f32 v197, v178, v179 clamp
    v_mfma_f32_16x16x32_bf16 v[180:183], a[112:115], v[144:147], v[180:183]
    v_mul_f32_dpp v160, v64, v32 row_newbcast:13 row_mask:0xf bank_mask:0xf
    v_mul_f32_dpp v161, v65, v33 row_newbcast:13 row_mask:0xf bank_mask:0xf
    s_cbranch_scc0 L_tail
    v_mfma_f32_16x16x32_bf16 v[168:171], a[0:3], v[128:131], v[0:3]
    v_cvt_pk_bf16_f32 v144, v160, v161
    v_mul_f32_dpp v162, v66, v34 row_newbcast:13 row_mask:0xf bank_mask:0xf
    v_mfma_f32_16x16x32_bf16 v[168:171], a[4:7], v[132:135], v[168:171]
    v_mul_f32_dpp v163, v67, v35 row_newbcast:13 row_mask:0xf bank_mask:0xf
    v_cvt_pk_bf16_f32 v145, v162, v163
    v_mfma_f32_16x16x32_bf16 v[168:171], a[8:11], v[136:139], v[168:171]
    v_cvt_pk_bf16_f32 v198, v180, v181 clamp
    v_cvt_pk_bf16_f32 v199, v182, v183 clamp
    v_mfma_f32_16x16x32_bf16 v[168:171], a[12:15], v[140:143], v[168:171]
    v_mul_f32_dpp v164, v68, v36 row_newbcast:13 row_mask:0xf bank_mask:0xf
    v_mul_f32_dpp v165, v69, v37 row_newbcast:13 row_mask:0xf bank_mask:0xf
    v_mfma_f32_16x16x32_bf16 v[172:175], a[28:31], v[140:143], v[4:7]
    v_cvt_pk_bf16_f32 v146, v164, v165
    v_mul_f32_dpp v166, v70, v38 row_newbcast:13 row_mask:0xf bank_mask:0xf
    v_mfma_f32_16x16x32_bf16 v[172:175], a[24:27], v[136:139], v[172:175]
    v_mul_f32_dpp v167, v71, v39 row_newbcast:13 row_mask:0xf bank_mask:0xf
    v_cvt_pk_bf16_f32 v147, v166, v167
    v_mfma_f32_16x16x32_bf16 v[172:175], a[20:23], v[132:135], v[172:175]
    v_cvt_pk_bf16_f32 v184, v168, v169 clamp
    v_cvt_pk_bf16_f32 v185, v170, v171 clamp
    v_mfma_f32_16x16x32_bf16 v[172:175], a[16:19], v[128:131], v[172:175]
    v_mul_f32_dpp v160, v72, v40 row_newbcast:13 row_mask:0xf bank_mask:0xf
    v_mul_f32_dpp v161, v73, v41 row_newbcast:13 row_mask:0xf bank_mask:0xf
    v_mfma_f32_16x16x32_bf16 v[176:179], a[32:35], v[128:131], v[8:11]
    v_cvt_pk_bf16_f32 v148, v160, v161
    v_mul_f32_dpp v162, v74, v42 row_newbcast:13 row_mask:0xf bank_mask:0xf
    v_mfma_f32_16x16x32_bf16 v[176:179], a[36:39], v[132:135], v[176:179]
    v_mul_f32_dpp v163, v75, v43 row_newbcast:13 row_mask:0xf bank_mask:0xf
    v_cvt_pk_bf16_f32 v149, v162, v163
    v_mfma_f32_16x16x32_bf16 v[176:179], a[40:43], v[136:139], v[176:179]
    v_cvt_pk_bf16_f32 v186, v172, v173 clamp
    v_cvt_pk_bf16_f32 v187, v174, v175 clamp
    v_mfma_f32_16x16x32_bf16 v[176:179], a[44:47], v[140:143], v[176:179]
    v_mul_f32_dpp v164, v76, v44 row_newbcast:13 row_mask:0xf bank_mask:0xf
    v_mul_f32_dpp v165, v77, v45 row_newbcast:13 row_mask:0xf bank_mask:0xf
    v_mfma_f32_16x16x32_bf16 v[180:183], a[60:63], v[140:143], v[12:15]
    v_cvt_pk_bf16_f32 v150, v164, v165
    v_mul_f32_dpp v166, v78, v46 row_newbcast:13 row_mask:0xf bank_mask:0xf
    v_mfma_f32_16x16x32_bf16 v[180:183], a[56:59], v[136:139], v[180:183]
    v_mul_f32_dpp v167, v79, v47 row_newbcast:13 row_mask:0xf bank_mask:0xf
    s_waitcnt vmcnt(0)
    v_mfma_f32_16x16x32_bf16 v[180:183], a[52:55], v[132:135], v[180:183]
    v_cvt_pk_bf16_f32 v188, v176, v177 clamp
    v_cvt_pk_bf16_f32 v189, v178, v179 clamp
    v_mfma_f32_16x16x32_bf16 v[180:183], a[48:51], v[128:131], v[180:183]
    v_cvt_pk_bf16_f32 v151, v166, v167
    v_mul_f32_dpp v160, v80, v48 row_newbcast:13 row_mask:0xf bank_mask:0xf
    v_mfma_f32_16x16x32_bf16 v[168:171], a[64:67], v[128:131], v[16:19]
    v_mul_f32_dpp v161, v81, v49 row_newbcast:13 row_mask:0xf bank_mask:0xf
    v_cvt_pk_bf16_f32 v152, v160, v161
    v_mfma_f32_16x16x32_bf16 v[168:171], a[68:71], v[132:135], v[168:171]
    v_mul_f32_dpp v162, v82, v50 row_newbcast:13 row_mask:0xf bank_mask:0xf
    v_mul_f32_dpp v163, v83, v51 row_newbcast:13 row_mask:0xf bank_mask:0xf
    v_mfma_f32_16x16x32_bf16 v[168:171], a[72:75], v[136:139], v[168:171]
    v_cvt_pk_bf16_f32 v190, v180, v181 clamp
    v_cvt_pk_bf16_f32 v191, v182, v183 clamp
    v_mfma_f32_16x16x32_bf16 v[168:171], a[76:79], v[140:143], v[168:171]
    v_cvt_pk_bf16_f32 v153, v162, v163
    v_mul_f32_dpp v164, v84, v52 row_newbcast:13 row_mask:0xf bank_mask:0xf
    v_mfma_f32_4x4x4_16b_bf16 v[32:35], a[200:201], v[112:113], 0
    v_mul_f32_dpp v165, v85, v53 row_newbcast:13 row_mask:0xf bank_mask:0xf
    v_mfma_f32_4x4x4_16b_bf16 v[36:39], a[200:201], v[114:115], 0
    v_cvt_pk_bf16_f32 v154, v164, v165
    v_mfma_f32_4x4x4_16b_bf16 v[40:43], a[200:201], v[116:117], 0
    v_mul_f32_dpp v166, v86, v54 row_newbcast:13 row_mask:0xf bank_mask:0xf
    v_mfma_f32_4x4x4_16b_bf16 v[44:47], a[200:201], v[118:119], 0
    v_mul_f32_dpp v167, v87, v55 row_newbcast:13 row_mask:0xf bank_mask:0xf
    v_cvt_pk_bf16_f32 v155, v166, v167
    v_mul_f32_dpp v160, v88, v56 row_newbcast:13 row_mask:0xf bank_mask:0xf
    v_mfma_f32_16x16x32_bf16 v[172:175], a[92:95], v[140:143], v[20:23]
    v_mul_f32_dpp v161, v89, v57 row_newbcast:13 row_mask:0xf bank_mask:0xf
    v_cvt_pk_bf16_f32 v156, v160, v161
    v_mfma_f32_16x16x32_bf16 v[172:175], a[88:91], v[136:139], v[172:175]
    v_mul_f32_dpp v162, v90, v58 row_newbcast:13 row_mask:0xf bank_mask:0xf
    v_mul_f32_dpp v163, v91, v59 row_newbcast:13 row_mask:0xf bank_mask:0xf
    v_mfma_f32_16x16x32_bf16 v[172:175], a[84:87], v[132:135], v[172:175]
    v_cvt_pk_bf16_f32 v157, v162, v163
    v_mul_f32_dpp v164, v92, v60 row_newbcast:13 row_mask:0xf bank_mask:0xf
    v_mfma_f32_16x16x32_bf16 v[172:175], a[80:83], v[128:131], v[172:175]
    v_mul_f32_dpp v165, v93, v61 row_newbcast:13 row_mask:0xf bank_mask:0xf
    v_cvt_pk_bf16_f32 v158, v164, v165
    v_smfmac_f32_16x16x64_bf16 v[204:207], a[140:143], v[192:199], v233
    v_cvt_pk_bf16_f32 v192, v168, v169 clamp
    v_smfmac_f32_16x16x64_bf16 v[204:207], a[144:147], v[184:191], v233
    v_cvt_pk_bf16_f32 v193, v170, v171 clamp
    v_mfma_f32_16x16x32_bf16 v[176:179], a[96:99], v[128:131], v[24:27]
    v_mul_f32_dpp v166, v94, v62 row_newbcast:13 row_mask:0xf bank_mask:0xf
    v_cvt_pk_bf16_f32 v194, v172, v173 clamp
    v_mfma_f32_16x16x32_bf16 v[176:179], a[100:103], v[132:135], v[176:179]
    v_cvt_pk_bf16_f32 v195, v174, v175 clamp
    v_mul_f32_dpp v167, v95, v63 row_newbcast:13 row_mask:0xf bank_mask:0xf
    v_mfma_f32_16x16x32_bf16 v[176:179], a[104:107], v[136:139], v[176:179]
    v_cvt_pk_bf16_f32 v159, v166, v167
    v_mul_f32_dpp v160, v32, v32 row_ror:1 row_mask:0xf bank_mask:0xf
    v_mfma_f32_16x16x32_bf16 v[176:179], a[108:111], v[140:143], v[176:179]
    v_mul_f32_dpp v161, v33, v33 row_ror:1 row_mask:0xf bank_mask:0xf
    v_cvt_pk_bf16_f32 v96, v160, v161
    v_mfma_f32_16x16x32_bf16 v[180:183], a[124:127], v[140:143], v[28:31]
    v_mul_f32_dpp v162, v34, v34 row_ror:1 row_mask:0xf bank_mask:0xf
    v_mul_f32_dpp v163, v35, v35 row_ror:1 row_mask:0xf bank_mask:0xf
    v_mfma_f32_16x16x32_bf16 v[180:183], a[120:123], v[136:139], v[180:183]
    v_cvt_pk_bf16_f32 v97, v162, v163
    v_mul_f32_dpp v164, v36, v36 row_ror:1 row_mask:0xf bank_mask:0xf
    v_mfma_f32_16x16x32_bf16 v[180:183], a[116:119], v[132:135], v[180:183]
    v_cvt_pk_bf16_f32 v196, v176, v177 clamp
    v_cvt_pk_bf16_f32 v197, v178, v179 clamp
    v_mfma_f32_16x16x32_bf16 v[180:183], a[112:115], v[128:131], v[180:183]
    v_mul_f32_dpp v165, v37, v37 row_ror:1 row_mask:0xf bank_mask:0xf
    v_cvt_pk_bf16_f32 v98, v164, v165
    v_mfma_f32_16x16x32_bf16 v[168:171], a[0:3], v[144:147], v[0:3]
    v_mul_f32_dpp v166, v38, v38 row_ror:1 row_mask:0xf bank_mask:0xf
    v_mul_f32_dpp v167, v39, v39 row_ror:1 row_mask:0xf bank_mask:0xf
    v_mfma_f32_16x16x32_bf16 v[168:171], a[4:7], v[148:151], v[168:171]
    v_cvt_pk_bf16_f32 v99, v166, v167
    v_mul_f32_dpp v160, v40, v40 row_ror:1 row_mask:0xf bank_mask:0xf
    v_mfma_f32_16x16x32_bf16 v[168:171], a[8:11], v[152:155], v[168:171]
    v_cvt_pk_bf16_f32 v198, v180, v181 clamp
    v_cvt_pk_bf16_f32 v199, v182, v183 clamp
    v_mfma_f32_16x16x32_bf16 v[168:171], a[12:15], v[156:159], v[168:171]
    global_load_dwordx4 v[80:83], v246, s[6:7] offset:0
    v_mfma_f32_4x4x4_16b_bf16 v[48:51], a[200:201], v[120:121], 0
    v_mul_f32_dpp v161, v41, v41 row_ror:1 row_mask:0xf bank_mask:0xf
    v_mfma_f32_4x4x4_16b_bf16 v[52:55], a[200:201], v[122:123], 0
    v_cvt_pk_bf16_f32 v100, v160, v161
    v_mfma_f32_4x4x4_16b_bf16 v[56:59], a[200:201], v[124:125], 0
    v_mul_f32_dpp v162, v42, v42 row_ror:1 row_mask:0xf bank_mask:0xf
    v_mfma_f32_4x4x4_16b_bf16 v[60:63], a[200:201], v[126:127], 0
    v_cvt_pk_bf16_f32 v184, v168, v169 clamp
    v_cvt_pk_bf16_f32 v185, v170, v171 clamp
    v_mul_f32_dpp v163, v43, v43 row_ror:1 row_mask:0xf bank_mask:0xf
    v_mfma_f32_16x16x32_bf16 v[172:175], a[28:31], v[156:159], v[4:7]
    v_cvt_pk_bf16_f32 v101, v162, v163
    v_mul_f32_dpp v164, v44, v44 row_ror:1 row_mask:0xf bank_mask:0xf
    v_mfma_f32_16x16x32_bf16 v[172:175], a[24:27], v[152:155], v[172:175]
    v_mul_f32_dpp v165, v45, v45 row_ror:1 row_mask:0xf bank_mask:0xf
    v_cvt_pk_bf16_f32 v102, v164, v165
    v_mfma_f32_16x16x32_bf16 v[172:175], a[20:23], v[148:151], v[172:175]
    v_mul_f32_dpp v166, v46, v46 row_ror:1 row_mask:0xf bank_mask:0xf
    v_mul_f32_dpp v167, v47, v47 row_ror:1 row_mask:0xf bank_mask:0xf
    v_mfma_f32_16x16x32_bf16 v[172:175], a[16:19], v[144:147], v[172:175]
    global_load_dwordx4 v[84:87], v246, s[6:7] offset:64
    v_mfma_f32_16x16x32_bf16 v[176:179], a[32:35], v[144:147], v[8:11]
    v_cvt_pk_bf16_f32 v103, v166, v167
    v_mul_f32_dpp v160, v48, v48 row_ror:1 row_mask:0xf bank_mask:0xf
    v_mfma_f32_16x16x32_bf16 v[176:179], a[36:39], v[148:151], v[176:179]
    v_mul_f32_dpp v161, v49, v49 row_ror:1 row_mask:0xf bank_mask:0xf
    v_cvt_pk_bf16_f32 v104, v160, v161
    v_mfma_f32_16x16x32_bf16 v[176:179], a[40:43], v[152:155], v[176:179]
    v_cvt_pk_bf16_f32 v186, v172, v173 clamp
    v_cvt_pk_bf16_f32 v187, v174, v175 clamp
    v_mfma_f32_16x16x32_bf16 v[176:179], a[44:47], v[156:159], v[176:179]
    v_mul_f32_dpp v162, v50, v50 row_ror:1 row_mask:0xf bank_mask:0xf
    v_mul_f32_dpp v163, v51, v51 row_ror:1 row_mask:0xf bank_mask:0xf
    v_mfma_f32_16x16x32_bf16 v[180:183], a[60:63], v[156:159], v[12:15]
    v_cvt_pk_bf16_f32 v105, v162, v163
    v_mul_f32_dpp v164, v52, v52 row_ror:1 row_mask:0xf bank_mask:0xf
    v_mfma_f32_16x16x32_bf16 v[180:183], a[56:59], v[152:155], v[180:183]
    v_mul_f32_dpp v165, v53, v53 row_ror:1 row_mask:0xf bank_mask:0xf
    v_cvt_pk_bf16_f32 v106, v164, v165
    v_mfma_f32_16x16x32_bf16 v[180:183], a[52:55], v[148:151], v[180:183]
    v_cvt_pk_bf16_f32 v188, v176, v177 clamp
    v_cvt_pk_bf16_f32 v189, v178, v179 clamp
    v_mfma_f32_16x16x32_bf16 v[180:183], a[48:51], v[144:147], v[180:183]
    v_mul_f32_dpp v166, v54, v54 row_ror:1 row_mask:0xf bank_mask:0xf
    v_mul_f32_dpp v167, v55, v55 row_ror:1 row_mask:0xf bank_mask:0xf
    v_mfma_f32_16x16x32_bf16 v[168:171], a[64:67], v[144:147], v[16:19]
    global_load_dwordx4 v[88:91], v246, s[6:7] offset:128
    v_mfma_f32_16x16x32_bf16 v[168:171], a[68:71], v[148:151], v[168:171]
    v_cvt_pk_bf16_f32 v107, v166, v167
    v_mul_f32_dpp v160, v56, v56 row_ror:1 row_mask:0xf bank_mask:0xf
    v_mfma_f32_16x16x32_bf16 v[168:171], a[72:75], v[152:155], v[168:171]
    v_cvt_pk_bf16_f32 v190, v180, v181 clamp
    v_cvt_pk_bf16_f32 v191, v182, v183 clamp
    v_mfma_f32_16x16x32_bf16 v[168:171], a[76:79], v[156:159], v[168:171]
    v_mul_f32_dpp v161, v57, v57 row_ror:1 row_mask:0xf bank_mask:0xf
    v_cvt_pk_bf16_f32 v108, v160, v161
    v_mfma_f32_16x16x32_bf16 v[172:175], a[92:95], v[156:159], v[20:23]
    v_mul_f32_dpp v162, v58, v58 row_ror:1 row_mask:0xf bank_mask:0xf
    v_mul_f32_dpp v163, v59, v59 row_ror:1 row_mask:0xf bank_mask:0xf
    v_mfma_f32_16x16x32_bf16 v[172:175], a[88:91], v[152:155], v[172:175]
    v_cvt_pk_bf16_f32 v109, v162, v163
    v_mul_f32_dpp v164, v60, v60 row_ror:1 row_mask:0xf bank_mask:0xf
    v_mfma_f32_16x16x32_bf16 v[172:175], a[84:87], v[148:151], v[172:175]
    v_mul_f32_dpp v165, v61, v61 row_ror:1 row_mask:0xf bank_mask:0xf
    v_cvt_pk_bf16_f32 v110, v164, v165
    v_mfma_f32_16x16x32_bf16 v[172:175], a[80:83], v[144:147], v[172:175]
    v_mul_f32_dpp v166, v62, v62 row_ror:1 row_mask:0xf bank_mask:0xf
    v_mul_f32_dpp v167, v63, v63 row_ror:1 row_mask:0xf bank_mask:0xf
    v_smfmac_f32_16x16x64_bf16 v[204:207], a[148:151], v[192:199], v233
    v_cvt_pk_bf16_f32 v192, v168, v169 clamp
    v_smfmac_f32_16x16x64_bf16 v[204:207], a[152:155], v[184:191], v233
    v_cvt_pk_bf16_f32 v193, v170, v171 clamp
    v_mfma_f32_16x16x32_bf16 v[176:179], a[96:99], v[144:147], v[24:27]
    global_load_dwordx4 v[92:95], v246, s[6:7] offset:192
    v_mfma_f32_16x16x32_bf16 v[176:179], a[100:103], v[148:151], v[176:179]
    v_cvt_pk_bf16_f32 v194, v172, v173 clamp
    v_cvt_pk_bf16_f32 v195, v174, v175 clamp
    v_mfma_f32_16x16x32_bf16 v[176:179], a[104:107], v[152:155], v[176:179]
    v_cvt_pk_bf16_f32 v111, v166, v167
    v_mul_f32_dpp v160, v32, v32 row_ror:2 row_mask:0xf bank_mask:0xf
    v_mfma_f32_16x16x32_bf16 v[176:179], a[108:111], v[156:159], v[176:179]
    v_mul_f32_dpp v161, v33, v33 row_ror:2 row_mask:0xf bank_mask:0xf
    v_mul_f32_dpp v162, v34, v34 row_ror:2 row_mask:0xf bank_mask:0xf
    v_mfma_f32_16x16x32_bf16 v[180:183], a[124:127], v[156:159], v[28:31]
    v_mul_f32_dpp v163, v35, v35 row_ror:2 row_mask:0xf bank_mask:0xf
    v_mul_f32_dpp v164, v36, v36 row_ror:2 row_mask:0xf bank_mask:0xf
    v_mfma_f32_16x16x32_bf16 v[180:183], a[120:123], v[152:155], v[180:183]
    v_mul_f32_dpp v165, v37, v37 row_ror:2 row_mask:0xf bank_mask:0xf
    v_mul_f32_dpp v166, v38, v38 row_ror:2 row_mask:0xf bank_mask:0xf
    v_mfma_f32_16x16x32_bf16 v[180:183], a[116:119], v[148:151], v[180:183]
    v_cvt_pk_bf16_f32 v196, v176, v177 clamp
    v_cvt_pk_bf16_f32 v197, v178, v179 clamp
    v_mfma_f32_16x16x32_bf16 v[180:183], a[112:115], v[144:147], v[180:183]
    v_cvt_pk_bf16_f32 v144, v160, v161
    v_cvt_pk_bf16_f32 v145, v162, v163
    s_branch L_loop
L_tail:
L_pad9:
    s_cbranch_vccnz L_resume
    v_mfma_f32_16x16x32_bf16 v[168:171], a[0:3], v[128:131], v[0:3]
    v_cvt_pk_bf16_f32 v144, v160, v161
    v_mul_f32_dpp v162, v66, v34 row_newbcast:13 row_mask:0xf bank_mask:0xf
    v_mfma_f32_16x16x32_bf16 v[168:171], a[4:7], v[132:135], v[168:171]
    v_mul_f32_dpp v163, v67, v35 row_newbcast:13 row_mask:0xf bank_mask:0xf
    v_cvt_pk_bf16_f32 v145, v162, v163
    v_mfma_f32_16x16x32_bf16 v[168:171], a[8:11], v[136:139], v[168:171]
    v_cvt_pk_bf16_f32 v198, v180, v181 clamp
    v_cvt_pk_bf16_f32 v199, v182, v183 clamp
    v_mfma_f32_16x16x32_bf16 v[168:171], a[12:15], v[140:143], v[168:171]
    v_mul_f32_dpp v164, v68, v36 row_newbcast:13 row_mask:0xf bank_mask:0xf
    v_mul_f32_dpp v165, v69, v37 row_newbcast:13 row_mask:0xf bank_mask:0xf
    v_mfma_f32_16x16x32_bf16 v[172:175], a[28:31], v[140:143], v[4:7]
    v_cvt_pk_bf16_f32 v146, v164, v165
    v_mul_f32_dpp v166, v70, v38 row_newbcast:13 row_mask:0xf bank_mask:0xf
    v_mfma_f32_16x16x32_bf16 v[172:175], a[24:27], v[136:139], v[172:175]
    v_mul_f32_dpp v167, v71, v39 row_newbcast:13 row_mask:0xf bank_mask:0xf
    v_cvt_pk_bf16_f32 v147, v166, v167
    v_mfma_f32_16x16x32_bf16 v[172:175], a[20:23], v[132:135], v[172:175]
    v_cvt_pk_bf16_f32 v184, v168, v169 clamp
    v_cvt_pk_bf16_f32 v185, v170, v171 clamp
    v_mfma_f32_16x16x32_bf16 v[172:175], a[16:19], v[128:131], v[172:175]
    v_mul_f32_dpp v160, v72, v40 row_newbcast:13 row_mask:0xf bank_mask:0xf
    v_mul_f32_dpp v161, v73, v41 row_newbcast:13 row_mask:0xf bank_mask:0xf
    v_mfma_f32_16x16x32_bf16 v[176:179], a[32:35], v[128:131], v[8:11]
    v_cvt_pk_bf16_f32 v148, v160, v161
    v_mul_f32_dpp v162, v74, v42 row_newbcast:13 row_mask:0xf bank_mask:0xf
    v_mfma_f32_16x16x32_bf16 v[176:179], a[36:39], v[132:135], v[176:179]
    v_mul_f32_dpp v163, v75, v43 row_newbcast:13 row_mask:0xf bank_mask:0xf
    v_cvt_pk_bf16_f32 v149, v162, v163
    v_mfma_f32_16x16x32_bf16 v[176:179], a[40:43], v[136:139], v[176:179]
    v_cvt_pk_bf16_f32 v186, v172, v173 clamp
    v_cvt_pk_bf16_f32 v187, v174, v175 clamp
    v_mfma_f32_16x16x32_bf16 v[176:179], a[44:47], v[140:143], v[176:179]
    v_mul_f32_dpp v164, v76, v44 row_newbcast:13 row_mask:0xf bank_mask:0xf
    v_mul_f32_dpp v165, v77, v45 row_newbcast:13 row_mask:0xf bank_mask:0xf
    v_mfma_f32_16x16x32_bf16 v[180:183], a[60:63], v[140:143], v[12:15]
    v_cvt_pk_bf16_f32 v150, v164, v165
    v_mul_f32_dpp v166, v78, v46 row_newbcast:13 row_mask:0xf bank_mask:0xf
    v_mfma_f32_16x16x32_bf16 v[180:183], a[56:59], v[136:139], v[180:183]
    v_mul_f32_dpp v167, v79, v47 row_newbcast:13 row_mask:0xf bank_mask:0xf
    v_cvt_pk_bf16_f32 v151, v166, v167
    v_mfma_f32_16x16x32_bf16 v[180:183], a[52:55], v[132:135], v[180:183]
    v_cvt_pk_bf16_f32 v188, v176, v177 clamp
    v_cvt_pk_bf16_f32 v189, v178, v179 clamp
    v_mfma_f32_16x16x32_bf16 v[180:183], a[48:51], v[128:131], v[180:183]
    v_mul_f32_dpp v160, v80, v48 row_newbcast:13 row_mask:0xf bank_mask:0xf
    v_mul_f32_dpp v161, v81, v49 row_newbcast:13 row_mask:0xf bank_mask:0xf
    v_mfma_f32_16x16x32_bf16 v[168:171], a[64:67], v[128:131], v[16:19]
    v_cvt_pk_bf16_f32 v152, v160, v161
    v_mul_f32_dpp v162, v82, v50 row_newbcast:13 row_mask:0xf bank_mask:0xf
    v_mfma_f32_16x16x32_bf16 v[168:171], a[68:71], v[132:135], v[168:171]
    v_mul_f32_dpp v163, v83, v51 row_newbcast:13 row_mask:0xf bank_mask:0xf
    v_cvt_pk_bf16_f32 v153, v162, v163
    v_mfma_f32_16x16x32_bf16 v[168:171], a[72:75], v[136:139], v[168:171]
    v_cvt_pk_bf16_f32 v190, v180, v181 clamp
    v_cvt_pk_bf16_f32 v191, v182, v183 clamp
    v_mfma_f32_16x16x32_bf16 v[168:171], a[76:79], v[140:143], v[168:171]
    v_mul_f32_dpp v164, v84, v52 row_newbcast:13 row_mask:0xf bank_mask:0xf
    v_mul_f32_dpp v165, v85, v53 row_newbcast:13 row_mask:0xf bank_mask:0xf
    v_mfma_f32_16x16x32_bf16 v[172:175], a[92:95], v[140:143], v[20:23]
    v_cvt_pk_bf16_f32 v154, v164, v165
    v_mul_f32_dpp v166, v86, v54 row_newbcast:13 row_mask:0xf bank_mask:0xf
    v_mfma_f32_16x16x32_bf16 v[172:175], a[88:91], v[136:139], v[172:175]
    v_mul_f32_dpp v167, v87, v55 row_newbcast:13 row_mask:0xf bank_mask:0xf
    v_cvt_pk_bf16_f32 v155, v166, v167
    v_mfma_f32_16x16x32_bf16 v[172:175], a[84:87], v[132:135], v[172:175]
    v_mul_f32_dpp v160, v88, v56 row_newbcast:13 row_mask:0xf bank_mask:0xf
    v_mul_f32_dpp v161, v89, v57 row_newbcast:13 row_mask:0xf bank_mask:0xf
    v_mfma_f32_16x16x32_bf16 v[172:175], a[80:83], v[128:131], v[172:175]
    v_cvt_pk_bf16_f32 v156, v160, v161
    v_mul_f32_dpp v162, v90, v58 row_newbcast:13 row_mask:0xf bank_mask:0xf
    v_smfmac_f32_16x16x64_bf16 v[204:207], a[140:143], v[192:199], v233
    v_cvt_pk_bf16_f32 v192, v168, v169 clamp
    v_smfmac_f32_16x16x64_bf16 v[204:207], a[144:147], v[184:191], v233
    v_cvt_pk_bf16_f32 v193, v170, v171 clamp
    v_mfma_f32_16x16x32_bf16 v[176:179], a[96:99], v[128:131], v[24:27]
    v_mul_f32_dpp v163, v91, v59 row_newbcast:13 row_mask:0xf bank_mask:0xf
    v_cvt_pk_bf16_f32 v194, v172, v173 clamp
    v_mfma_f32_16x16x32_bf16 v[176:179], a[100:103], v[132:135], v[176:179]
    v_cvt_pk_bf16_f32 v157, v162, v163
    v_cvt_pk_bf16_f32 v195, v174, v175 clamp
    v_mfma_f32_16x16x32_bf16 v[176:179], a[104:107], v[136:139], v[176:179]
    v_mul_f32_dpp v164, v92, v60 row_newbcast:13 row_mask:0xf bank_mask:0xf
    v_mul_f32_dpp v165, v93, v61 row_newbcast:13 row_mask:0xf bank_mask:0xf
    v_mfma_f32_16x16x32_bf16 v[176:179], a[108:111], v[140:143], v[176:179]
    v_cvt_pk_bf16_f32 v158, v164, v165
    v_mul_f32_dpp v166, v94, v62 row_newbcast:13 row_mask:0xf bank_mask:0xf
    v_mfma_f32_16x16x32_bf16 v[180:183], a[124:127], v[140:143], v[28:31]
    v_mul_f32_dpp v167, v95, v63 row_newbcast:13 row_mask:0xf bank_mask:0xf
    v_cvt_pk_bf16_f32 v159, v166, v167
    v_mfma_f32_16x16x32_bf16 v[180:183], a[120:123], v[136:139], v[180:183]
    ds_read_b32 v224, v243 offset:1280
    v_mfma_f32_16x16x32_bf16 v[180:183], a[116:119], v[132:135], v[180:183]
    v_cvt_pk_bf16_f32 v196, v176, v177 clamp
    v_cvt_pk_bf16_f32 v197, v178, v179 clamp
    v_mfma_f32_16x16x32_bf16 v[180:183], a[112:115], v[128:131], v[180:183]
    ds_read_b32 v225, v244 offset:1280
    v_mfma_f32_16x16x32_bf16 v[168:171], a[0:3], v[144:147], v[0:3]
    v_max3_f32 v235, v226, v232, v227
    v_max3_f32 v235, v235, v228, v229
    v_mfma_f32_16x16x32_bf16 v[168:171], a[4:7], v[148:151], v[168:171]
    v_permlane16_swap_b32 v240, v239
    v_mfma_f32_16x16x32_bf16 v[168:171], a[8:11], v[152:155], v[168:171]
    v_max_f32_dpp v235, v235, v235 row_ror:8 row_mask:0xf bank_mask:0xf
    v_cvt_pk_bf16_f32 v198, v180, v181 clamp
    v_mfma_f32_16x16x32_bf16 v[168:171], a[12:15], v[156:159], v[168:171]
    v_cvt_pk_bf16_f32 v199, v182, v183 clamp
    v_max_f32_dpp v235, v235, v235 row_ror:4 row_mask:0xf bank_mask:0xf
    v_mfma_f32_16x16x32_bf16 v[172:175], a[28:31], v[156:159], v[4:7]
    v_add_f32 v240, v240, v239
    v_max_f32_dpp v235, v235, v235 row_ror:2 row_mask:0xf bank_mask:0xf
    v_mfma_f32_16x16x32_bf16 v[172:175], a[24:27], v[152:155], v[172:175]
    v_add_f32_dpp v240, v240, v240 row_ror:8 row_mask:0xf bank_mask:0xf
    v_max_f32_dpp v235, v235, v235 row_ror:1 row_mask:0xf bank_mask:0xf
    v_mfma_f32_16x16x32_bf16 v[172:175], a[20:23], v[148:151], v[172:175]
    v_cvt_pk_bf16_f32 v184, v168, v169 clamp
    v_cvt_pk_bf16_f32 v185, v170, v171 clamp
    v_mfma_f32_16x16x32_bf16 v[172:175], a[16:19], v[144:147], v[172:175]
    v_max_f32_dpp v235, v235, v235 row_bcast:15 row_mask:0xa bank_mask:0xf
    v_add_f32_dpp v240, v240, v240 row_ror:4 row_mask:0xf bank_mask:0xf
    v_mfma_f32_16x16x32_bf16 v[176:179], a[32:35], v[144:147], v[8:11]
    v_max_f32_dpp v235, v235, v235 row_bcast:31 row_mask:0xc bank_mask:0xf
    v_mul_f32 v254, v253, v235
    v_mfma_f32_16x16x32_bf16 v[176:179], a[36:39], v[148:151], v[176:179]
    v_fma_f32 v254, |v254|, s23, v254
    v_add_f32_dpp v240, v240, v240 row_ror:2 row_mask:0xf bank_mask:0xf
    v_mfma_f32_16x16x32_bf16 v[176:179], a[40:43], v[152:155], v[176:179]
    v_cvt_pk_bf16_f32 v186, v172, v173 clamp
    v_cvt_pk_bf16_f32 v187, v174, v175 clamp
    v_mfma_f32_16x16x32_bf16 v[176:179], a[44:47], v[156:159], v[176:179]
    s_waitcnt lgkmcnt(0)
    v_mov_b32_dpp v222, v225 quad_perm:[0,1,2,3] row_mask:0x7 bank_mask:0xf
    v_mfma_f32_16x16x32_bf16 v[180:183], a[60:63], v[156:159], v[12:15]
    v_readlane_b32 s24, v254, 63
    v_add_f32_dpp v240, v240, v240 row_ror:1 row_mask:0xf bank_mask:0xf
    v_mfma_f32_16x16x32_bf16 v[180:183], a[56:59], v[152:155], v[180:183]
    v_mov_b32 v254, s24
    v_fma_f32 v226, v226, v253, -s24
    v_mfma_f32_16x16x32_bf16 v[180:183], a[52:55], v[148:151], v[180:183]
    v_cvt_pk_bf16_f32 v188, v176, v177 clamp
    v_cvt_pk_bf16_f32 v189, v178, v179 clamp
    v_mfma_f32_16x16x32_bf16 v[180:183], a[48:51], v[144:147], v[180:183]
    v_exp_f32_e64 v226, v226 clamp
    v_mfma_f32_16x16x32_bf16 v[168:171], a[64:67], v[144:147], v[16:19]
    v_mul_f32 v236, v226, v224
    v_fma_f32 v232, v232, v253, -s24
    v_mfma_f32_16x16x32_bf16 v[168:171], a[68:71], v[148:151], v[168:171]
    v_exp_f32_e64 v232, v232 clamp
    v_mfma_f32_16x16x32_bf16 v[168:171], a[72:75], v[152:155], v[168:171]
    v_fmac_f32 v236, v232, v225
    v_cvt_pk_bf16_f32 v190, v180, v181 clamp
    v_mfma_f32_16x16x32_bf16 v[168:171], a[76:79], v[156:159], v[168:171]
    v_cvt_pk_bf16_f32 v191, v182, v183 clamp
    v_add_f32 v237, v226, v232
    v_mfma_f32_16x16x32_bf16 v[172:175], a[92:95], v[156:159], v[20:23]
    v_fma_f32 v227, v227, v253, -s24
    v_fma_f32 v228, v228, v253, -s24
    v_mfma_f32_16x16x32_bf16 v[172:175], a[88:91], v[152:155], v[172:175]
    v_exp_f32_e64 v227, v227 clamp
    v_mfma_f32_16x16x32_bf16 v[172:175], a[84:87], v[148:151], v[172:175]
    v_fmac_f32 v236, v227, v222
    v_add_f32 v237, v237, v227
    v_mfma_f32_16x16x32_bf16 v[172:175], a[80:83], v[144:147], v[172:175]
    v_exp_f32_e64 v228, v228 clamp
    v_smfmac_f32_16x16x64_bf16 v[204:207], a[148:151], v[192:199], v233
    v_cvt_pk_bf16_f32 v192, v168, v169 clamp
    v_smfmac_f32_16x16x64_bf16 v[204:207], a[152:155], v[184:191], v233
    v_cvt_pk_bf16_f32 v193, v170, v171 clamp
    v_mfma_f32_16x16x32_bf16 v[176:179], a[96:99], v[144:147], v[24:27]
    v_fmac_f32 v236, v228, v223
    v_add_f32 v237, v237, v228
    v_mfma_f32_16x16x32_bf16 v[176:179], a[100:103], v[148:151], v[176:179]
    v_cvt_pk_bf16_f32 v194, v172, v173 clamp
    v_cvt_pk_bf16_f32 v195, v174, v175 clamp
    v_mfma_f32_16x16x32_bf16 v[176:179], a[104:107], v[152:155], v[176:179]
    v_fma_f32 v229, v229, v253, -s24
    v_mfma_f32_16x16x32_bf16 v[176:179], a[108:111], v[156:159], v[176:179]
    v_exp_f32_e64 v229, v229 clamp
    v_mfma_f32_16x16x32_bf16 v[180:183], a[124:127], v[156:159], v[28:31]
    v_fmac_f32 v236, v229, v220
    v_add_f32 v237, v237, v229
    v_mfma_f32_16x16x32_bf16 v[180:183], a[120:123], v[152:155], v[180:183]
    v_mfma_f32_16x16x32_bf16 v[180:183], a[116:119], v[148:151], v[180:183]
    v_mfma_f32_16x16x32_bf16 v[180:183], a[112:115], v[144:147], v[180:183]
    s_nop 0
    v_cvt_pk_bf16_f32 v196, v176, v177 clamp
    v_cvt_pk_bf16_f32 v197, v178, v179 clamp
    s_nop 4
    v_cvt_pk_bf16_f32 v198, v180, v181 clamp
    v_cvt_pk_bf16_f32 v199, v182, v183 clamp
    s_nop 1
    v_smfmac_f32_16x16x64_bf16 v[204:207], a[156:159], v[192:199], v233
    s_nop 7
    v_add_f32 v230, v204, v205
    v_max_f32 v235, v235, v230
    s_nop 1
    v_max_f32_dpp v235, v235, v235 row_ror:8 row_mask:0xf bank_mask:0xf
    s_nop 1
    v_max_f32_dpp v235, v235, v235 row_ror:4 row_mask:0xf bank_mask:0xf
    s_nop 1
    v_max_f32_dpp v235, v235, v235 row_ror:2 row_mask:0xf bank_mask:0xf
    s_nop 1
    v_max_f32_dpp v235, v235, v235 row_ror:1 row_mask:0xf bank_mask:0xf
    s_nop 1
    v_max_f32_dpp v235, v235, v235 row_bcast:15 row_mask:0xa bank_mask:0xf
    s_nop 1
    v_max_f32_dpp v235, v235, v235 row_bcast:31 row_mask:0xc bank_mask:0xf
    v_mul_f32 v235, v253, v235
    v_fma_f32 v235, |v235|, s23, v235
    s_nop 0
    v_readlane_b32 s25, v235, 63
    s_nop 1
    v_fma_f32 v230, v230, v253, -s25
    v_subrev_f32 v255, s25, v254
    v_exp_f32_e64 v230, v230 clamp
    v_exp_f32 v255, v255
    v_mul_f32 v221, v230, v221
    v_fma_f32 v237, v237, v255, v230
    v_fma_f32 v236, v236, v255, v221
    s_nop 1
    v_permlane32_swap_b32 v236, v237
    v_add_f32 v236, v236, v237
    s_nop 1
    v_permlane16_swap_b32 v238, v236
    v_add_f32 v238, v238, v236
    s_nop 1
    v_add_f32_dpp v238, v238, v238 row_ror:8 row_mask:0xf bank_mask:0xf
    s_nop 1
    v_add_f32_dpp v238, v238, v238 row_ror:4 row_mask:0xf bank_mask:0xf
    s_nop 1
    v_add_f32_dpp v238, v238, v238 row_ror:2 row_mask:0xf bank_mask:0xf
    s_nop 1
    v_add_f32_dpp v238, v238, v238 row_ror:1 row_mask:0xf bank_mask:0xf
    s_nop 1
    v_permlane32_swap_b32 v240, v238
    v_rcp_f32 v238, v238
    s_nop 0
    v_mul_f32 v240, v240, v238
    v_cvt_pk_bf16_f32 v240, v240, v240
    s_mov_b64 exec, s[30:31]
    global_store_short v252, v240, s[16:17]
L_done:
    s_endpgm
L_end:
.section .rodata,"a"
.p2align 6
.amdhsa_kernel standalone__factorization_afm__recsys_kernel
  .amdhsa_next_free_vgpr 512
  .amdhsa_next_free_sgpr 40
  .amdhsa_accum_offset 256
  .amdhsa_group_segment_fixed_size 0
  .amdhsa_kernarg_size 88
  .amdhsa_user_sgpr_count 2
  .amdhsa_user_sgpr_kernarg_segment_ptr 1
  .amdhsa_system_sgpr_workgroup_id_x 1
  .amdhsa_float_denorm_mode_32 3
.end_amdhsa_kernel
```
